```python
import torch

def _softmax(x, axis=-1):
    return torch.softmax(x, dim=axis)
def _gelu(x):
    return torch.nn.functional.gelu(x, approximate="tanh")
def _silu(x):
    return torch.nn.functional.silu(x)
def _sigmoid(x):
    return torch.sigmoid(x)
def _layernorm(x, axis=-1, eps=1e-5):
    m = x.mean(dim=axis, keepdim=True)
    v = x.var(dim=axis, keepdim=True, unbiased=False)
    return (x - m) / torch.sqrt(v + eps)
def _scatter_add(tgt, idx, src, axis=0):
    return tgt.clone().index_add_(axis, idx, src)
def _segment_sum(src, seg, n):
    out = torch.zeros((n,) + src.shape[1:], dtype=src.dtype)
    return out.index_add_(0, seg, src)
def _pad(x, pw):
    flat = tuple(v for pair in reversed(pw) for v in pair)
    return torch.nn.functional.pad(x, flat)

kernel_name = 'concat_heads__linear_kernel_hedgehog__sliding_block__prompt'

def setup_inputs():

    _w = (lambda a: (lambda t: t.to(torch.bfloat16) if t.is_floating_point() else t)(torch.as_tensor(a)))
    def _A_setup():
        B, S, D, H = 1, 2048, 512, 32
        Dh = D // H
        return {
            "x": _w((lambda *s: torch.randn(*s, dtype=torch.bfloat16) * 0.1)(B, S, D)),
            "wqkv": _w((lambda *s: torch.randn(*s, dtype=torch.bfloat16) * 1.6)(D, 3 * D)),
            "w_phi": _w((lambda *s: torch.randn(*s, dtype=torch.bfloat16) * 1.6)(H, Dh, Dh) * (Dh ** -0.5)),
            "wo": _w((lambda *s: torch.randn(*s, dtype=torch.bfloat16) * 3.2)(D, D)),
        }
    _A_in = _A_setup()

    def _B_setup():
        B, S, D = 1, 2048, 512
        return {
            "x": _w((lambda *s: torch.randn(*s, dtype=torch.bfloat16) * 0.2)(B, S, D)),
            "wqkv": _w((lambda *s: torch.randn(*s, dtype=torch.bfloat16) * 0.4)(D, 3 * D)),
            "wo": _w((lambda *s: torch.randn(*s, dtype=torch.bfloat16) * 0.4)(D, D)),
        }
    _B_in = _B_setup()

    return {
        "A_x": _A_in["x"],
        "A_wqkv": _A_in["wqkv"],
        "A_w_phi": _A_in["w_phi"],
        "A_wo": _A_in["wo"],
        "B_x": _B_in["x"],
        "B_wqkv": _B_in["wqkv"],
        "B_wo": _B_in["wo"],
    }

def reference(A_x, A_wqkv, A_w_phi, A_wo, B_x, B_wqkv, B_wo):
    def _A_ref(x, wqkv, w_phi, wo):
        B, S, D = x.shape
        H = 32; Dh = D // H
        qkv = (lambda x, *d: x.permute(*d))((x @ wqkv).reshape(B, S, 3, H, Dh), 2, 0, 3, 1, 4)
        q, k, v = qkv[0], qkv[1], qkv[2]
        pq = torch.einsum("bhsd,hdf->bhsf", q, w_phi)
        pk = torch.einsum("bhsd,hdf->bhsf", k, w_phi)
        phi_q = torch.concatenate([_softmax(pq, axis=-1), _softmax(-pq, axis=-1)], axis=-1)
        phi_k = torch.concatenate([_softmax(pk, axis=-1), _softmax(-pk, axis=-1)], axis=-1)
        kv = torch.einsum("bhsf,bhsd->bhfd", phi_k, v)
        z  = torch.einsum("bhsf->bhf", phi_k)
        num = torch.einsum("bhqf,bhfd->bhqd", phi_q, kv)
        den = torch.einsum("bhqf,bhf->bhq", phi_q, z)[..., None] + 1e-6
        o = num / den
        return (lambda x, *d: x.permute(*d))(o, 0, 2, 1, 3).reshape(B, S, D) @ wo

    def _B_ref(x, wqkv, wo):
        B, S, D = x.shape
        H = 32; Dh = D // H; W = 256
        qkv = (lambda x, *d: x.permute(*d))((x @ wqkv).reshape(B, S, 3, H, Dh), 2, 0, 3, 1, 4)
        q, k, v = qkv[0], qkv[1], qkv[2]
        scores = torch.einsum("bhqd,bhkd->bhqk", q, k) * (Dh ** -0.5)
        idx = torch.arange(S)
        mask = (idx[:, None] - idx[None, :] >= 0) & (idx[:, None] - idx[None, :] < W)
        scores = torch.where(mask[None, None], scores, -1e9)
        p = _softmax(scores, axis=-1)
        o = torch.einsum("bhqk,bhkd->bhqd", p, v)
        return (lambda x, *d: x.permute(*d))(o, 0, 2, 1, 3).reshape(B, S, D) @ wo

    a = _A_ref(A_x, A_wqkv, A_w_phi, A_wo)
    b = _B_ref(B_x, B_wqkv, B_wo)
    return torch.concatenate([a, b], axis=-1)
```

```asm
; @launch grid=(256,1,1) block=(512,1,1) lds=163840
.amdgcn_target "amdgcn-amd-amdhsa--gfx950"
.text
.p2align 12
.fill 832, 4, 0xbf800000
.globl concat_heads__linear_kernel_hedgehog__sliding_block__prompt_kernel
.p2align 8
.type concat_heads__linear_kernel_hedgehog__sliding_block__prompt_kernel,@function
concat_heads__linear_kernel_hedgehog__sliding_block__prompt_kernel:
  s_cmp_ge_u32 s2, 256
  s_cbranch_scc1 K_END
  s_andn2_b32 s20, 1, s2
  s_lshl_b32 s5, s20, 5
  s_load_dwordx2 s[24:25], s[0:1], s5
  s_add_u32 s5, s5, 8
  s_load_dwordx2 s[28:29], s[0:1], s5
  s_load_dwordx2 s[32:33], s[0:1], 72
  s_load_dwordx2 s[14:15], s[0:1], 16
  s_lshr_b32 s4, s2, 3
  v_lshrrev_b32 v4, 5, v0
  s_getpc_b64 s[6:7]
CPF_BASE:
  s_mul_i32 s5, s4, 2560
  v_mad_u32_u24 v2, v0, 5, s5
  v_and_b32 v2, -4, v2
  v_min_u32 v2, K_LAST-CPF_BASE, v2
  global_load_dword v219, v2, s[6:7]
  s_bfe_u32 s3, s2, 0x20001
  s_lshl1_add_u32 s2, s4, s20
  s_lshl2_add_u32 s2, s2, s3
  s_lshl_b32 s8, s3, 5
  s_add_u32 s8, s8, s4
  s_mul_i32 s8, s8, 12288
  v_mul_u32_u24 v2, 24, v0
  v_and_b32 v2, 0x3f80, v2
  s_and_b32 s6, s4, 3
  s_lshl2_add_u32 s21, s3, s6
  s_lshr_b32 s22, s4, 2
  s_lshl3_add_u32 s54, s21, s22
  s_lshl_b32 s10, s54, 9
  s_lshl_b32 s54, s54, 14
  v_and_b32 v3, 7, v0
  s_cmp_eq_u32 s20, 0
  s_cselect_b32 s9, 0, 1
  v_min_u32 v3, s9, v3
  v_lshl_add_u32 v3, s3, 1, v3
  v_and_b32 v3, 7, v3
  v_lshlrev_b32 v4, 10, v4
  v_lshl_add_u32 v7, v3, 7, v4
  s_and_b32 s3, s2, 7
  s_lshl_b32 s5, s3, 7
  s_sub_u32 s10, s10, 147968
  v_lshl_add_u32 v3, v0, 7, s10
  v_and_b32 v5, 0x1fc, v0
  s_mul_i32 s11, s20, 3
  s_add_u32 s11, s11, 1
  v_cmp_eq_u32 vcc, s11, v5
  v_mov_b32 v253, 1024
  v_writelane_b32 v253, s5, 1
  v_cndmask_b32 v253, v253, v3, vcc
  v_add_u32 v253, 10108928, v253
  s_mov_b32 s26, 0x200000
  s_mov_b32 s27, 0x20000
  s_mov_b32 s30, 0x180000
  s_mov_b32 s31, 0x20000
  s_mov_b32 s34, 0x1000000
  s_mov_b32 s35, 0x20000
  s_waitcnt lgkmcnt(0)
  s_and_b32 s29, s29, 0xffff
  s_and_b32 s25, s25, 0xffff
  buffer_load_dword v219, v2, s[28:31], s8 offen
  buffer_load_dword v219, v7, s[24:27], s54 offen
  s_and_b32 s33, s33, 0xffff
  buffer_load_dword v253, v253, s[32:35], 0 offen sc1
T_C:
  v_mov_b32 v254, 0
  s_mul_i32 s5, s20, 24
  s_add_u32 s5, s5, 24
  s_load_dwordx2 s[16:17], s[0:1], s5
  s_load_dwordx4 s[60:63], s[0:1], 56
  s_load_dwordx2 s[72:73], s[0:1], 48
  v_lshrrev_b32 v1, 6, v0
  v_and_b32 v0, 63, v0
  v_readfirstlane_b32 s23, v1
  v_lshlrev_b32 v1, 4, v0
  v_and_b32 v8, 31, v0
  v_lshrrev_b32 v9, 5, v0
  s_cmp_lt_u32 s23, 4
  s_cbranch_scc1 K_M
  s_sub_u32 s96, s23, 4
  v_lshrrev_b32 v2, 3, v0
  v_lshrrev_b32 v3, 4, v0
  v_and_b32 v4, 7, v0
  s_lshl_b32 s5, s96, 3
  v_add_u32 v2, s5, v2
  s_and_b32 s6, s96, 1
  s_lshl_b32 s6, s6, 2
  v_add_u32 v5, s6, v3
  v_xor_b32 v5, v5, v4
  v_lshlrev_b32 v5, 4, v5
  v_lshl_add_u32 v188, v2, 10, v5
  v_and_b32 v3, 1, v3
  v_lshlrev_b32 v3, 2, v3
  v_xor_b32 v3, v3, v4
  v_lshlrev_b32 v3, 4, v3
  v_mul_u32_u24 v6, 3072, v2
  v_add_u32 v189, v6, v3
  s_lshl_b32 s53, s21, 17
  s_lshl_b32 s98, s22, 7
  s_lshl_b32 s99, s96, 10
  s_add_u32 s5, s3, 0
  s_and_b32 s5, s5, 3
  s_mul_i32 s6, s5, 393216
  s_add_u32 s84, s98, s6
  s_lshl_b32 s5, s5, 8
  s_add_u32 s97, s53, s5
  s_cmp_lg_u32 s20, 0
  s_cbranch_scc1 L_0B
  s_add_u32 m0, s99, 12288
  s_add_u32 s95, s97, 0
  buffer_load_dwordx4 v188, s[24:27], s95 offen lds
  s_add_u32 m0, s99, 36864
  s_add_u32 s95, s97, 32768
  buffer_load_dwordx4 v188, s[24:27], s95 offen lds
  s_add_u32 m0, s99, 61440
  s_add_u32 s95, s97, 65536
  buffer_load_dwordx4 v188, s[24:27], s95 offen lds
  s_add_u32 m0, s99, 86016
  s_add_u32 s95, s97, 98304
  buffer_load_dwordx4 v188, s[24:27], s95 offen lds
  s_add_u32 m0, s99, 114688
  s_add_u32 s95, s84, 1024
  buffer_load_dwordx4 v189, s[28:31], s95 offen lds
  s_branch L_0C
L_0B:
  s_add_u32 m0, s99, 12288
  s_add_u32 s95, s97, 0
  buffer_load_dwordx4 v188, s[24:27], s95 offen lds
  s_add_u32 m0, s99, 36864
  s_add_u32 s95, s97, 98304
  buffer_load_dwordx4 v188, s[24:27], s95 offen lds
  s_add_u32 m0, s99, 61440
  s_add_u32 s95, s97, 32768
  buffer_load_dwordx4 v188, s[24:27], s95 offen lds
  s_add_u32 m0, s99, 86016
  s_add_u32 s95, s97, 65536
  buffer_load_dwordx4 v188, s[24:27], s95 offen lds
  s_add_u32 m0, s99, 8192
  s_add_u32 s95, s84, 1024
  buffer_load_dwordx4 v189, s[28:31], s95 offen lds
L_0C:
  s_add_u32 s5, s3, 1
  s_and_b32 s5, s5, 3
  s_mul_i32 s6, s5, 393216
  s_add_u32 s85, s98, s6
  s_lshl_b32 s5, s5, 8
  s_add_u32 s92, s53, s5
  s_add_u32 s5, s3, 2
  s_and_b32 s5, s5, 3
  s_mul_i32 s6, s5, 393216
  s_add_u32 s86, s98, s6
  s_lshl_b32 s5, s5, 8
  s_add_u32 s93, s53, s5
  s_add_u32 s5, s3, 3
  s_and_b32 s5, s5, 3
  s_mul_i32 s6, s5, 393216
  s_add_u32 s87, s98, s6
  s_lshl_b32 s5, s5, 8
  s_add_u32 s94, s53, s5
  s_waitcnt lgkmcnt(0)
  s_mov_b32 s36, s14
  s_and_b32 s37, s15, 0xffff
  s_mov_b32 s38, 0x4000
  s_mov_b32 s39, 0x20000
  s_mov_b32 s40, s16
  s_and_b32 s41, s17, 0xffff
  s_mov_b32 s42, 0x80000
  s_mov_b32 s43, 0x20000
  s_mov_b32 s44, s60
  s_and_b32 s45, s61, 0xffff
  s_mov_b32 s46, 0x400000
  s_mov_b32 s47, 0x20000
  s_getreg_b32 s18, hwreg(HW_REG_XCC_ID, 0, 4)
  s_lshl_b32 s18, s18, 28
  s_lshl_b32 s5, s3, 7
  s_add_u32 s5, s5, 10108928
  v_lshl_add_u32 v252, v8, 2, s5
  s_lshr_b32 s5, s54, 12
  s_add_u32 s5, s5, s96
  s_lshl_b32 s53, s5, 10
  s_lshl2_add_u32 s5, s4, s96
  s_mul_i32 s90, s5, 12288
  v_min_u32 v191, 11, v0
  v_lshlrev_b32 v191, 10, v191
  s_cmp_eq_u32 s20, 0
  s_cselect_b32 s5, 1, 2
  v_max_u32 v7, s5, v4
  v_lshl_add_u32 v7, s3, 1, v7
  v_and_b32 v7, 7, v7
  v_bfe_u32 v2, v0, 3, 2
  v_lshl_add_u32 v2, s96, 2, v2
  v_lshlrev_b32 v2, 10, v2
  v_lshl_add_u32 v190, v7, 7, v2
  v_lshlrev_b32 v216, 7, v4
  s_cmp_lg_u32 s20, 0
  s_cbranch_scc1 L_B
L_A:
  v_mov_b32 v196, v216
  s_lshr_b32 s74, s96, 1
  s_and_b32 s75, s96, 1
  s_lshl_b32 s76, s22, 2
  s_lshl1_add_u32 s76, s75, s76
  v_lshlrev_b32 v48, 5, v8
  v_lshl_add_u32 v48, v9, 4, v48
  s_lshl_b32 s5, s76, 9
  v_add_u32 v48, s5, v48
  v_and_b32 v56, 15, v0
  v_lshlrev_b32 v57, 3, v9
  v_sub_u32 v56, v56, v57
  v_lshrrev_b32 v57, 4, v8
  v_lshlrev_b32 v57, 15, v57
  v_or_b32 v57, 0x3f80, v57
  v_and_b32 v58, 1, v56
  v_lshlrev_b32 v58, 4, v58
  v_lshlrev_b32 v57, v58, v57
  v_lshrrev_b32 v56, 1, v56
  v_cmp_eq_u32 vcc, 0, v56
  s_nop 1
  v_cndmask_b32 v52, 0, v57, vcc
  v_cmp_eq_u32 vcc, 1, v56
  s_nop 1
  v_cndmask_b32 v53, 0, v57, vcc
  v_cmp_eq_u32 vcc, 2, v56
  s_nop 1
  v_cndmask_b32 v54, 0, v57, vcc
  v_cmp_eq_u32 vcc, 3, v56
  s_nop 1
  v_cndmask_b32 v55, 0, v57, vcc
  s_mov_b32 s56, 0x3fb8aa3b
  s_mov_b32 s57, 0x5d800000
  v_min_u32 v170, 16, v8
  v_mad_u32_u24 v170, v9, 20, v170
  v_lshlrev_b32 v170, 4, v170
  s_lshl_b32 s5, s3, 5
  s_add_u32 s5, s5, s76
  s_mul_i32 s5, s5, 1920
  s_add_u32 s10, s5, 9437184
  s_lshl1_add_u32 s5, s21, s74
  s_lshl_b32 s5, s5, 6
  s_add_u32 s5, s5, s76
  s_lshl_b32 s12, s5, 10
  s_add_u32 s12, s12, 4194304
  s_add_u32 s13, s12, 32768
  s_lshl_b32 s14, s5, 2
  s_add_u32 s14, s14, 10092544
  v_bfe_u32 v171, v0, 1, 1
  v_and_b32 v15, 1, v0
  v_lshl_add_u32 v171, v171, 5, v15
  v_lshlrev_b32 v171, 2, v171
  s_and_b32 s5, s21, 13
  s_lshl3_add_u32 s5, s5, s22
  s_bfe_u32 s6, s21, 0x10001
  s_lshl1_add_u32 s5, s5, s6
  s_lshl2_add_u32 s5, s5, s96
  s_lshl_b32 s5, s5, 12
  v_lshl_add_u32 v194, v8, 7, s5
  s_and_b32 s5, s23, 3
  s_lshl2_add_u32 s55, s21, s5
  v_bfe_u32 v198, v0, 2, 2
  v_lshl_add_u32 v200, v9, 2, v198
  v_lshlrev_b32 v200, 7, v200
  v_bfe_u32 v199, v0, 4, 1
  v_lshl_add_u32 v200, v199, 5, v200
  v_and_b32 v199, 3, v0
  v_lshl_add_u32 v200, v199, 3, v200
  v_lshrrev_b32 v198, 1, v198
  v_lshl_add_u32 v199, v198, 6, v200
  v_add_u32 v199, 98304, v199
  v_xor_b32 v200, 64, v199
  v_and_b32 v201, 28, v0
  v_and_b32 v198, 3, v0
  v_lshl_add_u32 v198, v9, 2, v198
  v_lshl_add_u32 v201, v201, 7, v198
  v_lshlrev_b32 v201, 4, v201
  s_lshl_b32 s60, s55, 16
  s_lshl_b32 s5, s20, 10
  s_add_u32 s60, s60, s5
  s_lshl_b32 s5, s22, 7
  s_add_u32 s60, s60, s5
  s_lshl_b32 s5, s20, 6
  s_add_u32 s5, s5, s55
  s_lshl_b32 s61, s5, 15
  s_add_u32 s61, s61, 4194304
  s_lshl_b32 s5, s5, 7
  s_add_u32 s5, s5, 10092544
  v_lshl_add_u32 v198, v8, 2, s5
  s_mul_i32 s5, s74, 49152
  v_bfe_u32 v15, v8, 1, 3
  v_xor_b32 v15, v15, v9
  v_xor_b32 v2, 0, v15
  v_lshl_add_u32 v2, v2, 4, s5
  v_lshl_add_u32 v2, v8, 7, v2
  v_xor_b32 v3, 2, v15
  v_lshl_add_u32 v3, v3, 4, s5
  v_lshl_add_u32 v3, v8, 7, v3
  v_xor_b32 v4, 4, v15
  v_lshl_add_u32 v4, v4, 4, s5
  v_lshl_add_u32 v4, v8, 7, v4
  v_xor_b32 v5, 6, v15
  v_lshl_add_u32 v5, v5, 4, s5
  v_lshl_add_u32 v5, v8, 7, v5
  v_bfe_u32 v15, v0, 2, 2
  v_lshl_add_u32 v6, v9, 3, v15
  v_lshlrev_b32 v6, 7, v6
  v_lshrrev_b32 v15, 1, v15
  v_xor_b32 v15, s75, v15
  v_lshl_add_u32 v6, v15, 6, v6
  v_bfe_u32 v15, v0, 4, 1
  v_lshl_add_u32 v6, v15, 5, v6
  v_and_b32 v15, 3, v0
  v_lshl_add_u32 v6, v15, 3, v6
  v_add_u32 v7, 65536, v6
  v_add_u32 v10, 131072, v6
  v_add_u32 v11, 98304, v2
  v_add_u32 v12, 98304, v3
  v_add_u32 v13, 98304, v4
  v_add_u32 v14, 98304, v5
  s_add_u32 m0, s99, 118784
  s_add_u32 s95, s84, 99328
  buffer_load_dwordx4 v189, s[28:31], s95 offen lds
  s_add_u32 m0, s99, 122880
  s_add_u32 s95, s84, 2048
  buffer_load_dwordx4 v189, s[28:31], s95 offen lds
  s_add_u32 m0, s99, 126976
  s_add_u32 s95, s84, 100352
  buffer_load_dwordx4 v189, s[28:31], s95 offen lds
  s_add_u32 m0, s99, 106496
  s_add_u32 s95, s97, 128
  buffer_load_dwordx4 v188, s[24:27], s95 offen lds
  s_add_u32 m0, s99, 110592
  s_add_u32 s95, s97, 32896
  buffer_load_dwordx4 v188, s[24:27], s95 offen lds
  s_add_u32 m0, s99, 155648
  s_add_u32 s95, s97, 65664
  buffer_load_dwordx4 v188, s[24:27], s95 offen lds
  s_add_u32 m0, s99, 159744
  s_add_u32 s95, s97, 98432
  buffer_load_dwordx4 v188, s[24:27], s95 offen lds
  s_add_u32 m0, s99, 57344
  s_add_u32 s95, s84, 197632
  buffer_load_dwordx4 v189, s[28:31], s95 offen lds
  s_add_u32 m0, s99, 69632
  s_add_u32 s95, s84, 295936
  buffer_load_dwordx4 v189, s[28:31], s95 offen lds
  s_add_u32 m0, s99, 81920
  s_add_u32 s95, s84, 198656
  buffer_load_dwordx4 v189, s[28:31], s95 offen lds
  s_add_u32 m0, s99, 94208
  s_add_u32 s95, s84, 296960
  buffer_load_dwordx4 v189, s[28:31], s95 offen lds
  s_add_u32 m0, s99, 8192
  s_add_u32 s95, s84, 0
  buffer_load_dwordx4 v189, s[28:31], s95 offen lds
  s_add_u32 m0, s99, 20480
  s_add_u32 s95, s84, 98304
  buffer_load_dwordx4 v189, s[28:31], s95 offen lds
  s_add_u32 m0, s99, 32768
  s_add_u32 s95, s84, 196608
  buffer_load_dwordx4 v189, s[28:31], s95 offen lds
  s_add_u32 m0, s99, 45056
  s_add_u32 s95, s84, 294912
  buffer_load_dwordx4 v189, s[28:31], s95 offen lds
  s_waitcnt vmcnt(12)
  v_readfirstlane_b32 s52, v253
  s_nop 3
  s_mul_i32 s52, s52, 0x915f77f5
  s_add_u32 s52, s52, 0x3c6ef39f
  v_mov_b32 v253, s52
  s_barrier
  buffer_load_dword v219, v190, s[24:27], s54 offen
  buffer_load_dwordx4 v[48:51], v48, s[36:39], 0 offen
  buffer_load_dword v219, v191, s[28:31], s90 offen offset:384
  s_add_u32 m0, s99, 98304
  s_add_u32 s95, s92, 0
  buffer_load_dwordx4 v188, s[24:27], s95 offen lds
  s_add_u32 m0, s99, 102400
  s_add_u32 s95, s92, 32768
  buffer_load_dwordx4 v188, s[24:27], s95 offen lds
  s_add_u32 m0, s99, 147456
  s_add_u32 s95, s92, 65536
  buffer_load_dwordx4 v188, s[24:27], s95 offen lds
  s_add_u32 m0, s99, 151552
  s_add_u32 s95, s92, 98304
  buffer_load_dwordx4 v188, s[24:27], s95 offen lds
  s_add_u32 m0, s99, 131072
  s_add_u32 s95, s85, 1024
  buffer_load_dwordx4 v189, s[28:31], s95 offen lds
  s_waitcnt vmcnt(8)
  s_barrier
  ds_read_b128 v[112:115], v2 offset:12288
  ds_read_b64_tr_b16 v[120:121], v6 offset:8192
  ds_read_b64_tr_b16 v[122:123], v6 offset:8704
  ds_read_b128 v[116:119], v2 offset:36864
  ds_read_b128 v[124:127], v3 offset:12288
  ds_read_b64_tr_b16 v[132:133], v6 offset:10240
  ds_read_b64_tr_b16 v[134:135], v6 offset:10752
  ds_read_b128 v[128:131], v3 offset:36864
  ds_read_b128 v[136:139], v4 offset:12288
  ds_read_b64_tr_b16 v[144:145], v6 offset:20480
  ds_read_b64_tr_b16 v[146:147], v6 offset:20992
  ds_read_b128 v[140:143], v4 offset:36864
  s_waitcnt lgkmcnt(9)
  v_mfma_f32_32x32x16_bf16 v[16:31], v[120:123], v[112:115], 0
  ds_read_b128 v[148:151], v5 offset:12288
  ds_read_b64_tr_b16 v[156:157], v6 offset:22528
  ds_read_b64_tr_b16 v[158:159], v6 offset:23040
  s_waitcnt lgkmcnt(11)
  v_mfma_f32_32x32x16_bf16 v[32:47], v[120:123], v[116:119], 0
  ds_read_b128 v[152:155], v5 offset:36864
  ds_read_b128 v[112:115], v11 offset:8192
  s_waitcnt lgkmcnt(10)
  v_mfma_f32_32x32x16_bf16 v[16:31], v[132:135], v[124:127], v[16:31]
  ds_read_b64_tr_b16 v[120:121], v6 offset:32768
  ds_read_b64_tr_b16 v[122:123], v6 offset:33280
  s_waitcnt lgkmcnt(11)
  v_mfma_f32_32x32x16_bf16 v[32:47], v[132:135], v[128:131], v[32:47]
  ds_read_b128 v[116:119], v11 offset:12288
  ds_read_b128 v[124:127], v12 offset:8192
  s_waitcnt lgkmcnt(10)
  v_mfma_f32_32x32x16_bf16 v[16:31], v[144:147], v[136:139], v[16:31]
  ds_read_b64_tr_b16 v[132:133], v6 offset:34816
  ds_read_b64_tr_b16 v[134:135], v6 offset:35328
  s_waitcnt lgkmcnt(11)
  v_mfma_f32_32x32x16_bf16 v[32:47], v[144:147], v[140:143], v[32:47]
  ds_read_b128 v[128:131], v12 offset:12288
  ds_read_b128 v[136:139], v13 offset:8192
  s_waitcnt lgkmcnt(10)
  v_mfma_f32_32x32x16_bf16 v[16:31], v[156:159], v[148:151], v[16:31]
  ds_read_b64_tr_b16 v[144:145], v6 offset:45056
  ds_read_b64_tr_b16 v[146:147], v6 offset:45568
  s_waitcnt lgkmcnt(11)
  v_mfma_f32_32x32x16_bf16 v[32:47], v[156:159], v[152:155], v[32:47]
  ds_read_b128 v[140:143], v13 offset:12288
  ds_read_b128 v[148:151], v14 offset:8192
  s_waitcnt lgkmcnt(10)
  v_mfma_f32_32x32x16_bf16 v[16:31], v[120:123], v[112:115], v[16:31]
  ds_read_b64_tr_b16 v[156:157], v6 offset:47104
  ds_read_b64_tr_b16 v[158:159], v6 offset:47616
  s_waitcnt lgkmcnt(11)
  v_mfma_f32_32x32x16_bf16 v[32:47], v[120:123], v[116:119], v[32:47]
  ds_read_b128 v[152:155], v14 offset:12288
  s_waitcnt lgkmcnt(9)
  v_mfma_f32_32x32x16_bf16 v[16:31], v[132:135], v[124:127], v[16:31]
  s_waitcnt lgkmcnt(8)
  v_mfma_f32_32x32x16_bf16 v[32:47], v[132:135], v[128:131], v[32:47]
  s_waitcnt lgkmcnt(5)
  v_mfma_f32_32x32x16_bf16 v[16:31], v[144:147], v[136:139], v[16:31]
  s_waitcnt lgkmcnt(4)
  v_mfma_f32_32x32x16_bf16 v[32:47], v[144:147], v[140:143], v[32:47]
  s_waitcnt lgkmcnt(1)
  v_mfma_f32_32x32x16_bf16 v[16:31], v[156:159], v[148:151], v[16:31]
  s_waitcnt lgkmcnt(0)
  v_mfma_f32_32x32x16_bf16 v[32:47], v[156:159], v[152:155], v[32:47]
  s_add_u32 m0, s99, 135168
  s_add_u32 s95, s85, 99328
  buffer_load_dwordx4 v189, s[28:31], s95 offen lds
  s_add_u32 m0, s99, 139264
  s_add_u32 s95, s85, 2048
  buffer_load_dwordx4 v189, s[28:31], s95 offen lds
  s_add_u32 m0, s99, 143360
  s_add_u32 s95, s85, 100352
  buffer_load_dwordx4 v189, s[28:31], s95 offen lds
  s_add_u32 m0, s99, 4096
  s_add_u32 s95, s92, 128
  buffer_load_dwordx4 v188, s[24:27], s95 offen lds
  s_add_u32 m0, s99, 28672
  s_add_u32 s95, s92, 32896
  buffer_load_dwordx4 v188, s[24:27], s95 offen lds
  s_add_u32 m0, s99, 53248
  s_add_u32 s95, s92, 65664
  buffer_load_dwordx4 v188, s[24:27], s95 offen lds
  s_add_u32 m0, s99, 77824
  s_add_u32 s95, s92, 98432
  buffer_load_dwordx4 v188, s[24:27], s95 offen lds
  s_add_u32 m0, s99, 114688
  s_add_u32 s95, s85, 197632
  buffer_load_dwordx4 v189, s[28:31], s95 offen lds
  s_add_u32 m0, s99, 118784
  s_add_u32 s95, s85, 295936
  buffer_load_dwordx4 v189, s[28:31], s95 offen lds
  s_add_u32 m0, s99, 122880
  s_add_u32 s95, s85, 198656
  buffer_load_dwordx4 v189, s[28:31], s95 offen lds
  s_add_u32 m0, s99, 126976
  s_add_u32 s95, s85, 296960
  buffer_load_dwordx4 v189, s[28:31], s95 offen lds
  s_add_u32 m0, s99, 0
  s_add_u32 s95, s93, 0
  buffer_load_dwordx4 v188, s[24:27], s95 offen lds
  s_add_u32 m0, s99, 24576
  s_add_u32 s95, s93, 32768
  buffer_load_dwordx4 v188, s[24:27], s95 offen lds
  s_add_u32 m0, s99, 49152
  s_add_u32 s95, s93, 65536
  buffer_load_dwordx4 v188, s[24:27], s95 offen lds
  s_add_u32 m0, s99, 73728
  s_add_u32 s95, s93, 98304
  buffer_load_dwordx4 v188, s[24:27], s95 offen lds
  s_waitcnt vmcnt(12)
  s_barrier
  ds_read_b128 v[64:67], v11 offset:0
  ds_read_b128 v[68:71], v11 offset:4096
  ds_read_b128 v[72:75], v12 offset:0
  ds_read_b128 v[76:79], v12 offset:4096
  ds_read_b128 v[80:83], v13 offset:0
  ds_read_b128 v[84:87], v13 offset:4096
  ds_read_b128 v[88:91], v14 offset:0
  ds_read_b128 v[92:95], v14 offset:4096
  s_add_u32 m0, s99, 8192
  s_add_u32 s95, s86, 1024
  buffer_load_dwordx4 v189, s[28:31], s95 offen lds
  s_add_u32 m0, s99, 20480
  s_add_u32 s95, s86, 99328
  buffer_load_dwordx4 v189, s[28:31], s95 offen lds
  s_add_u32 m0, s99, 32768
  s_add_u32 s95, s86, 2048
  buffer_load_dwordx4 v189, s[28:31], s95 offen lds
  s_add_u32 m0, s99, 45056
  s_add_u32 s95, s86, 100352
  buffer_load_dwordx4 v189, s[28:31], s95 offen lds
  s_add_u32 m0, s99, 16384
  s_add_u32 s95, s93, 128
  buffer_load_dwordx4 v188, s[24:27], s95 offen lds
  s_add_u32 m0, s99, 40960
  s_add_u32 s95, s93, 32896
  buffer_load_dwordx4 v188, s[24:27], s95 offen lds
  s_add_u32 m0, s99, 65536
  s_add_u32 s95, s93, 65664
  buffer_load_dwordx4 v188, s[24:27], s95 offen lds
  s_add_u32 m0, s99, 90112
  s_add_u32 s95, s93, 98432
  buffer_load_dwordx4 v188, s[24:27], s95 offen lds
  s_waitcnt lgkmcnt(0)
  s_waitcnt vmcnt(12)
  s_barrier
  s_add_u32 m0, s99, 57344
  s_add_u32 s95, s86, 197632
  buffer_load_dwordx4 v189, s[28:31], s95 offen lds
  s_add_u32 m0, s99, 69632
  s_add_u32 s95, s86, 295936
  buffer_load_dwordx4 v189, s[28:31], s95 offen lds
  s_add_u32 m0, s99, 81920
  s_add_u32 s95, s86, 198656
  buffer_load_dwordx4 v189, s[28:31], s95 offen lds
  s_add_u32 m0, s99, 94208
  s_add_u32 s95, s86, 296960
  buffer_load_dwordx4 v189, s[28:31], s95 offen lds
  s_add_u32 m0, s99, 12288
  s_add_u32 s95, s94, 0
  buffer_load_dwordx4 v188, s[24:27], s95 offen lds
  s_add_u32 m0, s99, 36864
  s_add_u32 s95, s94, 32768
  buffer_load_dwordx4 v188, s[24:27], s95 offen lds
  s_add_u32 m0, s99, 61440
  s_add_u32 s95, s94, 65536
  buffer_load_dwordx4 v188, s[24:27], s95 offen lds
  s_add_u32 m0, s99, 86016
  s_add_u32 s95, s94, 98304
  buffer_load_dwordx4 v188, s[24:27], s95 offen lds
  buffer_load_dword v194, v194, s[32:35], 0 offen
  s_waitcnt vmcnt(13)
  s_barrier
  s_add_u32 m0, s99, 131072
  s_add_u32 s95, s87, 1024
  buffer_load_dwordx4 v189, s[28:31], s95 offen lds
  s_add_u32 m0, s99, 135168
  s_add_u32 s95, s87, 99328
  buffer_load_dwordx4 v189, s[28:31], s95 offen lds
  s_add_u32 m0, s99, 106496
  s_add_u32 s95, s94, 128
  buffer_load_dwordx4 v188, s[24:27], s95 offen lds
  s_add_u32 m0, s99, 110592
  s_add_u32 s95, s94, 32896
  buffer_load_dwordx4 v188, s[24:27], s95 offen lds
  s_add_u32 m0, s99, 155648
  s_add_u32 s95, s94, 65664
  buffer_load_dwordx4 v188, s[24:27], s95 offen lds
  s_add_u32 m0, s99, 159744
  s_add_u32 s95, s94, 98432
  buffer_load_dwordx4 v188, s[24:27], s95 offen lds
  s_add_u32 m0, s99, 139264
  s_add_u32 s95, s87, 197632
  buffer_load_dwordx4 v189, s[28:31], s95 offen lds
  s_branch L_A2
PE0:
.p2align 12
PG1:
L_B:
  s_and_b32 s75, s23, 1
  s_lshr_b32 s7, s23, 2
  s_xor_b32 s5, s75, s7
  s_xor_b32 s7, s7, 1
  s_mul_i32 s5, s5, 3
  s_bfe_u32 s74, s23, 0x10001
  s_xor_b32 s74, s74, s5
  s_mov_b32 s58, 0x0000ffff
  s_mov_b32 s59, 0x0000ffff
  s_mov_b32 s56, 0x21800000
  s_mov_b32 s57, 0x3f803f80
  s_lshl1_add_u32 s6, s22, s7
  s_lshl_b32 s6, s6, 1
  s_lshl2_add_u32 s5, s21, s74
  s_lshl_b32 s7, s5, 5
  s_add_u32 s7, s7, s6
  s_lshl_b32 s12, s7, 10
  s_add_u32 s12, s12, 6291456
  s_lshl_b32 s13, s7, 2
  s_add_u32 s13, s13, 10100736
  s_xor_b32 s7, s7, 0x61
  s_lshl_b32 s14, s7, 10
  s_add_u32 s14, s14, 6291456
  s_lshl_b32 s15, s7, 2
  s_add_u32 s15, s15, 10100736
  s_lshr_b32 s91, s21, 1
  s_cmp_ge_u32 s21, 1
  s_cselect_b32 s76, 0, 0xff800000
  s_cmp_ge_u32 s21, 2
  s_cselect_b32 s77, 0, 0xff800000
  v_mov_b32 v12, 0xff800000
  v_mov_b32 v13, s77
  v_lshlrev_b32 v14, 2, v9
  v_sub_u32 v14, v8, v14
  v_cmp_gt_i32 s[64:65], 0, v14
  v_cmp_gt_i32 s[66:67], 1, v14
  v_cmp_gt_i32 s[68:69], 2, v14
  v_cmp_gt_i32 s[70:71], 3, v14
  v_cndmask_b32 v220, 0, v12, s[64:65]
  v_cndmask_b32 v236, v12, v13, s[64:65]
  v_cndmask_b32 v221, 0, v12, s[66:67]
  v_cndmask_b32 v237, v12, v13, s[66:67]
  v_cndmask_b32 v222, 0, v12, s[68:69]
  v_cndmask_b32 v238, v12, v13, s[68:69]
  v_cndmask_b32 v223, 0, v12, s[70:71]
  v_cndmask_b32 v239, v12, v13, s[70:71]
  v_cmp_gt_i32 s[64:65], 8, v14
  v_cmp_gt_i32 s[66:67], 9, v14
  v_cmp_gt_i32 s[68:69], 10, v14
  v_cmp_gt_i32 s[70:71], 11, v14
  v_cndmask_b32 v224, 0, v12, s[64:65]
  v_cndmask_b32 v240, v12, v13, s[64:65]
  v_cndmask_b32 v225, 0, v12, s[66:67]
  v_cndmask_b32 v241, v12, v13, s[66:67]
  v_cndmask_b32 v226, 0, v12, s[68:69]
  v_cndmask_b32 v242, v12, v13, s[68:69]
  v_cndmask_b32 v227, 0, v12, s[70:71]
  v_cndmask_b32 v243, v12, v13, s[70:71]
  v_cmp_gt_i32 s[64:65], 16, v14
  v_cmp_gt_i32 s[66:67], 17, v14
  v_cmp_gt_i32 s[68:69], 18, v14
  v_cmp_gt_i32 s[70:71], 19, v14
  v_cndmask_b32 v228, 0, v12, s[64:65]
  v_cndmask_b32 v244, v12, v13, s[64:65]
  v_cndmask_b32 v229, 0, v12, s[66:67]
  v_cndmask_b32 v245, v12, v13, s[66:67]
  v_cndmask_b32 v230, 0, v12, s[68:69]
  v_cndmask_b32 v246, v12, v13, s[68:69]
  v_cndmask_b32 v231, 0, v12, s[70:71]
  v_cndmask_b32 v247, v12, v13, s[70:71]
  v_cmp_gt_i32 s[64:65], 24, v14
  v_cmp_gt_i32 s[66:67], 25, v14
  v_cmp_gt_i32 s[68:69], 26, v14
  v_cmp_gt_i32 s[70:71], 27, v14
  v_cndmask_b32 v232, 0, v12, s[64:65]
  v_cndmask_b32 v248, v12, v13, s[64:65]
  v_cndmask_b32 v233, 0, v12, s[66:67]
  v_cndmask_b32 v249, v12, v13, s[66:67]
  v_cndmask_b32 v234, 0, v12, s[68:69]
  v_cndmask_b32 v250, v12, v13, s[68:69]
  v_cndmask_b32 v235, 0, v12, s[70:71]
  v_cndmask_b32 v251, v12, v13, s[70:71]
  s_mul_i32 s5, s75, 24576
  v_add_u32 v192, s5, v1
  s_add_u32 s6, s5, 49152
  v_and_b32 v193, 15, v0
  v_lshl_add_u32 v193, v193, 4, s6
  v_lshl_add_u32 v193, v9, 8, v193
  s_and_b32 s5, s23, 3
  s_lshl_b32 s5, s5, 10
  s_add_u32 s5, s5, 98304
  v_add_u32 v194, s5, v1
  v_mov_b32 v196, s12
  v_mov_b32 v197, s14
  s_mov_b32 s6, 0xff00ff00
  s_mov_b32 s7, 0xff00ff00
  v_cndmask_b32 v196, v196, v197, s[6:7]
  v_and_b32 v197, 7, v0
  v_lshl_add_u32 v196, v197, 7, v196
  v_writelane_b32 v196, s13, 32
  s_lshr_b32 s79, s54, 9
  s_add_u32 s79, s79, 10143744
  v_writelane_b32 v196, s79, 33
  v_mov_b32 v197, 0x5d800000
  s_and_b32 s5, s23, 3
  s_lshl2_add_u32 s55, s21, s5
  v_bfe_u32 v198, v0, 2, 2
  v_lshl_add_u32 v200, v9, 2, v198
  v_lshlrev_b32 v200, 7, v200
  v_bfe_u32 v199, v0, 4, 1
  v_lshl_add_u32 v200, v199, 5, v200
  v_and_b32 v199, 3, v0
  v_lshl_add_u32 v200, v199, 3, v200
  v_lshrrev_b32 v198, 1, v198
  v_lshl_add_u32 v199, v198, 6, v200
  v_add_u32 v199, 98304, v199
  v_xor_b32 v200, 64, v199
  v_and_b32 v201, 28, v0
  v_and_b32 v198, 3, v0
  v_lshl_add_u32 v198, v9, 2, v198
  v_lshl_add_u32 v201, v201, 7, v198
  v_lshlrev_b32 v201, 4, v201
  s_lshl_b32 s60, s55, 16
  s_lshl_b32 s5, s20, 10
  s_add_u32 s60, s60, s5
  s_lshl_b32 s5, s22, 7
  s_add_u32 s60, s60, s5
  s_lshl_b32 s5, s20, 6
  s_add_u32 s5, s5, s55
  s_lshl_b32 s61, s5, 15
  s_add_u32 s61, s61, 4194304
  s_lshl_b32 s5, s5, 7
  s_add_u32 s5, s5, 10092544
  v_lshl_add_u32 v198, v8, 2, s5
  v_and_b32 v12, 7, v0
  v_lshl_add_u32 v12, v12, 2, s79
  v_cmp_eq_u32 vcc, 1, v9
  s_nop 1
  v_cndmask_b32 v198, v198, v12, vcc
  s_mov_b32 s16, -1
  s_mov_b32 s17, 0
  s_cmp_lt_u32 s96, 2
  s_cselect_b32 s11, 4096, 0
  v_add_u32 v199, s11, v199
  v_add_u32 v200, s11, v200
  s_lshl_b32 s11, s11, 1
  v_mov_b32 v172, s76
  v_mov_b32 v202, s77
  v_mov_b32 v173, s76
  v_mov_b32 v203, s77
  v_mov_b32 v174, s76
  v_mov_b32 v204, s77
  v_mov_b32 v175, s76
  v_mov_b32 v205, s77
  v_mov_b32 v176, s76
  v_mov_b32 v206, s77
  v_mov_b32 v177, s76
  v_mov_b32 v207, s77
  v_mov_b32 v178, s76
  v_mov_b32 v208, s77
  v_mov_b32 v179, s76
  v_mov_b32 v209, s77
  v_mov_b32 v180, s76
  v_mov_b32 v210, s77
  v_mov_b32 v181, s76
  v_mov_b32 v211, s77
  v_mov_b32 v182, s76
  v_mov_b32 v212, s77
  v_mov_b32 v183, s76
  v_mov_b32 v213, s77
  v_mov_b32 v184, s76
  v_mov_b32 v214, s77
  v_mov_b32 v185, s76
  v_mov_b32 v215, s77
  v_mov_b32 v186, s76
  v_mov_b32 v216, s77
  v_mov_b32 v187, s76
  v_mov_b32 v217, s77
  v_mov_b32 v88, s57
  v_mov_b32 v89, s57
  v_mov_b32 v90, s57
  v_mov_b32 v91, s57
  v_mov_b32 v92, s57
  v_mov_b32 v93, s57
  v_mov_b32 v94, s57
  v_mov_b32 v95, s57
  s_mov_b32 s8, 0x3eb8aa3b
  s_mov_b32 s9, 0x3eb8aa3b
  s_lshr_b32 s6, s96, 1
  s_mul_i32 s5, s6, 49152
  v_bfe_u32 v15, v8, 1, 3
  v_xor_b32 v15, v15, v9
  v_xor_b32 v2, 0, v15
  v_lshl_add_u32 v2, v2, 4, s5
  v_lshl_add_u32 v2, v8, 7, v2
  v_xor_b32 v3, 2, v15
  v_lshl_add_u32 v3, v3, 4, s5
  v_lshl_add_u32 v3, v8, 7, v3
  v_xor_b32 v4, 4, v15
  v_lshl_add_u32 v4, v4, 4, s5
  v_lshl_add_u32 v4, v8, 7, v4
  v_xor_b32 v5, 6, v15
  v_lshl_add_u32 v5, v5, 4, s5
  v_lshl_add_u32 v5, v8, 7, v5
  v_bfe_u32 v15, v0, 2, 2
  v_lshl_add_u32 v6, v9, 3, v15
  v_lshlrev_b32 v6, 7, v6
  v_lshrrev_b32 v15, 1, v15
  v_xor_b32 v15, s75, v15
  v_lshl_add_u32 v6, v15, 6, v6
  v_bfe_u32 v15, v0, 4, 1
  v_lshl_add_u32 v6, v15, 5, v6
  v_and_b32 v15, 3, v0
  v_lshl_add_u32 v6, v15, 3, v6
  v_add_u32 v7, 65536, v6
  v_add_u32 v10, 131072, v6
  v_add_u32 v11, 98304, v2
  v_add_u32 v12, 98304, v3
  v_add_u32 v13, 98304, v4
  v_add_u32 v14, 98304, v5
  s_lshl_b32 s88, s53, 3
  s_lshr_b32 s5, s53, 3
  s_add_u32 s89, s5, 9961472
  v_lshlrev_b32 v169, 7, v0
  s_add_u32 s5, s99, 147456
  v_lshl_add_u32 v171, v0, 2, s5
  s_add_u32 m0, s99, 20480
  s_add_u32 s95, s84, 99328
  buffer_load_dwordx4 v189, s[28:31], s95 offen lds
  s_add_u32 m0, s99, 32768
  s_add_u32 s95, s84, 2048
  buffer_load_dwordx4 v189, s[28:31], s95 offen lds
  s_add_u32 m0, s99, 45056
  s_add_u32 s95, s84, 100352
  buffer_load_dwordx4 v189, s[28:31], s95 offen lds
  s_add_u32 m0, s99, 106496
  s_add_u32 s95, s97, 128
  buffer_load_dwordx4 v188, s[24:27], s95 offen lds
  s_add_u32 m0, s99, 110592
  s_add_u32 s95, s97, 98432
  buffer_load_dwordx4 v188, s[24:27], s95 offen lds
  s_add_u32 m0, s99, 155648
  s_add_u32 s95, s97, 32896
  buffer_load_dwordx4 v188, s[24:27], s95 offen lds
  s_add_u32 m0, s99, 159744
  s_add_u32 s95, s97, 65664
  buffer_load_dwordx4 v188, s[24:27], s95 offen lds
  s_add_u32 m0, s99, 131072
  s_add_u32 s95, s84, 197632
  buffer_load_dwordx4 v189, s[28:31], s95 offen lds
  s_add_u32 m0, s99, 135168
  s_add_u32 s95, s84, 295936
  buffer_load_dwordx4 v189, s[28:31], s95 offen lds
  s_add_u32 m0, s99, 139264
  s_add_u32 s95, s84, 198656
  buffer_load_dwordx4 v189, s[28:31], s95 offen lds
  s_add_u32 m0, s99, 143360
  s_add_u32 s95, s84, 296960
  buffer_load_dwordx4 v189, s[28:31], s95 offen lds
  s_add_u32 m0, s99, 114688
  s_add_u32 s95, s84, 0
  buffer_load_dwordx4 v189, s[28:31], s95 offen lds
  s_add_u32 m0, s99, 118784
  s_add_u32 s95, s84, 98304
  buffer_load_dwordx4 v189, s[28:31], s95 offen lds
  s_add_u32 m0, s99, 122880
  s_add_u32 s95, s84, 196608
  buffer_load_dwordx4 v189, s[28:31], s95 offen lds
  s_add_u32 m0, s99, 126976
  s_add_u32 s95, s84, 294912
  buffer_load_dwordx4 v189, s[28:31], s95 offen lds
  s_waitcnt vmcnt(12)
  v_readfirstlane_b32 s52, v253
  s_nop 3
  s_mul_i32 s52, s52, 0x915f77f5
  s_add_u32 s52, s52, 0x3c6ef39f
  v_mov_b32 v253, s52
  s_barrier
  buffer_load_dword v219, v190, s[24:27], s54 offen
  buffer_load_dword v219, v191, s[28:31], s90 offen offset:384
  s_add_u32 m0, s99, 98304
  s_add_u32 s95, s92, 0
  buffer_load_dwordx4 v188, s[24:27], s95 offen lds
  s_add_u32 m0, s99, 102400
  s_add_u32 s95, s92, 98304
  buffer_load_dwordx4 v188, s[24:27], s95 offen lds
  s_add_u32 m0, s99, 147456
  s_add_u32 s95, s92, 32768
  buffer_load_dwordx4 v188, s[24:27], s95 offen lds
  s_add_u32 m0, s99, 151552
  s_add_u32 s95, s92, 65536
  buffer_load_dwordx4 v188, s[24:27], s95 offen lds
  s_add_u32 m0, s99, 57344
  s_add_u32 s95, s85, 1024
  buffer_load_dwordx4 v189, s[28:31], s95 offen lds
  s_waitcnt vmcnt(7)
  s_barrier
  ds_read_b128 v[112:115], v2 offset:12288
  ds_read_b64_tr_b16 v[120:121], v7 offset:49152
  ds_read_b64_tr_b16 v[122:123], v7 offset:49664
  ds_read_b128 v[116:119], v2 offset:36864
  ds_read_b128 v[124:127], v3 offset:12288
  ds_read_b64_tr_b16 v[132:133], v7 offset:51200
  ds_read_b64_tr_b16 v[134:135], v7 offset:51712
  ds_read_b128 v[128:131], v3 offset:36864
  ds_read_b128 v[136:139], v4 offset:12288
  ds_read_b64_tr_b16 v[144:145], v7 offset:53248
  ds_read_b64_tr_b16 v[146:147], v7 offset:53760
  ds_read_b128 v[140:143], v4 offset:36864
  s_waitcnt lgkmcnt(9)
  v_mfma_f32_32x32x16_bf16 v[16:31], v[120:123], v[112:115], 0
  ds_read_b128 v[148:151], v5 offset:12288
  ds_read_b64_tr_b16 v[156:157], v7 offset:55296
  ds_read_b64_tr_b16 v[158:159], v7 offset:55808
  s_waitcnt lgkmcnt(11)
  v_mfma_f32_32x32x16_bf16 v[32:47], v[120:123], v[116:119], 0
  ds_read_b128 v[152:155], v5 offset:36864
  ds_read_b128 v[112:115], v11 offset:8192
  s_waitcnt lgkmcnt(10)
  v_mfma_f32_32x32x16_bf16 v[16:31], v[132:135], v[124:127], v[16:31]
  ds_read_b64_tr_b16 v[120:121], v7 offset:57344
  ds_read_b64_tr_b16 v[122:123], v7 offset:57856
  s_waitcnt lgkmcnt(11)
  v_mfma_f32_32x32x16_bf16 v[32:47], v[132:135], v[128:131], v[32:47]
  ds_read_b128 v[116:119], v11 offset:12288
  ds_read_b128 v[124:127], v12 offset:8192
  s_waitcnt lgkmcnt(10)
  v_mfma_f32_32x32x16_bf16 v[16:31], v[144:147], v[136:139], v[16:31]
  ds_read_b64_tr_b16 v[132:133], v7 offset:59392
  ds_read_b64_tr_b16 v[134:135], v7 offset:59904
  s_waitcnt lgkmcnt(11)
  v_mfma_f32_32x32x16_bf16 v[32:47], v[144:147], v[140:143], v[32:47]
  ds_read_b128 v[128:131], v12 offset:12288
  ds_read_b128 v[136:139], v13 offset:8192
  s_waitcnt lgkmcnt(10)
  v_mfma_f32_32x32x16_bf16 v[16:31], v[156:159], v[148:151], v[16:31]
  ds_read_b64_tr_b16 v[144:145], v7 offset:61440
  ds_read_b64_tr_b16 v[146:147], v7 offset:61952
  s_waitcnt lgkmcnt(11)
  v_mfma_f32_32x32x16_bf16 v[32:47], v[156:159], v[152:155], v[32:47]
  ds_read_b128 v[140:143], v13 offset:12288
  ds_read_b128 v[148:151], v14 offset:8192
  s_waitcnt lgkmcnt(10)
  v_mfma_f32_32x32x16_bf16 v[16:31], v[120:123], v[112:115], v[16:31]
  ds_read_b64_tr_b16 v[156:157], v7 offset:63488
  ds_read_b64_tr_b16 v[158:159], v7 offset:64000
  s_waitcnt lgkmcnt(11)
  v_mfma_f32_32x32x16_bf16 v[32:47], v[120:123], v[116:119], v[32:47]
  ds_read_b128 v[152:155], v14 offset:12288
  s_waitcnt lgkmcnt(9)
  v_mfma_f32_32x32x16_bf16 v[16:31], v[132:135], v[124:127], v[16:31]
  s_waitcnt lgkmcnt(8)
  v_mfma_f32_32x32x16_bf16 v[32:47], v[132:135], v[128:131], v[32:47]
  s_waitcnt lgkmcnt(5)
  v_mfma_f32_32x32x16_bf16 v[16:31], v[144:147], v[136:139], v[16:31]
  s_waitcnt lgkmcnt(4)
  v_mfma_f32_32x32x16_bf16 v[32:47], v[144:147], v[140:143], v[32:47]
  s_waitcnt lgkmcnt(1)
  v_mfma_f32_32x32x16_bf16 v[16:31], v[156:159], v[148:151], v[16:31]
  s_waitcnt lgkmcnt(0)
  v_mfma_f32_32x32x16_bf16 v[32:47], v[156:159], v[152:155], v[32:47]
  s_add_u32 m0, s99, 69632
  s_add_u32 s95, s85, 99328
  buffer_load_dwordx4 v189, s[28:31], s95 offen lds
  s_add_u32 m0, s99, 81920
  s_add_u32 s95, s85, 2048
  buffer_load_dwordx4 v189, s[28:31], s95 offen lds
  s_add_u32 m0, s99, 94208
  s_add_u32 s95, s85, 100352
  buffer_load_dwordx4 v189, s[28:31], s95 offen lds
  s_add_u32 m0, s99, 4096
  s_add_u32 s95, s92, 128
  buffer_load_dwordx4 v188, s[24:27], s95 offen lds
  s_add_u32 m0, s99, 28672
  s_add_u32 s95, s92, 98432
  buffer_load_dwordx4 v188, s[24:27], s95 offen lds
  s_add_u32 m0, s99, 53248
  s_add_u32 s95, s92, 32896
  buffer_load_dwordx4 v188, s[24:27], s95 offen lds
  s_add_u32 m0, s99, 77824
  s_add_u32 s95, s92, 65664
  buffer_load_dwordx4 v188, s[24:27], s95 offen lds
  s_add_u32 m0, s99, 8192
  s_add_u32 s95, s85, 197632
  buffer_load_dwordx4 v189, s[28:31], s95 offen lds
  s_add_u32 m0, s99, 20480
  s_add_u32 s95, s85, 295936
  buffer_load_dwordx4 v189, s[28:31], s95 offen lds
  s_add_u32 m0, s99, 32768
  s_add_u32 s95, s85, 198656
  buffer_load_dwordx4 v189, s[28:31], s95 offen lds
  s_add_u32 m0, s99, 45056
  s_add_u32 s95, s85, 296960
  buffer_load_dwordx4 v189, s[28:31], s95 offen lds
  s_add_u32 m0, s99, 0
  s_add_u32 s95, s93, 0
  buffer_load_dwordx4 v188, s[24:27], s95 offen lds
  s_add_u32 m0, s99, 24576
  s_add_u32 s95, s93, 98304
  buffer_load_dwordx4 v188, s[24:27], s95 offen lds
  s_add_u32 m0, s99, 49152
  s_add_u32 s95, s93, 32768
  buffer_load_dwordx4 v188, s[24:27], s95 offen lds
  s_add_u32 m0, s99, 73728
  s_add_u32 s95, s93, 65536
  buffer_load_dwordx4 v188, s[24:27], s95 offen lds
  s_branch L_B2
W9:
  s_branch W_RET
M_BJ:
  s_setprio 3
  buffer_store_dwordx4 v[160:163], v1, s[32:35], s77 offen offset:0 sc1
  buffer_store_dwordx4 v[160:163], v1, s[32:35], s77 offen offset:1024 sc1
  buffer_store_dwordx4 v[160:163], v1, s[32:35], s77 offen offset:2048 sc1
  buffer_store_dwordx4 v[160:163], v1, s[32:35], s77 offen offset:3072 sc1
  v_mov_b32 v88, s57
  v_mov_b32 v89, s57
  v_mov_b32 v90, s57
  v_mov_b32 v91, s57
  v_mov_b32 v92, s57
  v_mov_b32 v93, s57
  v_mov_b32 v94, s57
  v_mov_b32 v95, s57
  s_mov_b32 s7, 4000
LPq:
  ds_read_b32 v24, v20
  s_waitcnt lgkmcnt(0)
  v_cmp_eq_u32 vcc, v24, v28
  s_sub_u32 s7, s7, 1
  s_cbranch_scc1 LQq
  s_cbranch_vccz LQq
  s_sleep 1
  s_branch LPq
LQq:
  ds_read_b128 v[64:67], v194 offset:0
  ds_read_b128 v[68:71], v194 offset:4096
  ds_read_b128 v[72:75], v22 offset:8192
  ds_read_b128 v[76:79], v23 offset:20480
  buffer_load_dword v170, v171, s[32:35], 0 offen sc1
  s_waitcnt lgkmcnt(0)
  v_mfma_f32_32x32x16_bf16 v[96:111], v[72:75], v[64:67], v[220:235]
  s_cmp_eq_u32 s74, 0
  s_cbranch_scc1 VH0
  s_cmp_eq_u32 s74, 1
  s_cbranch_scc1 VH1
  s_cmp_eq_u32 s74, 2
  s_cbranch_scc1 VH2
  s_branch VH3
CK2:
  s_waitcnt vmcnt(0)
  v_cmp_ne_u32 vcc, s52, v170
  s_nop 0
  s_cbranch_vccz LQc2
  buffer_load_dword v170, v171, s[32:35], 0 offen sc1
  s_branch LRc2
LQc2:
  s_mov_b32 s81, 1
  s_add_u32 m0, s83, 0
  s_add_u32 s5, s82, 0
  buffer_load_dwordx4 v1, s[44:47], s5 offen offset:0 sc1 lds
  buffer_load_dwordx4 v1, s[44:47], s5 offen offset:1024 sc1 lds
  buffer_load_dwordx4 v1, s[44:47], s5 offen offset:2048 sc1 lds
  buffer_load_dwordx4 v1, s[44:47], s5 offen offset:3072 sc1 lds
  s_add_u32 m0, s83, 49152
  s_add_u32 s5, s82, 16384
  buffer_load_dwordx4 v1, s[44:47], s5 offen offset:0 sc1 lds
  buffer_load_dwordx4 v1, s[44:47], s5 offen offset:1024 sc1 lds
  buffer_load_dwordx4 v1, s[44:47], s5 offen offset:2048 sc1 lds
  buffer_load_dwordx4 v1, s[44:47], s5 offen offset:3072 sc1 lds
  s_add_u32 m0, s83, 12288
  s_add_u32 s5, s82, 4096
  buffer_load_dwordx4 v1, s[44:47], s5 offen offset:0 sc1 lds
  buffer_load_dwordx4 v1, s[44:47], s5 offen offset:1024 sc1 lds
  buffer_load_dwordx4 v1, s[44:47], s5 offen offset:2048 sc1 lds
  buffer_load_dwordx4 v1, s[44:47], s5 offen offset:3072 sc1 lds
  s_add_u32 m0, s83, 61440
  s_add_u32 s5, s82, 20480
  buffer_load_dwordx4 v1, s[44:47], s5 offen offset:0 sc1 lds
  buffer_load_dwordx4 v1, s[44:47], s5 offen offset:1024 sc1 lds
  buffer_load_dwordx4 v1, s[44:47], s5 offen offset:2048 sc1 lds
  buffer_load_dwordx4 v1, s[44:47], s5 offen offset:3072 sc1 lds
LRc2:
  s_cmp_eq_u32 s74, 0
  s_cbranch_scc1 CR2_0
  s_cmp_eq_u32 s74, 1
  s_cbranch_scc1 CR2_1
  s_cmp_eq_u32 s74, 2
  s_cbranch_scc1 CR2_2
  s_branch CR2_3
CK4:
  s_waitcnt vmcnt(0)
  v_cmp_ne_u32 vcc, s52, v170
  s_nop 0
  s_cbranch_vccz LQc4
  s_mov_b32 s7, 4000
LPc4:
  buffer_load_dword v170, v171, s[32:35], 0 offen sc1
  s_waitcnt vmcnt(0)
  v_cmp_ne_u32 vcc, s52, v170
  s_sub_u32 s7, s7, 1
  s_cbranch_scc1 LQc4
  s_cbranch_vccz LQc4
  s_sleep 1
  s_branch LPc4
LQc4:
  s_mov_b32 s81, 1
  s_add_u32 m0, s83, 0
  s_add_u32 s5, s82, 0
  buffer_load_dwordx4 v1, s[44:47], s5 offen offset:0 sc1 lds
  buffer_load_dwordx4 v1, s[44:47], s5 offen offset:1024 sc1 lds
  buffer_load_dwordx4 v1, s[44:47], s5 offen offset:2048 sc1 lds
  buffer_load_dwordx4 v1, s[44:47], s5 offen offset:3072 sc1 lds
  s_add_u32 m0, s83, 49152
  s_add_u32 s5, s82, 16384
  buffer_load_dwordx4 v1, s[44:47], s5 offen offset:0 sc1 lds
  buffer_load_dwordx4 v1, s[44:47], s5 offen offset:1024 sc1 lds
  buffer_load_dwordx4 v1, s[44:47], s5 offen offset:2048 sc1 lds
  buffer_load_dwordx4 v1, s[44:47], s5 offen offset:3072 sc1 lds
  s_add_u32 m0, s83, 12288
  s_add_u32 s5, s82, 4096
  buffer_load_dwordx4 v1, s[44:47], s5 offen offset:0 sc1 lds
  buffer_load_dwordx4 v1, s[44:47], s5 offen offset:1024 sc1 lds
  buffer_load_dwordx4 v1, s[44:47], s5 offen offset:2048 sc1 lds
  buffer_load_dwordx4 v1, s[44:47], s5 offen offset:3072 sc1 lds
  s_add_u32 m0, s83, 61440
  s_add_u32 s5, s82, 20480
  buffer_load_dwordx4 v1, s[44:47], s5 offen offset:0 sc1 lds
  buffer_load_dwordx4 v1, s[44:47], s5 offen offset:1024 sc1 lds
  buffer_load_dwordx4 v1, s[44:47], s5 offen offset:2048 sc1 lds
  buffer_load_dwordx4 v1, s[44:47], s5 offen offset:3072 sc1 lds
LRc4:
  s_cmp_eq_u32 s74, 0
  s_cbranch_scc1 CR4_0
  s_cmp_eq_u32 s74, 1
  s_cbranch_scc1 CR4_1
  s_cmp_eq_u32 s74, 2
  s_cbranch_scc1 CR4_2
  s_branch CR4_3
PE1:
.p2align 12
PG2:
K_M:
  s_lshr_b32 s96, s23, 1
  s_and_b32 s97, s23, 1
  s_mul_i32 s5, s96, 49152
  v_bfe_u32 v15, v8, 1, 3
  v_xor_b32 v15, v15, v9
  v_xor_b32 v2, 0, v15
  v_lshl_add_u32 v2, v2, 4, s5
  v_lshl_add_u32 v2, v8, 7, v2
  v_xor_b32 v3, 2, v15
  v_lshl_add_u32 v3, v3, 4, s5
  v_lshl_add_u32 v3, v8, 7, v3
  v_xor_b32 v4, 4, v15
  v_lshl_add_u32 v4, v4, 4, s5
  v_lshl_add_u32 v4, v8, 7, v4
  v_xor_b32 v5, 6, v15
  v_lshl_add_u32 v5, v5, 4, s5
  v_lshl_add_u32 v5, v8, 7, v5
  v_bfe_u32 v15, v0, 2, 2
  v_lshl_add_u32 v6, v9, 3, v15
  v_lshlrev_b32 v6, 7, v6
  v_lshrrev_b32 v15, 1, v15
  v_xor_b32 v15, s97, v15
  v_lshl_add_u32 v6, v15, 6, v6
  v_bfe_u32 v15, v0, 4, 1
  v_lshl_add_u32 v6, v15, 5, v6
  v_and_b32 v15, 3, v0
  v_lshl_add_u32 v6, v15, 3, v6
  v_add_u32 v7, 65536, v6
  v_add_u32 v10, 131072, v6
  v_add_u32 v11, 98304, v2
  v_add_u32 v12, 98304, v3
  v_add_u32 v13, 98304, v4
  v_add_u32 v14, 98304, v5
  s_waitcnt lgkmcnt(0)
  s_mov_b32 s36, s14
  s_and_b32 s37, s15, 0xffff
  s_mov_b32 s38, 0x4000
  s_mov_b32 s39, 0x20000
  s_mov_b32 s40, s16
  s_and_b32 s41, s17, 0xffff
  s_mov_b32 s42, 0x80000
  s_mov_b32 s43, 0x20000
  s_mov_b32 s44, s60
  s_and_b32 s45, s61, 0xffff
  s_mov_b32 s46, 0x400000
  s_mov_b32 s47, 0x20000
  s_getreg_b32 s18, hwreg(HW_REG_XCC_ID, 0, 4)
  s_lshl_b32 s18, s18, 28
  s_lshl_b32 s5, s3, 7
  s_add_u32 s5, s5, 10108928
  v_lshl_add_u32 v252, v8, 2, s5
  s_lshl_b32 s98, s22, 2
  s_lshl1_add_u32 s98, s97, s98
  s_lshl_b32 s99, s21, 2
  s_lshl1_add_u32 s99, s96, s99
  s_mul_i32 s5, s97, 24576
  s_lshl_b32 s94, s96, 11
  s_add_u32 s93, s5, s94
  s_add_u32 s6, s93, 8192
  v_add_u32 v168, s6, v1
  v_and_b32 v169, 15, v0
  v_lshlrev_b32 v169, 4, v169
  v_lshl_add_u32 v169, v9, 8, v169
  s_cmp_eq_u32 s20, 0
  s_cbranch_scc1 M_A
M_B:
  s_lshl_b32 s5, s96, 10
  v_subrev_u32 v168, s5, v168
  s_sub_u32 s6, s93, s5
  s_add_u32 s6, s6, 57344
  s_sub_u32 s10, 3072, s94
  v_lshrrev_b32 v15, 4, v8
  v_lshl_add_u32 v16, v15, 12, v169
  v_mul_u32_u24 v15, 12288, v15
  v_add3_u32 v169, v169, v15, s6
  v_add_u32 v17, s10, v168
  v_add_u32 v18, s10, v169
  s_lshl_b32 s84, s54, 1
  s_lshl3_add_u32 s5, s97, s96
  s_lshl_b32 s5, s5, 10
  s_add_u32 s84, s84, s5
  s_add_u32 s85, s84, 4096
  s_add_u32 s86, s84, s10
  s_add_u32 s87, s85, s10
  s_add_u32 s88, s84, 16384
  s_add_u32 s90, s86, 16384
  s_lshr_b32 s5, s54, 12
  s_add_u32 s5, s5, s23
  s_lshl_b32 s5, s5, 7
  s_add_u32 s89, s5, 9961472
  s_and_b32 s75, s23, 1
  s_lshr_b32 s7, s23, 2
  s_xor_b32 s5, s75, s7
  s_xor_b32 s7, s7, 1
  s_mul_i32 s5, s5, 3
  s_bfe_u32 s74, s23, 0x10001
  s_xor_b32 s74, s74, s5
  s_mov_b32 s58, 0x0000ffff
  s_mov_b32 s59, 0x0000ffff
  s_mov_b32 s56, 0x21800000
  s_mov_b32 s57, 0x3f803f80
  s_lshl1_add_u32 s6, s22, s7
  s_lshl_b32 s6, s6, 1
  s_lshl2_add_u32 s5, s21, s74
  s_lshl_b32 s7, s5, 5
  s_add_u32 s7, s7, s6
  s_lshl_b32 s12, s7, 10
  s_add_u32 s12, s12, 6291456
  s_lshl_b32 s13, s7, 2
  s_add_u32 s13, s13, 10100736
  s_xor_b32 s7, s7, 0x61
  s_lshl_b32 s14, s7, 10
  s_add_u32 s14, s14, 6291456
  s_lshl_b32 s15, s7, 2
  s_add_u32 s15, s15, 10100736
  s_lshr_b32 s91, s21, 1
  s_cmp_ge_u32 s21, 1
  s_cselect_b32 s76, 0, 0xff800000
  s_cmp_ge_u32 s21, 2
  s_cselect_b32 s77, 0, 0xff800000
  v_mov_b32 v188, 0xff800000
  v_mov_b32 v189, s77
  v_lshlrev_b32 v190, 2, v9
  v_sub_u32 v190, v8, v190
  v_cmp_gt_i32 s[64:65], 0, v190
  v_cmp_gt_i32 s[66:67], 1, v190
  v_cmp_gt_i32 s[68:69], 2, v190
  v_cmp_gt_i32 s[70:71], 3, v190
  v_cndmask_b32 v220, 0, v188, s[64:65]
  v_cndmask_b32 v236, v188, v189, s[64:65]
  v_cndmask_b32 v221, 0, v188, s[66:67]
  v_cndmask_b32 v237, v188, v189, s[66:67]
  v_cndmask_b32 v222, 0, v188, s[68:69]
  v_cndmask_b32 v238, v188, v189, s[68:69]
  v_cndmask_b32 v223, 0, v188, s[70:71]
  v_cndmask_b32 v239, v188, v189, s[70:71]
  v_cmp_gt_i32 s[64:65], 8, v190
  v_cmp_gt_i32 s[66:67], 9, v190
  v_cmp_gt_i32 s[68:69], 10, v190
  v_cmp_gt_i32 s[70:71], 11, v190
  v_cndmask_b32 v224, 0, v188, s[64:65]
  v_cndmask_b32 v240, v188, v189, s[64:65]
  v_cndmask_b32 v225, 0, v188, s[66:67]
  v_cndmask_b32 v241, v188, v189, s[66:67]
  v_cndmask_b32 v226, 0, v188, s[68:69]
  v_cndmask_b32 v242, v188, v189, s[68:69]
  v_cndmask_b32 v227, 0, v188, s[70:71]
  v_cndmask_b32 v243, v188, v189, s[70:71]
  v_cmp_gt_i32 s[64:65], 16, v190
  v_cmp_gt_i32 s[66:67], 17, v190
  v_cmp_gt_i32 s[68:69], 18, v190
  v_cmp_gt_i32 s[70:71], 19, v190
  v_cndmask_b32 v228, 0, v188, s[64:65]
  v_cndmask_b32 v244, v188, v189, s[64:65]
  v_cndmask_b32 v229, 0, v188, s[66:67]
  v_cndmask_b32 v245, v188, v189, s[66:67]
  v_cndmask_b32 v230, 0, v188, s[68:69]
  v_cndmask_b32 v246, v188, v189, s[68:69]
  v_cndmask_b32 v231, 0, v188, s[70:71]
  v_cndmask_b32 v247, v188, v189, s[70:71]
  v_cmp_gt_i32 s[64:65], 24, v190
  v_cmp_gt_i32 s[66:67], 25, v190
  v_cmp_gt_i32 s[68:69], 26, v190
  v_cmp_gt_i32 s[70:71], 27, v190
  v_cndmask_b32 v232, 0, v188, s[64:65]
  v_cndmask_b32 v248, v188, v189, s[64:65]
  v_cndmask_b32 v233, 0, v188, s[66:67]
  v_cndmask_b32 v249, v188, v189, s[66:67]
  v_cndmask_b32 v234, 0, v188, s[68:69]
  v_cndmask_b32 v250, v188, v189, s[68:69]
  v_cndmask_b32 v235, 0, v188, s[70:71]
  v_cndmask_b32 v251, v188, v189, s[70:71]
  s_mul_i32 s5, s75, 24576
  v_add_u32 v192, s5, v1
  s_add_u32 s6, s5, 49152
  v_and_b32 v193, 15, v0
  v_lshl_add_u32 v193, v193, 4, s6
  v_lshl_add_u32 v193, v9, 8, v193
  s_and_b32 s5, s23, 3
  s_lshl_b32 s5, s5, 10
  s_add_u32 s5, s5, 98304
  v_add_u32 v194, s5, v1
  v_mov_b32 v196, s12
  v_mov_b32 v197, s14
  s_mov_b32 s6, 0xff00ff00
  s_mov_b32 s7, 0xff00ff00
  v_cndmask_b32 v196, v196, v197, s[6:7]
  v_and_b32 v197, 7, v0
  v_lshl_add_u32 v196, v197, 7, v196
  v_writelane_b32 v196, s13, 32
  s_lshr_b32 s79, s54, 9
  s_add_u32 s79, s79, 10143744
  v_writelane_b32 v196, s79, 33
  v_mov_b32 v197, 0x5d800000
  s_and_b32 s5, s23, 3
  s_lshl2_add_u32 s55, s21, s5
  v_bfe_u32 v198, v0, 2, 2
  v_lshl_add_u32 v200, v9, 2, v198
  v_lshlrev_b32 v200, 7, v200
  v_bfe_u32 v199, v0, 4, 1
  v_lshl_add_u32 v200, v199, 5, v200
  v_and_b32 v199, 3, v0
  v_lshl_add_u32 v200, v199, 3, v200
  v_lshrrev_b32 v198, 1, v198
  v_lshl_add_u32 v199, v198, 6, v200
  v_add_u32 v199, 98304, v199
  v_xor_b32 v200, 64, v199
  v_and_b32 v201, 28, v0
  v_and_b32 v198, 3, v0
  v_lshl_add_u32 v198, v9, 2, v198
  v_lshl_add_u32 v201, v201, 7, v198
  v_lshlrev_b32 v201, 4, v201
  s_lshl_b32 s60, s55, 16
  s_lshl_b32 s5, s20, 10
  s_add_u32 s60, s60, s5
  s_lshl_b32 s5, s22, 7
  s_add_u32 s60, s60, s5
  s_lshl_b32 s5, s20, 6
  s_add_u32 s5, s5, s55
  s_lshl_b32 s61, s5, 15
  s_add_u32 s61, s61, 4194304
  s_lshl_b32 s5, s5, 7
  s_add_u32 s5, s5, 10092544
  v_lshl_add_u32 v198, v8, 2, s5
  v_lshrrev_b32 v195, 3, v0
  v_bfe_u32 v188, v0, 4, 1
  v_lshlrev_b32 v188, 2, v188
  v_and_b32 v189, 7, v0
  v_xor_b32 v188, v188, v189
  v_lshlrev_b32 v188, 4, v188
  v_lshl_add_u32 v195, v195, 10, v188
  s_lshl3_add_u32 s79, s23, s79
  s_mov_b64 s[68:69], s[32:33]
  s_cmp_eq_u32 s21, 15
  s_cselect_b32 s70, 0, 0x400000
  s_mov_b32 s71, 0x20000
  s_lshl_b32 s78, s23, 13
  s_lshl_b32 s5, s22, 7
  s_add_u32 s78, s78, s5
  s_lshl_b32 s99, s23, 10
  s_add_u32 s99, s99, 94208
  s_sub_u32 s78, s78, 32768
  s_lshl_b32 s5, s74, 10
  v_add_u32 v22, s5, v192
  s_xor_b32 s5, s5, 3072
  v_add_u32 v23, s5, v192
  s_mov_b32 s8, 4096
  s_mov_b32 s9, 32768
  v_mov_b32 v172, s76
  v_mov_b32 v202, s77
  v_mov_b32 v173, s76
  v_mov_b32 v203, s77
  v_mov_b32 v174, s76
  v_mov_b32 v204, s77
  v_mov_b32 v175, s76
  v_mov_b32 v205, s77
  v_mov_b32 v176, s76
  v_mov_b32 v206, s77
  v_mov_b32 v177, s76
  v_mov_b32 v207, s77
  v_mov_b32 v178, s76
  v_mov_b32 v208, s77
  v_mov_b32 v179, s76
  v_mov_b32 v209, s77
  v_mov_b32 v180, s76
  v_mov_b32 v210, s77
  v_mov_b32 v181, s76
  v_mov_b32 v211, s77
  v_mov_b32 v182, s76
  v_mov_b32 v212, s77
  v_mov_b32 v183, s76
  v_mov_b32 v213, s77
  v_mov_b32 v184, s76
  v_mov_b32 v214, s77
  v_mov_b32 v185, s76
  v_mov_b32 v215, s77
  v_mov_b32 v186, s76
  v_mov_b32 v216, s77
  v_mov_b32 v187, s76
  v_mov_b32 v217, s77
  s_add_u32 s5, s97, s21
  s_cmp_lt_u32 s5, 2
  s_cselect_b32 s81, 2, 0
  s_sub_i32 s5, s5, 2
  s_max_i32 s7, s5, 0
  s_mov_b32 s73, s7
  s_lshl_b32 s83, s97, 12
  s_mul_i32 s5, s96, 24576
  s_add_u32 s83, s83, s5
  s_mov_b64 s[44:45], s[32:33]
  s_lshl3_add_u32 s5, s7, s22
  s_lshl2_add_u32 s5, s5, s96
  s_lshl_b32 s82, s5, 13
  s_lshl_b32 s5, s5, 7
  s_add_u32 s5, s5, 9961472
  v_and_b32 v171, 1, v0
  v_lshl_add_u32 v171, v171, 8, s5
  v_and_b32 v15, 62, v0
  v_lshl_add_u32 v171, v15, 1, v171
  s_lshl2_add_u32 s5, s4, s23
  s_lshl_b32 s80, s5, 12
  v_and_b32 v19, 3, v0
  v_lshlrev_b32 v19, 10, v19
  v_mov_b32 v20, 147456
  v_lshl_add_u32 v20, s23, 10, v20
  v_lshl_add_u32 v20, v0, 2, v20
  v_mov_b32 v160, -1
  v_mov_b32 v161, -1
  v_mov_b32 v162, -1
  v_mov_b32 v163, -1
  s_lshl_b32 s5, s22, 12
  s_add_u32 s77, s5, s61
  s_lshr_b32 s5, s54, 12
  s_add_u32 s5, s5, s23
  s_lshl_b32 s5, s5, 13
  v_lshl_add_u32 v21, v0, 7, s5
  s_setprio 2
  s_branch M_B1
M_A:
  v_lshlrev_b32 v176, 5, v8
  v_lshl_add_u32 v176, v9, 4, v176
  s_lshl_b32 s5, s98, 9
  v_add_u32 v176, s5, v176
  v_and_b32 v184, 15, v0
  v_lshlrev_b32 v185, 3, v9
  v_sub_u32 v184, v184, v185
  v_lshrrev_b32 v185, 4, v8
  v_lshlrev_b32 v185, 15, v185
  v_or_b32 v185, 0x3f80, v185
  v_and_b32 v186, 1, v184
  v_lshlrev_b32 v186, 4, v186
  v_lshlrev_b32 v185, v186, v185
  v_lshrrev_b32 v184, 1, v184
  v_cmp_eq_u32 vcc, 0, v184
  s_nop 1
  v_cndmask_b32 v180, 0, v185, vcc
  v_cmp_eq_u32 vcc, 1, v184
  s_nop 1
  v_cndmask_b32 v181, 0, v185, vcc
  v_cmp_eq_u32 vcc, 2, v184
  s_nop 1
  v_cndmask_b32 v182, 0, v185, vcc
  v_cmp_eq_u32 vcc, 3, v184
  s_nop 1
  v_cndmask_b32 v183, 0, v185, vcc
  s_mov_b32 s56, 0x3fb8aa3b
  s_mov_b32 s57, 0x5d800000
  s_lshl_b32 s5, s96, 9
  v_xor_b32 v176, s5, v176
  s_lshl_b32 s5, s96, 5
  v_xor_b32 v6, s5, v6
  v_xor_b32 v7, s5, v7
  v_xor_b32 v10, s5, v10
  s_mov_b32 s58, 0x0000ffff
  s_mov_b32 s59, 0x0000ffff
  s_add_u32 s5, s23, 32
  v_lshl_add_u32 v209, s5, 12, v1
  v_xor_b32 v208, 256, v209
  v_xor_b32 v209, 8192, v209
  v_lshlrev_b32 v80, 2, v9
  v_sub_u32 v80, v8, v80
  v_and_b32 v81, 1, v80
  v_lshlrev_b32 v81, 4, v81
  v_mov_b32 v82, 0x3f80
  v_lshlrev_b32 v81, v81, v82
  v_lshrrev_b32 v80, 1, v80
  v_cmp_eq_u32 vcc, 0, v80
  s_nop 1
  v_cndmask_b32 v168, 0, v81, vcc
  v_cmp_eq_u32 vcc, 1, v80
  s_nop 1
  v_cndmask_b32 v169, 0, v81, vcc
  v_cmp_eq_u32 vcc, 4, v80
  s_nop 1
  v_cndmask_b32 v170, 0, v81, vcc
  v_cmp_eq_u32 vcc, 5, v80
  s_nop 1
  v_cndmask_b32 v171, 0, v81, vcc
  v_cmp_eq_u32 vcc, 8, v80
  s_nop 1
  v_cndmask_b32 v172, 0, v81, vcc
  v_cmp_eq_u32 vcc, 9, v80
  s_nop 1
  v_cndmask_b32 v173, 0, v81, vcc
  v_cmp_eq_u32 vcc, 12, v80
  s_nop 1
  v_cndmask_b32 v174, 0, v81, vcc
  v_cmp_eq_u32 vcc, 13, v80
  s_nop 1
  v_cndmask_b32 v175, 0, v81, vcc
  v_mad_u32_u24 v210, v9, 20, v8
  v_lshlrev_b32 v210, 4, v210
  s_add_u32 s9, s98, s96
  s_mul_i32 s5, s9, 30720
  s_mul_i32 s6, s21, 640
  s_add_u32 s5, s5, s6
  s_add_u32 s12, s5, 8388608
  s_add_u32 s13, s12, 10240
  s_add_u32 s14, s12, 20480
  s_mov_b32 s10, 0x000fffff
  s_mov_b32 s11, 0x000fffff
  s_and_b32 s5, s21, 3
  s_lshl2_add_u32 s5, s22, s5
  s_mul_i32 s6, s5, 3
  s_add_u32 s6, s6, s23
  s_mul_i32 s15, s6, 10240
  s_add_u32 s15, s15, 8388608
  s_mul_i32 s5, s3, 96
  s_add_u32 s6, s6, s5
  s_mul_i32 s16, s6, 640
  s_add_u32 s16, s16, 9437184
  s_lshl2_add_u32 s5, s21, s23
  s_lshl_b32 s17, s5, 7
  s_add_u32 s17, s17, 10092544
  s_lshl3_add_u32 s5, s5, s22
  s_lshl_b32 s5, s5, 12
  s_add_u32 s5, s5, 4194304
  v_lshl_add_u32 v213, v8, 7, s5
  v_min_u32 v15, 4, v8
  v_lshl_add_u32 v15, v15, 7, s16
  v_cmp_eq_u32 vcc, 1, v9
  s_nop 1
  v_cndmask_b32 v213, v213, v15, vcc
  v_writelane_b32 v213, s17, 63
  v_lshrrev_b32 v211, 3, v0
  v_bfe_u32 v80, v0, 4, 1
  v_lshlrev_b32 v80, 2, v80
  v_and_b32 v81, 7, v0
  v_xor_b32 v80, v80, v81
  v_lshlrev_b32 v80, 4, v80
  v_lshl_add_u32 v211, v211, 10, v80
  s_lshl_b32 s99, s23, 10
  s_mul_i32 s53, s22, 0x10080
  s_lshl3_add_u32 s53, s99, s53
  s_lshl2_add_u32 s5, s4, s23
  s_lshl_b32 s62, s5, 12
  v_and_b32 v212, 3, v0
  v_lshlrev_b32 v212, 10, v212
  v_mov_b32 v16, 0x3f803f80
  v_mov_b32 v17, 0x3f803f80
  v_mov_b32 v18, 0x3f803f80
  v_mov_b32 v19, 0x3f803f80
  v_mov_b32 v20, 0x3f803f80
  v_mov_b32 v21, 0x3f803f80
  v_mov_b32 v22, 0x3f803f80
  v_mov_b32 v23, 0x3f803f80
  v_mov_b32 v24, 0x3f803f80
  v_mov_b32 v25, 0x3f803f80
  v_mov_b32 v26, 0x3f803f80
  v_mov_b32 v27, 0x3f803f80
  v_mov_b32 v28, 0x3f803f80
  v_mov_b32 v29, 0x3f803f80
  v_mov_b32 v30, 0x3f803f80
  v_mov_b32 v31, 0x3f803f80
  v_mov_b32 v32, 0x3f803f80
  v_mov_b32 v33, 0x3f803f80
  v_mov_b32 v34, 0x3f803f80
  v_mov_b32 v35, 0x3f803f80
  v_mov_b32 v36, 0x3f803f80
  v_mov_b32 v37, 0x3f803f80
  v_mov_b32 v38, 0x3f803f80
  v_mov_b32 v39, 0x3f803f80
  v_mov_b32 v40, 0x3f803f80
  v_mov_b32 v41, 0x3f803f80
  v_mov_b32 v42, 0x3f803f80
  v_mov_b32 v43, 0x3f803f80
  v_mov_b32 v44, 0x3f803f80
  v_mov_b32 v45, 0x3f803f80
  v_mov_b32 v46, 0x3f803f80
  v_mov_b32 v47, 0x3f803f80
  s_setprio 2
  s_branch M_A1
PE2:
.p2align 12
PG3:
L_B2:
  s_waitcnt vmcnt(12)
  s_barrier
  ds_read_b128 v[48:51], v11 offset:0
  ds_read_b128 v[52:55], v11 offset:4096
  ds_read_b128 v[56:59], v12 offset:0
  ds_read_b128 v[60:63], v12 offset:4096
  ds_read_b128 v[64:67], v13 offset:0
  ds_read_b128 v[68:71], v13 offset:4096
  ds_read_b128 v[72:75], v14 offset:0
  ds_read_b128 v[76:79], v14 offset:4096
  s_add_u32 m0, s99, 114688
  s_add_u32 s95, s86, 1024
  buffer_load_dwordx4 v189, s[28:31], s95 offen lds
  s_add_u32 m0, s99, 118784
  s_add_u32 s95, s86, 99328
  buffer_load_dwordx4 v189, s[28:31], s95 offen lds
  s_add_u32 m0, s99, 122880
  s_add_u32 s95, s86, 2048
  buffer_load_dwordx4 v189, s[28:31], s95 offen lds
  s_add_u32 m0, s99, 126976
  s_add_u32 s95, s86, 100352
  buffer_load_dwordx4 v189, s[28:31], s95 offen lds
  s_add_u32 m0, s99, 16384
  s_add_u32 s95, s93, 128
  buffer_load_dwordx4 v188, s[24:27], s95 offen lds
  s_add_u32 m0, s99, 40960
  s_add_u32 s95, s93, 98432
  buffer_load_dwordx4 v188, s[24:27], s95 offen lds
  s_add_u32 m0, s99, 65536
  s_add_u32 s95, s93, 32896
  buffer_load_dwordx4 v188, s[24:27], s95 offen lds
  s_add_u32 m0, s99, 90112
  s_add_u32 s95, s93, 65664
  buffer_load_dwordx4 v188, s[24:27], s95 offen lds
  s_waitcnt lgkmcnt(0)
  s_waitcnt vmcnt(12)
  s_barrier
  ds_read_b32 v252, v254 offset:12288
  s_add_u32 m0, s99, 131072
  s_add_u32 s95, s86, 197632
  buffer_load_dwordx4 v189, s[28:31], s95 offen lds
  s_add_u32 m0, s99, 135168
  s_add_u32 s95, s86, 295936
  buffer_load_dwordx4 v189, s[28:31], s95 offen lds
  s_add_u32 m0, s99, 139264
  s_add_u32 s95, s86, 198656
  buffer_load_dwordx4 v189, s[28:31], s95 offen lds
  s_add_u32 m0, s99, 143360
  s_add_u32 s95, s86, 296960
  buffer_load_dwordx4 v189, s[28:31], s95 offen lds
  s_add_u32 m0, s99, 57344
  s_add_u32 s95, s87, 1024
  buffer_load_dwordx4 v189, s[28:31], s95 offen lds
  s_add_u32 m0, s99, 69632
  s_add_u32 s95, s87, 99328
  buffer_load_dwordx4 v189, s[28:31], s95 offen lds
  s_add_u32 m0, s99, 81920
  s_add_u32 s95, s87, 2048
  buffer_load_dwordx4 v189, s[28:31], s95 offen lds
  s_add_u32 m0, s99, 94208
  s_add_u32 s95, s87, 100352
  buffer_load_dwordx4 v189, s[28:31], s95 offen lds
  s_waitcnt lgkmcnt(0)
  v_readfirstlane_b32 s19, v252
  s_waitcnt vmcnt(12)
  s_barrier
  s_add_u32 m0, s99, 12288
  s_add_u32 s95, s94, 0
  buffer_load_dwordx4 v188, s[24:27], s95 offen lds
  s_add_u32 m0, s99, 36864
  s_add_u32 s95, s94, 98304
  buffer_load_dwordx4 v188, s[24:27], s95 offen lds
  s_add_u32 m0, s99, 61440
  s_add_u32 s95, s94, 32768
  buffer_load_dwordx4 v188, s[24:27], s95 offen lds
  s_add_u32 m0, s99, 86016
  s_add_u32 s95, s94, 65536
  buffer_load_dwordx4 v188, s[24:27], s95 offen lds
  s_add_u32 m0, s99, 106496
  s_add_u32 s95, s94, 128
  buffer_load_dwordx4 v188, s[24:27], s95 offen lds
  s_add_u32 m0, s99, 110592
  s_add_u32 s95, s94, 98432
  buffer_load_dwordx4 v188, s[24:27], s95 offen lds
  s_add_u32 m0, s99, 155648
  s_add_u32 s95, s94, 32896
  buffer_load_dwordx4 v188, s[24:27], s95 offen lds
  s_add_u32 m0, s99, 159744
  s_add_u32 s95, s94, 65664
  buffer_load_dwordx4 v188, s[24:27], s95 offen lds
  s_waitcnt vmcnt(12)
  s_barrier
  s_add_u32 m0, s99, 8192
  s_add_u32 s95, s87, 197632
  buffer_load_dwordx4 v189, s[28:31], s95 offen lds
  s_add_u32 m0, s99, 20480
  s_add_u32 s95, s87, 295936
  buffer_load_dwordx4 v189, s[28:31], s95 offen lds
  s_add_u32 m0, s99, 32768
  s_add_u32 s95, s87, 198656
  buffer_load_dwordx4 v189, s[28:31], s95 offen lds
  s_add_u32 m0, s99, 45056
  s_add_u32 s95, s87, 296960
  buffer_load_dwordx4 v189, s[28:31], s95 offen lds
  s_add_u32 m0, s99, 98304
  s_add_u32 s95, s85, 196608
  buffer_load_dwordx4 v189, s[28:31], s95 offen lds
  s_add_u32 m0, s99, 102400
  s_add_u32 s95, s85, 294912
  buffer_load_dwordx4 v189, s[28:31], s95 offen lds
  s_add_u32 m0, s99, 147456
  s_add_u32 s95, s86, 0
  buffer_load_dwordx4 v189, s[28:31], s95 offen lds
  s_add_u32 m0, s99, 151552
  s_add_u32 s95, s86, 98304
  buffer_load_dwordx4 v189, s[28:31], s95 offen lds
  s_waitcnt vmcnt(12)
  s_barrier
  s_add_u32 m0, s99, 114688
  s_add_u32 s95, s86, 196608
  buffer_load_dwordx4 v189, s[28:31], s95 offen lds
  s_add_u32 m0, s99, 118784
  s_add_u32 s95, s86, 294912
  buffer_load_dwordx4 v189, s[28:31], s95 offen lds
  s_add_u32 m0, s99, 122880
  s_add_u32 s95, s87, 0
  buffer_load_dwordx4 v189, s[28:31], s95 offen lds
  s_add_u32 m0, s99, 126976
  s_add_u32 s95, s87, 98304
  buffer_load_dwordx4 v189, s[28:31], s95 offen lds
  s_add_u32 m0, s99, 131072
  s_add_u32 s95, s87, 196608
  buffer_load_dwordx4 v189, s[28:31], s95 offen lds
  s_add_u32 m0, s99, 135168
  s_add_u32 s95, s87, 294912
  buffer_load_dwordx4 v189, s[28:31], s95 offen lds
  s_add_u32 m0, s99, 139264
  s_add_u32 s95, s85, 0
  buffer_load_dwordx4 v189, s[28:31], s95 offen lds
  s_add_u32 m0, s99, 143360
  s_add_u32 s95, s85, 98304
  buffer_load_dwordx4 v189, s[28:31], s95 offen lds
  s_andn2_b32 s91, s19, s91
  s_cbranch_scc0 KT_A
  buffer_load_dword v168, v169, s[32:35], s88 offen
  s_branch KT_B
KT_A:
  buffer_load_dword v168, v254, s[32:35], s89 offen
KT_B:
  s_waitcnt vmcnt(13)
  s_barrier
  s_waitcnt vmcnt(5)
  s_barrier
  ds_read_b32 v170, v171
  ds_read_b128 v[112:115], v2 offset:4096
  ds_read_b64_tr_b16 v[120:121], v7 offset:32768
  ds_read_b64_tr_b16 v[122:123], v7 offset:33280
  ds_read_b128 v[116:119], v2 offset:28672
  ds_read_b128 v[124:127], v3 offset:4096
  ds_read_b64_tr_b16 v[132:133], v7 offset:34816
  ds_read_b64_tr_b16 v[134:135], v7 offset:35328
  ds_read_b128 v[128:131], v3 offset:28672
  ds_read_b128 v[136:139], v4 offset:4096
  ds_read_b64_tr_b16 v[144:145], v7 offset:36864
  ds_read_b64_tr_b16 v[146:147], v7 offset:37376
  ds_read_b128 v[140:143], v4 offset:28672
  s_waitcnt lgkmcnt(9)
  v_mfma_f32_32x32x16_bf16 v[16:31], v[120:123], v[112:115], v[16:31]
  ds_read_b128 v[148:151], v5 offset:4096
  ds_read_b64_tr_b16 v[156:157], v7 offset:38912
  ds_read_b64_tr_b16 v[158:159], v7 offset:39424
  s_waitcnt lgkmcnt(11)
  v_mfma_f32_32x32x16_bf16 v[32:47], v[120:123], v[116:119], v[32:47]
  ds_read_b128 v[152:155], v5 offset:28672
  ds_read_b128 v[112:115], v2 offset:0
  s_waitcnt lgkmcnt(10)
  v_mfma_f32_32x32x16_bf16 v[16:31], v[132:135], v[124:127], v[16:31]
  ds_read_b64_tr_b16 v[120:121], v10 offset:16384
  ds_read_b64_tr_b16 v[122:123], v10 offset:16896
  s_waitcnt lgkmcnt(11)
  v_mfma_f32_32x32x16_bf16 v[32:47], v[132:135], v[128:131], v[32:47]
  ds_read_b128 v[116:119], v2 offset:24576
  ds_read_b128 v[124:127], v3 offset:0
  s_waitcnt lgkmcnt(10)
  v_mfma_f32_32x32x16_bf16 v[16:31], v[144:147], v[136:139], v[16:31]
  ds_read_b64_tr_b16 v[132:133], v10 offset:18432
  ds_read_b64_tr_b16 v[134:135], v10 offset:18944
  s_waitcnt lgkmcnt(11)
  v_mfma_f32_32x32x16_bf16 v[32:47], v[144:147], v[140:143], v[32:47]
  ds_read_b128 v[128:131], v3 offset:24576
  ds_read_b128 v[136:139], v4 offset:0
  s_waitcnt lgkmcnt(10)
  v_mfma_f32_32x32x16_bf16 v[16:31], v[156:159], v[148:151], v[16:31]
  ds_read_b64_tr_b16 v[144:145], v10 offset:20480
  ds_read_b64_tr_b16 v[146:147], v10 offset:20992
  s_waitcnt lgkmcnt(11)
  v_mfma_f32_32x32x16_bf16 v[32:47], v[156:159], v[152:155], v[32:47]
  ds_read_b128 v[140:143], v4 offset:24576
  ds_read_b128 v[148:151], v5 offset:0
  s_waitcnt lgkmcnt(10)
  v_mfma_f32_32x32x16_bf16 v[16:31], v[120:123], v[112:115], v[16:31]
  ds_read_b64_tr_b16 v[156:157], v10 offset:22528
  ds_read_b64_tr_b16 v[158:159], v10 offset:23040
  s_waitcnt lgkmcnt(11)
  v_mfma_f32_32x32x16_bf16 v[32:47], v[120:123], v[116:119], v[32:47]
  ds_read_b128 v[152:155], v5 offset:24576
  ds_read_b128 v[112:115], v2 offset:16384
  s_waitcnt lgkmcnt(10)
  v_mfma_f32_32x32x16_bf16 v[16:31], v[132:135], v[124:127], v[16:31]
  ds_read_b64_tr_b16 v[120:121], v7 offset:49152
  ds_read_b64_tr_b16 v[122:123], v7 offset:49664
  s_add_u32 s80, s61, 0
  s_add_u32 s81, s61, 4096
  s_add_u32 s82, s61, 8192
  s_add_u32 s83, s61, 12288
  s_waitcnt lgkmcnt(11)
  v_mfma_f32_32x32x16_bf16 v[32:47], v[132:135], v[128:131], v[32:47]
  ds_read_b128 v[116:119], v2 offset:40960
  ds_read_b128 v[124:127], v3 offset:16384
  s_add_u32 s84, s61, 16384
  s_add_u32 s85, s61, 20480
  s_add_u32 s86, s61, 24576
  s_add_u32 s87, s61, 28672
  s_waitcnt lgkmcnt(10)
  v_mfma_f32_32x32x16_bf16 v[16:31], v[144:147], v[136:139], v[16:31]
  ds_read_b64_tr_b16 v[132:133], v7 offset:51200
  ds_read_b64_tr_b16 v[134:135], v7 offset:51712
  s_mov_b32 s63, -1
  s_mov_b32 s62, 0
  s_waitcnt lgkmcnt(11)
  v_mfma_f32_32x32x16_bf16 v[32:47], v[144:147], v[140:143], v[32:47]
  ds_read_b128 v[128:131], v3 offset:40960
  ds_read_b128 v[136:139], v4 offset:16384
  s_waitcnt lgkmcnt(10)
  v_mfma_f32_32x32x16_bf16 v[16:31], v[156:159], v[148:151], v[16:31]
  ds_read_b64_tr_b16 v[144:145], v7 offset:53248
  ds_read_b64_tr_b16 v[146:147], v7 offset:53760
  s_waitcnt lgkmcnt(11)
  v_mfma_f32_32x32x16_bf16 v[32:47], v[156:159], v[152:155], v[32:47]
  ds_read_b128 v[140:143], v4 offset:40960
  ds_read_b128 v[148:151], v5 offset:16384
  s_waitcnt lgkmcnt(10)
  v_mfma_f32_32x32x16_bf16 v[16:31], v[120:123], v[112:115], v[16:31]
  ds_read_b64_tr_b16 v[156:157], v7 offset:55296
  ds_read_b64_tr_b16 v[158:159], v7 offset:55808
  s_waitcnt lgkmcnt(11)
  v_mfma_f32_32x32x16_bf16 v[32:47], v[120:123], v[116:119], v[32:47]
  ds_read_b128 v[152:155], v5 offset:40960
  ds_read_b128 v[112:115], v2 offset:12288
  s_waitcnt lgkmcnt(10)
  v_mfma_f32_32x32x16_bf16 v[16:31], v[132:135], v[124:127], v[16:31]
  ds_read_b64_tr_b16 v[120:121], v7 offset:57344
  ds_read_b64_tr_b16 v[122:123], v7 offset:57856
  s_waitcnt lgkmcnt(11)
  v_mfma_f32_32x32x16_bf16 v[32:47], v[132:135], v[128:131], v[32:47]
  ds_read_b128 v[116:119], v2 offset:36864
  ds_read_b128 v[124:127], v3 offset:12288
  s_waitcnt lgkmcnt(10)
  v_mfma_f32_32x32x16_bf16 v[16:31], v[144:147], v[136:139], v[16:31]
  ds_read_b64_tr_b16 v[132:133], v7 offset:59392
  ds_read_b64_tr_b16 v[134:135], v7 offset:59904
  s_waitcnt lgkmcnt(11)
  v_mfma_f32_32x32x16_bf16 v[32:47], v[144:147], v[140:143], v[32:47]
  ds_read_b128 v[128:131], v3 offset:36864
  ds_read_b128 v[136:139], v4 offset:12288
  s_waitcnt lgkmcnt(10)
  v_mfma_f32_32x32x16_bf16 v[16:31], v[156:159], v[148:151], v[16:31]
  ds_read_b64_tr_b16 v[144:145], v7 offset:61440
  ds_read_b64_tr_b16 v[146:147], v7 offset:61952
  s_waitcnt lgkmcnt(11)
  v_mfma_f32_32x32x16_bf16 v[32:47], v[156:159], v[152:155], v[32:47]
  ds_read_b128 v[140:143], v4 offset:36864
  ds_read_b128 v[148:151], v5 offset:12288
  s_waitcnt lgkmcnt(10)
  v_mfma_f32_32x32x16_bf16 v[16:31], v[120:123], v[112:115], v[16:31]
  ds_read_b64_tr_b16 v[156:157], v7 offset:63488
  ds_read_b64_tr_b16 v[158:159], v7 offset:64000
  s_waitcnt lgkmcnt(11)
  v_mfma_f32_32x32x16_bf16 v[32:47], v[120:123], v[116:119], v[32:47]
  ds_read_b128 v[152:155], v5 offset:36864
  s_waitcnt lgkmcnt(9)
  v_mfma_f32_32x32x16_bf16 v[16:31], v[132:135], v[124:127], v[16:31]
  s_waitcnt lgkmcnt(8)
  v_mfma_f32_32x32x16_bf16 v[32:47], v[132:135], v[128:131], v[32:47]
  s_waitcnt vmcnt(1)
  s_waitcnt lgkmcnt(0)
  s_barrier
  ds_read_b128 v[112:115], v11 offset:8192
  ds_read_b64_tr_b16 v[120:121], v10 offset:0
  ds_read_b64_tr_b16 v[122:123], v10 offset:512
  ds_read_b128 v[116:119], v11 offset:12288
  v_mfma_f32_32x32x16_bf16 v[16:31], v[144:147], v[136:139], v[16:31]
  ds_read_b128 v[124:127], v12 offset:8192
  ds_read_b64_tr_b16 v[132:133], v10 offset:2048
  ds_read_b64_tr_b16 v[134:135], v10 offset:2560
  v_mfma_f32_32x32x16_bf16 v[32:47], v[144:147], v[140:143], v[32:47]
  ds_read_b128 v[128:131], v12 offset:12288
  ds_read_b128 v[136:139], v13 offset:8192
  v_mfma_f32_32x32x16_bf16 v[16:31], v[156:159], v[148:151], v[16:31]
  ds_read_b64_tr_b16 v[144:145], v10 offset:4096
  ds_read_b64_tr_b16 v[146:147], v10 offset:4608
  v_mfma_f32_32x32x16_bf16 v[32:47], v[156:159], v[152:155], v[32:47]
  ds_read_b128 v[140:143], v13 offset:12288
  ds_read_b128 v[148:151], v14 offset:8192
  s_waitcnt lgkmcnt(10)
  v_mfma_f32_32x32x16_bf16 v[16:31], v[120:123], v[112:115], v[16:31]
  ds_read_b64_tr_b16 v[156:157], v10 offset:6144
  ds_read_b64_tr_b16 v[158:159], v10 offset:6656
  s_waitcnt lgkmcnt(11)
  v_mfma_f32_32x32x16_bf16 v[32:47], v[120:123], v[116:119], v[32:47]
  ds_read_b128 v[152:155], v14 offset:12288
  ds_read_b64_tr_b16 v[120:121], v10 offset:8192
  s_waitcnt lgkmcnt(10)
  v_mfma_f32_32x32x16_bf16 v[16:31], v[132:135], v[124:127], v[16:31]
  ds_read_b64_tr_b16 v[122:123], v10 offset:8704
  v_not_b32 v170, v170
  s_waitcnt lgkmcnt(10)
  v_mfma_f32_32x32x16_bf16 v[32:47], v[132:135], v[128:131], v[32:47]
  ds_read_b64_tr_b16 v[132:133], v10 offset:10240
  ds_read_b64_tr_b16 v[134:135], v10 offset:10752
  s_waitcnt lgkmcnt(9)
  v_mfma_f32_32x32x16_bf16 v[16:31], v[144:147], v[136:139], v[16:31]
  s_waitcnt lgkmcnt(8)
  v_mfma_f32_32x32x16_bf16 v[32:47], v[144:147], v[140:143], v[32:47]
  ds_read_b64_tr_b16 v[144:145], v10 offset:12288
  ds_read_b64_tr_b16 v[146:147], v10 offset:12800
  s_waitcnt lgkmcnt(7)
  v_mfma_f32_32x32x16_bf16 v[16:31], v[156:159], v[148:151], v[16:31]
  s_waitcnt lgkmcnt(6)
  v_mfma_f32_32x32x16_bf16 v[32:47], v[156:159], v[152:155], v[32:47]
  ds_read_b64_tr_b16 v[156:157], v10 offset:14336
  ds_read_b64_tr_b16 v[158:159], v10 offset:14848
  s_waitcnt lgkmcnt(6)
  v_mfma_f32_32x32x16_bf16 v[16:31], v[120:123], v[48:51], v[16:31]
  v_mfma_f32_32x32x16_bf16 v[32:47], v[120:123], v[52:55], v[32:47]
  s_waitcnt lgkmcnt(4)
  v_mfma_f32_32x32x16_bf16 v[16:31], v[132:135], v[56:59], v[16:31]
  v_mfma_f32_32x32x16_bf16 v[32:47], v[132:135], v[60:63], v[32:47]
  s_waitcnt lgkmcnt(2)
  v_mfma_f32_32x32x16_bf16 v[16:31], v[144:147], v[64:67], v[16:31]
  v_mfma_f32_32x32x16_bf16 v[32:47], v[144:147], v[68:71], v[32:47]
  s_waitcnt lgkmcnt(0)
  v_mfma_f32_32x32x16_bf16 v[16:31], v[156:159], v[72:75], v[16:31]
  v_mfma_f32_32x32x16_bf16 v[32:47], v[156:159], v[76:79], v[32:47]
  s_setprio 2
  s_cmp_eq_u32 s74, 0
  s_cbranch_scc1 V0
  s_cmp_eq_u32 s74, 1
  s_cbranch_scc1 V1
  s_cmp_eq_u32 s74, 2
  s_cbranch_scc1 V2
  s_branch V3
L_FIN:
  s_lshl3_add_u32 s5, s2, s23
  s_cmp_lg_u32 s5, 35
  s_cbranch_scc1 K_FIN
  s_mov_b32 s7, 4000
  v_lshlrev_b32 v2, 9, v0
  s_mov_b32 s5, 10110976
NU_L:
  buffer_load_dword v160, v2, s[32:35], s5 offen offset:0 sc1
  buffer_load_dword v161, v2, s[32:35], s5 offen offset:128 sc1
  buffer_load_dword v162, v2, s[32:35], s5 offen offset:256 sc1
  buffer_load_dword v163, v2, s[32:35], s5 offen offset:384 sc1
  s_waitcnt vmcnt(0)
  v_xor_b32 v160, s52, v160
  v_xor_b32 v161, s52, v161
  v_xor_b32 v162, s52, v162
  v_xor_b32 v163, s52, v163
  v_or3_b32 v160, v160, v161, v162
  v_or_b32 v160, v160, v163
  v_cmp_ne_u32 vcc, 0, v160
  s_sub_u32 s7, s7, 1
  s_cbranch_scc1 NU_D
  s_cbranch_vccz NU_D
  s_sleep 16
  s_branch NU_L
NU_D:
  s_mov_b32 s5, 10109952
  v_lshlrev_b32 v2, 2, v8
  buffer_store_dword v253, v2, s[32:35], s5 offen sc1
  s_branch K_FIN
PE3:
.p2align 12
PG4:
M_B1:
  s_waitcnt vmcnt(0)
  v_readfirstlane_b32 s52, v253
  s_nop 3
  s_mul_i32 s52, s52, 0x915f77f5
  s_add_u32 s52, s52, 0x3c6ef39f
  v_mov_b32 v253, s52
  s_lshl_b32 s6, s3, 5
  s_add_u32 s6, s6, s4
  s_lshl_b32 s6, s6, 2
  s_add_u32 s6, s6, 10108928
  v_xor_b32 v219, s18, v253
  v_lshlrev_b32 v218, 2, v8
  s_cmp_eq_u32 s23, 0
  s_cselect_b64 exec, 1, 0
  buffer_store_dword v219, v254, s[32:35], s6 offen
  s_mov_b64 exec, -1
  s_barrier
  ds_read_b128 v[112:115], v2 offset:12288
  ds_read_b64_tr_b16 v[120:121], v6 offset:8192
  ds_read_b64_tr_b16 v[122:123], v6 offset:8704
  ds_read_b128 v[116:119], v2 offset:36864
  ds_read_b64_tr_b16 v[124:125], v6 offset:32768
  ds_read_b64_tr_b16 v[126:127], v6 offset:33280
  s_waitcnt lgkmcnt(3)
  v_mfma_f32_32x32x16_bf16 v[48:63], v[120:123], v[112:115], 0
  ds_read_b128 v[128:131], v3 offset:12288
  ds_read_b64_tr_b16 v[136:137], v6 offset:10240
  s_waitcnt lgkmcnt(4)
  v_mfma_f32_32x32x16_bf16 v[64:79], v[120:123], v[116:119], 0
  ds_read_b64_tr_b16 v[138:139], v6 offset:10752
  ds_read_b128 v[132:135], v3 offset:36864
  s_waitcnt lgkmcnt(4)
  v_mfma_f32_32x32x16_bf16 v[80:95], v[112:115], v[124:127], 0
  ds_read_b64_tr_b16 v[140:141], v6 offset:34816
  ds_read_b64_tr_b16 v[142:143], v6 offset:35328
  v_mfma_f32_32x32x16_bf16 v[96:111], v[116:119], v[124:127], 0
  ds_read_b128 v[144:147], v4 offset:12288
  ds_read_b64_tr_b16 v[152:153], v6 offset:20480
  s_waitcnt lgkmcnt(5)
  v_mfma_f32_32x32x16_bf16 v[48:63], v[136:139], v[128:131], v[48:63]
  ds_read_b64_tr_b16 v[154:155], v6 offset:20992
  ds_read_b128 v[148:151], v4 offset:36864
  s_waitcnt lgkmcnt(6)
  v_mfma_f32_32x32x16_bf16 v[64:79], v[136:139], v[132:135], v[64:79]
  ds_read_b64_tr_b16 v[156:157], v6 offset:45056
  ds_read_b64_tr_b16 v[158:159], v6 offset:45568
  s_waitcnt lgkmcnt(6)
  v_mfma_f32_32x32x16_bf16 v[80:95], v[128:131], v[140:143], v[80:95]
  ds_read_b128 v[112:115], v5 offset:12288
  ds_read_b64_tr_b16 v[120:121], v6 offset:22528
  v_mfma_f32_32x32x16_bf16 v[96:111], v[132:135], v[140:143], v[96:111]
  ds_read_b64_tr_b16 v[122:123], v6 offset:23040
  ds_read_b128 v[116:119], v5 offset:36864
  s_waitcnt lgkmcnt(7)
  v_mfma_f32_32x32x16_bf16 v[48:63], v[152:155], v[144:147], v[48:63]
  ds_read_b64_tr_b16 v[124:125], v6 offset:47104
  ds_read_b64_tr_b16 v[126:127], v6 offset:47616
  s_cmp_lg_u32 s23, 0
  s_cbranch_scc1 XT_S
  buffer_load_dword v252, v252, s[32:35], 0 offen sc1
XT_S:
  s_waitcnt lgkmcnt(8)
  v_mfma_f32_32x32x16_bf16 v[64:79], v[152:155], v[148:151], v[64:79]
  s_waitcnt lgkmcnt(6)
  v_mfma_f32_32x32x16_bf16 v[80:95], v[144:147], v[156:159], v[80:95]
  v_mfma_f32_32x32x16_bf16 v[96:111], v[148:151], v[156:159], v[96:111]
  s_waitcnt lgkmcnt(0)
  s_barrier
  ds_read_b128 v[128:131], v11 offset:8192
  ds_read_b64_tr_b16 v[136:137], v10 offset:0
  ds_read_b64_tr_b16 v[138:139], v10 offset:512
  ds_read_b128 v[132:135], v11 offset:12288
  v_mfma_f32_32x32x16_bf16 v[48:63], v[120:123], v[112:115], v[48:63]
  ds_read_b64_tr_b16 v[140:141], v10 offset:8192
  ds_read_b64_tr_b16 v[142:143], v10 offset:8704
  v_mfma_f32_32x32x16_bf16 v[64:79], v[120:123], v[116:119], v[64:79]
  ds_read_b128 v[144:147], v12 offset:8192
  ds_read_b64_tr_b16 v[152:153], v10 offset:2048
  v_mfma_f32_32x32x16_bf16 v[80:95], v[112:115], v[124:127], v[80:95]
  ds_read_b64_tr_b16 v[154:155], v10 offset:2560
  ds_read_b128 v[148:151], v12 offset:12288
  v_mfma_f32_32x32x16_bf16 v[96:111], v[116:119], v[124:127], v[96:111]
  ds_read_b64_tr_b16 v[156:157], v10 offset:10240
  ds_read_b64_tr_b16 v[158:159], v10 offset:10752
  s_waitcnt lgkmcnt(9)
  v_mfma_f32_32x32x16_bf16 v[48:63], v[136:139], v[128:131], v[48:63]
  ds_read_b128 v[112:115], v13 offset:8192
  ds_read_b64_tr_b16 v[120:121], v10 offset:4096
  s_waitcnt lgkmcnt(10)
  v_mfma_f32_32x32x16_bf16 v[64:79], v[136:139], v[132:135], v[64:79]
  ds_read_b64_tr_b16 v[122:123], v10 offset:4608
  ds_read_b128 v[116:119], v13 offset:12288
  s_waitcnt lgkmcnt(10)
  v_mfma_f32_32x32x16_bf16 v[80:95], v[128:131], v[140:143], v[80:95]
  ds_read_b64_tr_b16 v[124:125], v10 offset:12288
  ds_read_b64_tr_b16 v[126:127], v10 offset:12800
  v_mfma_f32_32x32x16_bf16 v[96:111], v[132:135], v[140:143], v[96:111]
  ds_read_b128 v[128:131], v14 offset:8192
  ds_read_b64_tr_b16 v[136:137], v10 offset:6144
  s_waitcnt lgkmcnt(11)
  v_mfma_f32_32x32x16_bf16 v[48:63], v[152:155], v[144:147], v[48:63]
  ds_read_b64_tr_b16 v[138:139], v10 offset:6656
  ds_read_b128 v[132:135], v14 offset:12288
  s_waitcnt lgkmcnt(12)
  v_mfma_f32_32x32x16_bf16 v[64:79], v[152:155], v[148:151], v[64:79]
  ds_read_b64_tr_b16 v[140:141], v10 offset:14336
  ds_read_b64_tr_b16 v[142:143], v10 offset:14848
  s_waitcnt lgkmcnt(12)
  v_mfma_f32_32x32x16_bf16 v[80:95], v[144:147], v[156:159], v[80:95]
  v_mfma_f32_32x32x16_bf16 v[96:111], v[148:151], v[156:159], v[96:111]
  s_waitcnt lgkmcnt(9)
  v_mfma_f32_32x32x16_bf16 v[48:63], v[120:123], v[112:115], v[48:63]
  s_waitcnt lgkmcnt(8)
  v_mfma_f32_32x32x16_bf16 v[64:79], v[120:123], v[116:119], v[64:79]
  s_cmp_eq_u32 s74, 0
  s_cbranch_scc1 W4
  s_cmp_eq_u32 s74, 1
  s_cbranch_scc1 W5
  s_cmp_eq_u32 s74, 2
  s_cbranch_scc1 W6
  s_branch W7
W_RET:
  s_waitcnt lgkmcnt(0)
  s_barrier
  ds_read_b128 v[144:147], v11 offset:0
  ds_read_b64_tr_b16 v[152:153], v6 offset:57344
  ds_read_b64_tr_b16 v[154:155], v6 offset:57856
  ds_read_b128 v[148:151], v11 offset:4096
  v_mfma_f32_32x32x16_bf16 v[80:95], v[112:115], v[124:127], v[80:95]
  ds_read_b64_tr_b16 v[156:157], v7 offset:16384
  ds_read_b64_tr_b16 v[158:159], v7 offset:16896
  v_mfma_f32_32x32x16_bf16 v[96:111], v[116:119], v[124:127], v[96:111]
  ds_read_b128 v[112:115], v12 offset:0
  ds_read_b64_tr_b16 v[120:121], v6 offset:59392
  v_mfma_f32_32x32x16_bf16 v[48:63], v[136:139], v[128:131], v[48:63]
  ds_read_b64_tr_b16 v[122:123], v6 offset:59904
  ds_read_b128 v[116:119], v12 offset:4096
  v_mfma_f32_32x32x16_bf16 v[64:79], v[136:139], v[132:135], v[64:79]
  ds_read_b64_tr_b16 v[124:125], v7 offset:18432
  ds_read_b64_tr_b16 v[126:127], v7 offset:18944
  v_mfma_f32_32x32x16_bf16 v[80:95], v[128:131], v[140:143], v[80:95]
  v_mfma_f32_32x32x16_bf16 v[96:111], v[132:135], v[140:143], v[96:111]
  ds_read_b128 v[128:131], v13 offset:0
  ds_read_b64_tr_b16 v[136:137], v7 offset:4096
  s_waitcnt lgkmcnt(11)
  v_mfma_f32_32x32x16_bf16 v[48:63], v[152:155], v[144:147], v[48:63]
  ds_read_b64_tr_b16 v[138:139], v7 offset:4608
  ds_read_b128 v[132:135], v13 offset:4096
  s_waitcnt lgkmcnt(12)
  v_mfma_f32_32x32x16_bf16 v[64:79], v[152:155], v[148:151], v[64:79]
  ds_read_b64_tr_b16 v[140:141], v7 offset:28672
  ds_read_b64_tr_b16 v[142:143], v7 offset:29184
  s_waitcnt lgkmcnt(12)
  v_mfma_f32_32x32x16_bf16 v[80:95], v[144:147], v[156:159], v[80:95]
  v_mfma_f32_32x32x16_bf16 v[96:111], v[148:151], v[156:159], v[96:111]
  ds_read_b128 v[144:147], v14 offset:0
  ds_read_b64_tr_b16 v[152:153], v7 offset:6144
  s_waitcnt lgkmcnt(11)
  v_mfma_f32_32x32x16_bf16 v[48:63], v[120:123], v[112:115], v[48:63]
  ds_read_b64_tr_b16 v[154:155], v7 offset:6656
  ds_read_b128 v[148:151], v14 offset:4096
  s_cmp_eq_u32 s23, 0
  s_cselect_b64 exec, -1, 0
  s_waitcnt vmcnt(0)
  s_xor_b32 s6, s52, s18
  v_cmp_ne_u32 vcc, s6, v252
  s_nop 1
  s_cmp_eq_u64 vcc, 0
  s_cselect_b32 s19, 1, 0
  v_mov_b32 v252, s19
  ds_write_b32 v254, v252 offset:12288
  s_mov_b64 exec, -1
  s_waitcnt lgkmcnt(13)
  v_mfma_f32_32x32x16_bf16 v[64:79], v[120:123], v[116:119], v[64:79]
  ds_read_b64_tr_b16 v[156:157], v7 offset:30720
  ds_read_b64_tr_b16 v[158:159], v7 offset:31232
  s_waitcnt lgkmcnt(13)
  v_mfma_f32_32x32x16_bf16 v[80:95], v[112:115], v[124:127], v[80:95]
  v_mfma_f32_32x32x16_bf16 v[96:111], v[116:119], v[124:127], v[96:111]
  s_waitcnt lgkmcnt(10)
  v_mfma_f32_32x32x16_bf16 v[48:63], v[136:139], v[128:131], v[48:63]
  s_waitcnt lgkmcnt(9)
  v_mfma_f32_32x32x16_bf16 v[64:79], v[136:139], v[132:135], v[64:79]
  s_waitcnt lgkmcnt(0)
  s_barrier
  ds_read_b128 v[112:115], v2 offset:4096
  ds_read_b64_tr_b16 v[120:121], v6 offset:8192
  ds_read_b64_tr_b16 v[122:123], v6 offset:8704
  ds_read_b128 v[116:119], v2 offset:28672
  v_mfma_f32_32x32x16_bf16 v[80:95], v[128:131], v[140:143], v[80:95]
  ds_read_b64_tr_b16 v[124:125], v6 offset:32768
  ds_read_b64_tr_b16 v[126:127], v6 offset:33280
  v_mfma_f32_32x32x16_bf16 v[96:111], v[132:135], v[140:143], v[96:111]
  ds_read_b128 v[128:131], v3 offset:4096
  ds_read_b64_tr_b16 v[136:137], v6 offset:10240
  v_mfma_f32_32x32x16_bf16 v[48:63], v[152:155], v[144:147], v[48:63]
  ds_read_b64_tr_b16 v[138:139], v6 offset:10752
  ds_read_b128 v[132:135], v3 offset:28672
  v_mfma_f32_32x32x16_bf16 v[64:79], v[152:155], v[148:151], v[64:79]
  ds_read_b64_tr_b16 v[140:141], v6 offset:34816
  ds_read_b64_tr_b16 v[142:143], v6 offset:35328
  v_mfma_f32_32x32x16_bf16 v[80:95], v[144:147], v[156:159], v[80:95]
  v_mfma_f32_32x32x16_bf16 v[96:111], v[148:151], v[156:159], v[96:111]
  ds_read_b128 v[144:147], v4 offset:4096
  ds_read_b64_tr_b16 v[152:153], v6 offset:20480
  s_waitcnt lgkmcnt(11)
  v_mfma_f32_32x32x16_bf16 v[48:63], v[120:123], v[112:115], v[48:63]
  ds_read_b64_tr_b16 v[154:155], v6 offset:20992
  ds_read_b128 v[148:151], v4 offset:28672
  s_waitcnt lgkmcnt(12)
  v_mfma_f32_32x32x16_bf16 v[64:79], v[120:123], v[116:119], v[64:79]
  ds_read_b64_tr_b16 v[156:157], v6 offset:45056
  ds_read_b64_tr_b16 v[158:159], v6 offset:45568
  s_waitcnt lgkmcnt(12)
  v_mfma_f32_32x32x16_bf16 v[80:95], v[112:115], v[124:127], v[80:95]
  v_mfma_f32_32x32x16_bf16 v[96:111], v[116:119], v[124:127], v[96:111]
  ds_read_b128 v[112:115], v5 offset:4096
  ds_read_b64_tr_b16 v[120:121], v6 offset:22528
  s_waitcnt lgkmcnt(11)
  v_mfma_f32_32x32x16_bf16 v[48:63], v[136:139], v[128:131], v[48:63]
  ds_read_b64_tr_b16 v[122:123], v6 offset:23040
  ds_read_b128 v[116:119], v5 offset:28672
  ds_read_b32 v252, v254 offset:12288
  s_waitcnt lgkmcnt(13)
  v_mfma_f32_32x32x16_bf16 v[64:79], v[136:139], v[132:135], v[64:79]
  ds_read_b64_tr_b16 v[124:125], v6 offset:47104
  ds_read_b64_tr_b16 v[126:127], v6 offset:47616
  s_waitcnt lgkmcnt(13)
  v_mfma_f32_32x32x16_bf16 v[80:95], v[128:131], v[140:143], v[80:95]
  v_mfma_f32_32x32x16_bf16 v[96:111], v[132:135], v[140:143], v[96:111]
  s_waitcnt lgkmcnt(10)
  v_mfma_f32_32x32x16_bf16 v[48:63], v[152:155], v[144:147], v[48:63]
  s_waitcnt lgkmcnt(9)
  v_mfma_f32_32x32x16_bf16 v[64:79], v[152:155], v[148:151], v[64:79]
  s_waitcnt lgkmcnt(0)
  s_barrier
  ds_read_b128 v[128:131], v2 offset:0
  ds_read_b64_tr_b16 v[136:137], v7 offset:49152
  ds_read_b64_tr_b16 v[138:139], v7 offset:49664
  ds_read_b128 v[132:135], v2 offset:24576
  v_mfma_f32_32x32x16_bf16 v[80:95], v[144:147], v[156:159], v[80:95]
  ds_read_b64_tr_b16 v[140:141], v7 offset:57344
  ds_read_b64_tr_b16 v[142:143], v7 offset:57856
  v_mfma_f32_32x32x16_bf16 v[96:111], v[148:151], v[156:159], v[96:111]
  ds_read_b128 v[144:147], v3 offset:0
  ds_read_b64_tr_b16 v[152:153], v7 offset:51200
  v_mfma_f32_32x32x16_bf16 v[48:63], v[120:123], v[112:115], v[48:63]
  ds_read_b64_tr_b16 v[154:155], v7 offset:51712
  ds_read_b128 v[148:151], v3 offset:24576
  v_mfma_f32_32x32x16_bf16 v[64:79], v[120:123], v[116:119], v[64:79]
  ds_read_b64_tr_b16 v[156:157], v7 offset:59392
  ds_read_b64_tr_b16 v[158:159], v7 offset:59904
  v_mfma_f32_32x32x16_bf16 v[80:95], v[112:115], v[124:127], v[80:95]
  v_mfma_f32_32x32x16_bf16 v[96:111], v[116:119], v[124:127], v[96:111]
  ds_read_b128 v[112:115], v4 offset:0
  ds_read_b64_tr_b16 v[120:121], v7 offset:53248
  s_waitcnt lgkmcnt(11)
  v_mfma_f32_32x32x16_bf16 v[48:63], v[136:139], v[128:131], v[48:63]
  ds_read_b64_tr_b16 v[122:123], v7 offset:53760
  ds_read_b128 v[116:119], v4 offset:24576
  s_waitcnt lgkmcnt(12)
  v_mfma_f32_32x32x16_bf16 v[64:79], v[136:139], v[132:135], v[64:79]
  ds_read_b64_tr_b16 v[124:125], v7 offset:61440
  ds_read_b64_tr_b16 v[126:127], v7 offset:61952
  s_waitcnt lgkmcnt(12)
  v_mfma_f32_32x32x16_bf16 v[80:95], v[128:131], v[140:143], v[80:95]
  v_mfma_f32_32x32x16_bf16 v[96:111], v[132:135], v[140:143], v[96:111]
  ds_read_b128 v[128:131], v5 offset:0
  ds_read_b64_tr_b16 v[136:137], v7 offset:55296
  s_waitcnt lgkmcnt(11)
  v_mfma_f32_32x32x16_bf16 v[48:63], v[152:155], v[144:147], v[48:63]
  ds_read_b64_tr_b16 v[138:139], v7 offset:55808
  ds_read_b128 v[132:135], v5 offset:24576
  v_readfirstlane_b32 s19, v252
  s_waitcnt lgkmcnt(12)
  v_mfma_f32_32x32x16_bf16 v[64:79], v[152:155], v[148:151], v[64:79]
  ds_read_b64_tr_b16 v[140:141], v7 offset:63488
  ds_read_b64_tr_b16 v[142:143], v7 offset:64000
  s_andn2_b32 s91, s19, s91
  s_waitcnt lgkmcnt(12)
  v_mfma_f32_32x32x16_bf16 v[80:95], v[144:147], v[156:159], v[80:95]
  v_mfma_f32_32x32x16_bf16 v[96:111], v[148:151], v[156:159], v[96:111]
  s_waitcnt lgkmcnt(9)
  v_mfma_f32_32x32x16_bf16 v[48:63], v[120:123], v[112:115], v[48:63]
  s_waitcnt lgkmcnt(8)
  v_mfma_f32_32x32x16_bf16 v[64:79], v[120:123], v[116:119], v[64:79]
  s_waitcnt lgkmcnt(0)
  s_barrier
  ds_read_b128 v[144:147], v2 offset:16384
  ds_read_b64_tr_b16 v[152:153], v10 offset:0
  ds_read_b64_tr_b16 v[154:155], v10 offset:512
  ds_read_b128 v[148:151], v2 offset:40960
  v_mfma_f32_32x32x16_bf16 v[80:95], v[112:115], v[124:127], v[80:95]
  ds_read_b64_tr_b16 v[156:157], v10 offset:8192
  ds_read_b64_tr_b16 v[158:159], v10 offset:8704
  v_mfma_f32_32x32x16_bf16 v[96:111], v[116:119], v[124:127], v[96:111]
  ds_read_b128 v[112:115], v3 offset:16384
  ds_read_b64_tr_b16 v[120:121], v10 offset:2048
  v_mfma_f32_32x32x16_bf16 v[48:63], v[136:139], v[128:131], v[48:63]
  ds_read_b64_tr_b16 v[122:123], v10 offset:2560
  ds_read_b128 v[116:119], v3 offset:40960
  v_mfma_f32_32x32x16_bf16 v[64:79], v[136:139], v[132:135], v[64:79]
  ds_read_b64_tr_b16 v[124:125], v10 offset:10240
  ds_read_b64_tr_b16 v[126:127], v10 offset:10752
  v_mfma_f32_32x32x16_bf16 v[80:95], v[128:131], v[140:143], v[80:95]
  v_mfma_f32_32x32x16_bf16 v[96:111], v[132:135], v[140:143], v[96:111]
  ds_read_b128 v[128:131], v4 offset:16384
  ds_read_b64_tr_b16 v[136:137], v10 offset:4096
  s_waitcnt lgkmcnt(11)
  v_mfma_f32_32x32x16_bf16 v[48:63], v[152:155], v[144:147], v[48:63]
  ds_read_b64_tr_b16 v[138:139], v10 offset:4608
  ds_read_b128 v[132:135], v4 offset:40960
  s_waitcnt lgkmcnt(12)
  v_mfma_f32_32x32x16_bf16 v[64:79], v[152:155], v[148:151], v[64:79]
  ds_read_b64_tr_b16 v[140:141], v10 offset:12288
  ds_read_b64_tr_b16 v[142:143], v10 offset:12800
  s_waitcnt lgkmcnt(12)
  v_mfma_f32_32x32x16_bf16 v[80:95], v[144:147], v[156:159], v[80:95]
  v_mfma_f32_32x32x16_bf16 v[96:111], v[148:151], v[156:159], v[96:111]
  ds_read_b128 v[144:147], v5 offset:16384
  ds_read_b64_tr_b16 v[152:153], v10 offset:6144
  s_waitcnt lgkmcnt(11)
  v_mfma_f32_32x32x16_bf16 v[48:63], v[120:123], v[112:115], v[48:63]
  ds_read_b64_tr_b16 v[154:155], v10 offset:6656
  ds_read_b128 v[148:151], v5 offset:40960
  s_waitcnt lgkmcnt(12)
  v_mfma_f32_32x32x16_bf16 v[64:79], v[120:123], v[116:119], v[64:79]
  ds_read_b64_tr_b16 v[156:157], v10 offset:14336
  ds_read_b64_tr_b16 v[158:159], v10 offset:14848
  s_waitcnt lgkmcnt(12)
  v_mfma_f32_32x32x16_bf16 v[80:95], v[112:115], v[124:127], v[80:95]
  v_mfma_f32_32x32x16_bf16 v[96:111], v[116:119], v[124:127], v[96:111]
  s_waitcnt lgkmcnt(9)
  v_mfma_f32_32x32x16_bf16 v[48:63], v[136:139], v[128:131], v[48:63]
  s_waitcnt lgkmcnt(8)
  v_mfma_f32_32x32x16_bf16 v[64:79], v[136:139], v[132:135], v[64:79]
  s_waitcnt lgkmcnt(0)
  s_barrier
  ds_read_b128 v[112:115], v2 offset:12288
  ds_read_b64_tr_b16 v[120:121], v6 offset:57344
  ds_read_b64_tr_b16 v[122:123], v6 offset:57856
  ds_read_b128 v[116:119], v2 offset:36864
  v_mfma_f32_32x32x16_bf16 v[80:95], v[128:131], v[140:143], v[80:95]
  ds_read_b64_tr_b16 v[124:125], v7 offset:16384
  ds_read_b64_tr_b16 v[126:127], v7 offset:16896
  v_mfma_f32_32x32x16_bf16 v[96:111], v[132:135], v[140:143], v[96:111]
  ds_read_b128 v[128:131], v3 offset:12288
  ds_read_b64_tr_b16 v[136:137], v6 offset:59392
  v_mfma_f32_32x32x16_bf16 v[48:63], v[152:155], v[144:147], v[48:63]
  ds_read_b64_tr_b16 v[138:139], v6 offset:59904
  ds_read_b128 v[132:135], v3 offset:36864
  v_mfma_f32_32x32x16_bf16 v[64:79], v[152:155], v[148:151], v[64:79]
  ds_read_b64_tr_b16 v[140:141], v7 offset:18432
  ds_read_b64_tr_b16 v[142:143], v7 offset:18944
  v_mfma_f32_32x32x16_bf16 v[80:95], v[144:147], v[156:159], v[80:95]
  v_mfma_f32_32x32x16_bf16 v[96:111], v[148:151], v[156:159], v[96:111]
  ds_read_b128 v[144:147], v4 offset:12288
  ds_read_b64_tr_b16 v[152:153], v7 offset:4096
  s_waitcnt lgkmcnt(11)
  v_mfma_f32_32x32x16_bf16 v[48:63], v[120:123], v[112:115], v[48:63]
  ds_read_b64_tr_b16 v[154:155], v7 offset:4608
  ds_read_b128 v[148:151], v4 offset:36864
  s_waitcnt lgkmcnt(12)
  v_mfma_f32_32x32x16_bf16 v[64:79], v[120:123], v[116:119], v[64:79]
  ds_read_b64_tr_b16 v[156:157], v7 offset:28672
  ds_read_b64_tr_b16 v[158:159], v7 offset:29184
  s_waitcnt lgkmcnt(12)
  v_mfma_f32_32x32x16_bf16 v[80:95], v[112:115], v[124:127], v[80:95]
  v_mfma_f32_32x32x16_bf16 v[96:111], v[116:119], v[124:127], v[96:111]
  ds_read_b128 v[112:115], v5 offset:12288
  ds_read_b64_tr_b16 v[120:121], v7 offset:6144
  s_waitcnt lgkmcnt(11)
  v_mfma_f32_32x32x16_bf16 v[48:63], v[136:139], v[128:131], v[48:63]
  ds_read_b64_tr_b16 v[122:123], v7 offset:6656
  ds_read_b128 v[116:119], v5 offset:36864
  s_waitcnt lgkmcnt(12)
  v_mfma_f32_32x32x16_bf16 v[64:79], v[136:139], v[132:135], v[64:79]
  ds_read_b64_tr_b16 v[124:125], v7 offset:30720
  ds_read_b64_tr_b16 v[126:127], v7 offset:31232
  s_waitcnt lgkmcnt(12)
  v_mfma_f32_32x32x16_bf16 v[80:95], v[128:131], v[140:143], v[80:95]
  v_mfma_f32_32x32x16_bf16 v[96:111], v[132:135], v[140:143], v[96:111]
  s_waitcnt lgkmcnt(9)
  v_mfma_f32_32x32x16_bf16 v[48:63], v[152:155], v[144:147], v[48:63]
  s_waitcnt lgkmcnt(8)
  v_mfma_f32_32x32x16_bf16 v[64:79], v[152:155], v[148:151], v[64:79]
  s_waitcnt lgkmcnt(0)
  s_barrier
  ds_read_b128 v[128:131], v11 offset:8192
  ds_read_b64_tr_b16 v[136:137], v6 offset:8192
  ds_read_b64_tr_b16 v[138:139], v6 offset:8704
  ds_read_b128 v[132:135], v11 offset:12288
  v_mfma_f32_32x32x16_bf16 v[80:95], v[144:147], v[156:159], v[80:95]
  ds_read_b64_tr_b16 v[140:141], v6 offset:32768
  ds_read_b64_tr_b16 v[142:143], v6 offset:33280
  v_mfma_f32_32x32x16_bf16 v[96:111], v[148:151], v[156:159], v[96:111]
  ds_read_b128 v[144:147], v12 offset:8192
  ds_read_b64_tr_b16 v[152:153], v6 offset:10240
  v_mfma_f32_32x32x16_bf16 v[48:63], v[120:123], v[112:115], v[48:63]
  ds_read_b64_tr_b16 v[154:155], v6 offset:10752
  ds_read_b128 v[148:151], v12 offset:12288
  v_mfma_f32_32x32x16_bf16 v[64:79], v[120:123], v[116:119], v[64:79]
  ds_read_b64_tr_b16 v[156:157], v6 offset:34816
  ds_read_b64_tr_b16 v[158:159], v6 offset:35328
  v_mfma_f32_32x32x16_bf16 v[80:95], v[112:115], v[124:127], v[80:95]
  v_mfma_f32_32x32x16_bf16 v[96:111], v[116:119], v[124:127], v[96:111]
  ds_read_b128 v[112:115], v13 offset:8192
  ds_read_b64_tr_b16 v[120:121], v6 offset:20480
  s_waitcnt lgkmcnt(11)
  v_mfma_f32_32x32x16_bf16 v[48:63], v[136:139], v[128:131], v[48:63]
  ds_read_b64_tr_b16 v[122:123], v6 offset:20992
  ds_read_b128 v[116:119], v13 offset:12288
  s_waitcnt lgkmcnt(12)
  v_mfma_f32_32x32x16_bf16 v[64:79], v[136:139], v[132:135], v[64:79]
  ds_read_b64_tr_b16 v[124:125], v6 offset:45056
  ds_read_b64_tr_b16 v[126:127], v6 offset:45568
  s_waitcnt lgkmcnt(12)
  v_mfma_f32_32x32x16_bf16 v[80:95], v[128:131], v[140:143], v[80:95]
  v_mfma_f32_32x32x16_bf16 v[96:111], v[132:135], v[140:143], v[96:111]
  ds_read_b128 v[128:131], v14 offset:8192
  ds_read_b64_tr_b16 v[136:137], v6 offset:22528
  s_waitcnt lgkmcnt(11)
  v_mfma_f32_32x32x16_bf16 v[48:63], v[152:155], v[144:147], v[48:63]
  ds_read_b64_tr_b16 v[138:139], v6 offset:23040
  ds_read_b128 v[132:135], v14 offset:12288
  s_waitcnt lgkmcnt(12)
  v_mfma_f32_32x32x16_bf16 v[64:79], v[152:155], v[148:151], v[64:79]
  ds_read_b64_tr_b16 v[140:141], v6 offset:47104
  ds_read_b64_tr_b16 v[142:143], v6 offset:47616
  s_waitcnt lgkmcnt(12)
  v_mfma_f32_32x32x16_bf16 v[80:95], v[144:147], v[156:159], v[80:95]
  v_mfma_f32_32x32x16_bf16 v[96:111], v[148:151], v[156:159], v[96:111]
  s_waitcnt lgkmcnt(0)
  s_barrier
  v_mfma_f32_32x32x16_bf16 v[48:63], v[120:123], v[112:115], v[48:63]
  v_mfma_f32_32x32x16_bf16 v[64:79], v[120:123], v[116:119], v[64:79]
  v_mfma_f32_32x32x16_bf16 v[80:95], v[112:115], v[124:127], v[80:95]
  v_mfma_f32_32x32x16_bf16 v[96:111], v[116:119], v[124:127], v[96:111]
  v_mfma_f32_32x32x16_bf16 v[48:63], v[136:139], v[128:131], v[48:63]
  v_mfma_f32_32x32x16_bf16 v[64:79], v[136:139], v[132:135], v[64:79]
  v_mfma_f32_32x32x16_bf16 v[80:95], v[128:131], v[140:143], v[80:95]
  v_mfma_f32_32x32x16_bf16 v[96:111], v[132:135], v[140:143], v[96:111]
  s_cmp_lg_u32 s91, 0
  s_cbranch_scc1 M_BL
  ds_read_b32 v28, v20
  v_cvt_pk_bf16_f32 v48, v48, v49
  v_cvt_pk_bf16_f32 v49, v50, v51
  v_cvt_pk_bf16_f32 v50, v52, v53
  v_cvt_pk_bf16_f32 v51, v54, v55
  buffer_store_dwordx4 v[48:51], v1, s[68:71], s84 offen sc1
  ds_write_b128 v168, v[48:51] offset:0
  v_cvt_pk_bf16_f32 v56, v56, v57
  v_cvt_pk_bf16_f32 v57, v58, v59
  v_cvt_pk_bf16_f32 v58, v60, v61
  v_cvt_pk_bf16_f32 v59, v62, v63
  buffer_store_dwordx4 v[56:59], v1, s[68:71], s85 offen sc1
  ds_write_b128 v168, v[56:59] offset:12288
  v_cvt_pk_bf16_f32 v64, v64, v65
  v_cvt_pk_bf16_f32 v65, v66, v67
  v_cvt_pk_bf16_f32 v66, v68, v69
  v_cvt_pk_bf16_f32 v67, v70, v71
  buffer_store_dwordx4 v[64:67], v1, s[68:71], s86 offen sc1
  ds_write_b128 v17, v[64:67] offset:0
  v_cvt_pk_bf16_f32 v72, v72, v73
  v_cvt_pk_bf16_f32 v73, v74, v75
  v_cvt_pk_bf16_f32 v74, v76, v77
  v_cvt_pk_bf16_f32 v75, v78, v79
  buffer_store_dwordx4 v[72:75], v1, s[68:71], s87 offen sc1
  ds_write_b128 v17, v[72:75] offset:12288
  v_cvt_pk_bf16_f32 v80, v80, v81
  v_cvt_pk_bf16_f32 v81, v82, v83
  v_cvt_pk_bf16_f32 v82, v84, v85
  v_cvt_pk_bf16_f32 v83, v86, v87
  buffer_store_dwordx4 v[80:83], v16, s[68:71], s88 offen offset:0 sc1
  ds_write_b128 v169, v[80:83] offset:0
  v_cvt_pk_bf16_f32 v88, v88, v89
  v_cvt_pk_bf16_f32 v89, v90, v91
  v_cvt_pk_bf16_f32 v90, v92, v93
  v_cvt_pk_bf16_f32 v91, v94, v95
  buffer_store_dwordx4 v[88:91], v16, s[68:71], s88 offen offset:512 sc1
  ds_write_b128 v169, v[88:91] offset:512
  v_cvt_pk_bf16_f32 v96, v96, v97
  v_cvt_pk_bf16_f32 v97, v98, v99
  v_cvt_pk_bf16_f32 v98, v100, v101
  v_cvt_pk_bf16_f32 v99, v102, v103
  buffer_store_dwordx4 v[96:99], v16, s[68:71], s90 offen offset:0 sc1
  ds_write_b128 v18, v[96:99] offset:0
  v_cvt_pk_bf16_f32 v104, v104, v105
  v_cvt_pk_bf16_f32 v105, v106, v107
  v_cvt_pk_bf16_f32 v106, v108, v109
  v_cvt_pk_bf16_f32 v107, v110, v111
  buffer_store_dwordx4 v[104:107], v16, s[68:71], s90 offen offset:512 sc1
  ds_write_b128 v18, v[104:107] offset:512
  s_waitcnt lgkmcnt(0)
  s_barrier
  s_waitcnt vmcnt(0)
  buffer_store_dword v253, v218, s[32:35], s89 offen sc1
  s_branch M_BJ
M_BL:
  ds_read_b32 v28, v20
  v_cvt_pk_bf16_f32 v48, v48, v49
  v_cvt_pk_bf16_f32 v49, v50, v51
  v_cvt_pk_bf16_f32 v50, v52, v53
  v_cvt_pk_bf16_f32 v51, v54, v55
  ds_write_b128 v168, v[48:51] offset:0
  v_cvt_pk_bf16_f32 v56, v56, v57
  v_cvt_pk_bf16_f32 v57, v58, v59
  v_cvt_pk_bf16_f32 v58, v60, v61
  v_cvt_pk_bf16_f32 v59, v62, v63
  ds_write_b128 v168, v[56:59] offset:12288
  v_cvt_pk_bf16_f32 v64, v64, v65
  v_cvt_pk_bf16_f32 v65, v66, v67
  v_cvt_pk_bf16_f32 v66, v68, v69
  v_cvt_pk_bf16_f32 v67, v70, v71
  ds_write_b128 v17, v[64:67] offset:0
  v_cvt_pk_bf16_f32 v72, v72, v73
  v_cvt_pk_bf16_f32 v73, v74, v75
  v_cvt_pk_bf16_f32 v74, v76, v77
  v_cvt_pk_bf16_f32 v75, v78, v79
  ds_write_b128 v17, v[72:75] offset:12288
  v_cvt_pk_bf16_f32 v80, v80, v81
  v_cvt_pk_bf16_f32 v81, v82, v83
  v_cvt_pk_bf16_f32 v82, v84, v85
  v_cvt_pk_bf16_f32 v83, v86, v87
  ds_write_b128 v169, v[80:83] offset:0
  v_cvt_pk_bf16_f32 v88, v88, v89
  v_cvt_pk_bf16_f32 v89, v90, v91
  v_cvt_pk_bf16_f32 v90, v92, v93
  v_cvt_pk_bf16_f32 v91, v94, v95
  ds_write_b128 v169, v[88:91] offset:512
  v_cvt_pk_bf16_f32 v96, v96, v97
  v_cvt_pk_bf16_f32 v97, v98, v99
  v_cvt_pk_bf16_f32 v98, v100, v101
  v_cvt_pk_bf16_f32 v99, v102, v103
  ds_write_b128 v18, v[96:99] offset:0
  v_cvt_pk_bf16_f32 v104, v104, v105
  v_cvt_pk_bf16_f32 v105, v106, v107
  v_cvt_pk_bf16_f32 v106, v108, v109
  v_cvt_pk_bf16_f32 v107, v110, v111
  ds_write_b128 v18, v[104:107] offset:512
  buffer_store_dwordx4 v[48:51], v1, s[68:71], s84 offen
  buffer_store_dwordx4 v[56:59], v1, s[68:71], s85 offen
  buffer_store_dwordx4 v[64:67], v1, s[68:71], s86 offen
  buffer_store_dwordx4 v[72:75], v1, s[68:71], s87 offen
  buffer_store_dwordx4 v[80:83], v16, s[68:71], s88 offen offset:0
  buffer_store_dwordx4 v[88:91], v16, s[68:71], s88 offen offset:512
  buffer_store_dwordx4 v[96:99], v16, s[68:71], s90 offen offset:0
  buffer_store_dwordx4 v[104:107], v16, s[68:71], s90 offen offset:512
  s_waitcnt lgkmcnt(0)
  s_barrier
  s_waitcnt vmcnt(0)
  buffer_store_dword v253, v218, s[32:35], s89 offen
  s_branch M_BJ
PE4:
.p2align 12
PG5:
M_A1:
  s_waitcnt vmcnt(0)
  v_readfirstlane_b32 s52, v253
  s_nop 3
  s_mul_i32 s52, s52, 0x915f77f5
  s_add_u32 s52, s52, 0x3c6ef39f
  v_mov_b32 v253, s52
  s_lshl_b32 s6, s3, 5
  s_add_u32 s6, s6, s4
  s_lshl_b32 s6, s6, 2
  s_add_u32 s6, s6, 10108928
  v_xor_b32 v219, s18, v253
  v_lshlrev_b32 v218, 2, v8
  s_cmp_eq_u32 s23, 0
  s_cselect_b64 exec, 1, 0
  buffer_store_dword v219, v254, s[32:35], s6 offen
  s_mov_b64 exec, -1
  s_barrier
  buffer_load_dwordx4 v[176:179], v176, s[36:39], 0 offen
  ds_read_b128 v[112:115], v2 offset:12288
  ds_read_b64_tr_b16 v[120:121], v7 offset:49152
  ds_read_b64_tr_b16 v[122:123], v7 offset:49664
  ds_read_b128 v[116:119], v2 offset:36864
  ds_read_b64_tr_b16 v[124:125], v7 offset:57344
  ds_read_b64_tr_b16 v[126:127], v7 offset:57856
  s_waitcnt lgkmcnt(3)
  v_mfma_f32_32x32x16_bf16 v[48:63], v[120:123], v[112:115], 0
  ds_read_b128 v[128:131], v3 offset:12288
  ds_read_b64_tr_b16 v[136:137], v7 offset:51200
  s_waitcnt lgkmcnt(4)
  v_mfma_f32_32x32x16_bf16 v[64:79], v[120:123], v[116:119], 0
  ds_read_b64_tr_b16 v[138:139], v7 offset:51712
  ds_read_b128 v[132:135], v3 offset:36864
  s_waitcnt lgkmcnt(4)
  v_mfma_f32_32x32x16_bf16 v[80:95], v[112:115], v[124:127], 0
  ds_read_b64_tr_b16 v[140:141], v7 offset:59392
  ds_read_b64_tr_b16 v[142:143], v7 offset:59904
  v_mfma_f32_32x32x16_bf16 v[96:111], v[116:119], v[124:127], 0
  ds_read_b128 v[144:147], v4 offset:12288
  ds_read_b64_tr_b16 v[152:153], v7 offset:53248
  s_waitcnt lgkmcnt(5)
  v_mfma_f32_32x32x16_bf16 v[48:63], v[136:139], v[128:131], v[48:63]
  ds_read_b64_tr_b16 v[154:155], v7 offset:53760
  ds_read_b128 v[148:151], v4 offset:36864
  s_waitcnt lgkmcnt(6)
  v_mfma_f32_32x32x16_bf16 v[64:79], v[136:139], v[132:135], v[64:79]
  ds_read_b64_tr_b16 v[156:157], v7 offset:61440
  ds_read_b64_tr_b16 v[158:159], v7 offset:61952
  s_waitcnt lgkmcnt(6)
  v_mfma_f32_32x32x16_bf16 v[80:95], v[128:131], v[140:143], v[80:95]
  ds_read_b128 v[112:115], v5 offset:12288
  ds_read_b64_tr_b16 v[120:121], v7 offset:55296
  v_mfma_f32_32x32x16_bf16 v[96:111], v[132:135], v[140:143], v[96:111]
  ds_read_b64_tr_b16 v[122:123], v7 offset:55808
  ds_read_b128 v[116:119], v5 offset:36864
  s_waitcnt lgkmcnt(7)
  v_mfma_f32_32x32x16_bf16 v[48:63], v[152:155], v[144:147], v[48:63]
  ds_read_b64_tr_b16 v[124:125], v7 offset:63488
  ds_read_b64_tr_b16 v[126:127], v7 offset:64000
  s_waitcnt lgkmcnt(8)
  v_mfma_f32_32x32x16_bf16 v[64:79], v[152:155], v[148:151], v[64:79]
  s_waitcnt lgkmcnt(6)
  v_mfma_f32_32x32x16_bf16 v[80:95], v[144:147], v[156:159], v[80:95]
  v_mfma_f32_32x32x16_bf16 v[96:111], v[148:151], v[156:159], v[96:111]
  s_waitcnt lgkmcnt(0)
  s_barrier
  ds_read_b128 v[128:131], v11 offset:8192
  ds_read_b64_tr_b16 v[136:137], v6 offset:57344
  ds_read_b64_tr_b16 v[138:139], v6 offset:57856
  ds_read_b128 v[132:135], v11 offset:12288
  v_mfma_f32_32x32x16_bf16 v[48:63], v[120:123], v[112:115], v[48:63]
  ds_read_b64_tr_b16 v[140:141], v7 offset:16384
  ds_read_b64_tr_b16 v[142:143], v7 offset:16896
  v_mfma_f32_32x32x16_bf16 v[64:79], v[120:123], v[116:119], v[64:79]
  ds_read_b128 v[144:147], v12 offset:8192
  ds_read_b64_tr_b16 v[152:153], v6 offset:59392
  v_mfma_f32_32x32x16_bf16 v[80:95], v[112:115], v[124:127], v[80:95]
  ds_read_b64_tr_b16 v[154:155], v6 offset:59904
  ds_read_b128 v[148:151], v12 offset:12288
  v_mfma_f32_32x32x16_bf16 v[96:111], v[116:119], v[124:127], v[96:111]
  ds_read_b64_tr_b16 v[156:157], v7 offset:18432
  ds_read_b64_tr_b16 v[158:159], v7 offset:18944
  s_waitcnt lgkmcnt(9)
  v_mfma_f32_32x32x16_bf16 v[48:63], v[136:139], v[128:131], v[48:63]
  ds_read_b128 v[112:115], v13 offset:8192
  ds_read_b64_tr_b16 v[120:121], v7 offset:4096
  s_waitcnt lgkmcnt(10)
  v_mfma_f32_32x32x16_bf16 v[64:79], v[136:139], v[132:135], v[64:79]
  ds_read_b64_tr_b16 v[122:123], v7 offset:4608
  ds_read_b128 v[116:119], v13 offset:12288
  s_waitcnt lgkmcnt(10)
  v_mfma_f32_32x32x16_bf16 v[80:95], v[128:131], v[140:143], v[80:95]
  ds_read_b64_tr_b16 v[124:125], v7 offset:28672
  ds_read_b64_tr_b16 v[126:127], v7 offset:29184
  v_mfma_f32_32x32x16_bf16 v[96:111], v[132:135], v[140:143], v[96:111]
  ds_read_b128 v[128:131], v14 offset:8192
  ds_read_b64_tr_b16 v[136:137], v7 offset:6144
  s_waitcnt lgkmcnt(11)
  v_mfma_f32_32x32x16_bf16 v[48:63], v[152:155], v[144:147], v[48:63]
  ds_read_b64_tr_b16 v[138:139], v7 offset:6656
  ds_read_b128 v[132:135], v14 offset:12288
  s_waitcnt lgkmcnt(12)
  v_mfma_f32_32x32x16_bf16 v[64:79], v[152:155], v[148:151], v[64:79]
  ds_read_b64_tr_b16 v[140:141], v7 offset:30720
  ds_read_b64_tr_b16 v[142:143], v7 offset:31232
  s_waitcnt lgkmcnt(12)
  v_mfma_f32_32x32x16_bf16 v[80:95], v[144:147], v[156:159], v[80:95]
  v_mfma_f32_32x32x16_bf16 v[96:111], v[148:151], v[156:159], v[96:111]
  s_waitcnt lgkmcnt(9)
  v_mfma_f32_32x32x16_bf16 v[48:63], v[120:123], v[112:115], v[48:63]
  s_waitcnt lgkmcnt(8)
  v_mfma_f32_32x32x16_bf16 v[64:79], v[120:123], v[116:119], v[64:79]
  s_branch WA
WA_RET:
  s_waitcnt lgkmcnt(0)
  s_barrier
  ds_read_b128 v[144:147], v11 offset:0
  ds_read_b64_tr_b16 v[152:153], v10 offset:0
  ds_read_b64_tr_b16 v[154:155], v10 offset:512
  ds_read_b128 v[148:151], v11 offset:4096
  v_mfma_f32_32x32x16_bf16 v[80:95], v[112:115], v[124:127], v[80:95]
  ds_read_b64_tr_b16 v[156:157], v10 offset:8192
  ds_read_b64_tr_b16 v[158:159], v10 offset:8704
  v_mfma_f32_32x32x16_bf16 v[96:111], v[116:119], v[124:127], v[96:111]
  ds_read_b128 v[112:115], v12 offset:0
  ds_read_b64_tr_b16 v[120:121], v10 offset:2048
  v_mfma_f32_32x32x16_bf16 v[48:63], v[136:139], v[128:131], v[48:63]
  ds_read_b64_tr_b16 v[122:123], v10 offset:2560
  ds_read_b128 v[116:119], v12 offset:4096
  v_mfma_f32_32x32x16_bf16 v[64:79], v[136:139], v[132:135], v[64:79]
  ds_read_b64_tr_b16 v[124:125], v10 offset:10240
  ds_read_b64_tr_b16 v[126:127], v10 offset:10752
  v_mfma_f32_32x32x16_bf16 v[80:95], v[128:131], v[140:143], v[80:95]
  v_mfma_f32_32x32x16_bf16 v[96:111], v[132:135], v[140:143], v[96:111]
  ds_read_b128 v[128:131], v13 offset:0
  ds_read_b64_tr_b16 v[136:137], v10 offset:4096
  s_waitcnt lgkmcnt(11)
  v_mfma_f32_32x32x16_bf16 v[48:63], v[152:155], v[144:147], v[48:63]
  ds_read_b64_tr_b16 v[138:139], v10 offset:4608
  ds_read_b128 v[132:135], v13 offset:4096
  s_waitcnt lgkmcnt(12)
  v_mfma_f32_32x32x16_bf16 v[64:79], v[152:155], v[148:151], v[64:79]
  ds_read_b64_tr_b16 v[140:141], v10 offset:12288
  ds_read_b64_tr_b16 v[142:143], v10 offset:12800
  s_waitcnt lgkmcnt(12)
  v_mfma_f32_32x32x16_bf16 v[80:95], v[144:147], v[156:159], v[80:95]
  v_mfma_f32_32x32x16_bf16 v[96:111], v[148:151], v[156:159], v[96:111]
  ds_read_b128 v[144:147], v14 offset:0
  ds_read_b64_tr_b16 v[152:153], v10 offset:6144
  s_waitcnt lgkmcnt(11)
  v_mfma_f32_32x32x16_bf16 v[48:63], v[120:123], v[112:115], v[48:63]
  ds_read_b64_tr_b16 v[154:155], v10 offset:6656
  ds_read_b128 v[148:151], v14 offset:4096
  s_waitcnt vmcnt(0)
  v_mfma_f32_32x32x16_bf16 v[220:235], v[176:179], v[180:183], 0
  s_waitcnt lgkmcnt(12)
  v_mfma_f32_32x32x16_bf16 v[64:79], v[120:123], v[116:119], v[64:79]
  ds_read_b64_tr_b16 v[156:157], v10 offset:14336
  ds_read_b64_tr_b16 v[158:159], v10 offset:14848
  s_waitcnt lgkmcnt(12)
  v_mfma_f32_32x32x16_bf16 v[80:95], v[112:115], v[124:127], v[80:95]
  v_mfma_f32_32x32x16_bf16 v[96:111], v[116:119], v[124:127], v[96:111]
  s_waitcnt lgkmcnt(9)
  v_mfma_f32_32x32x16_bf16 v[48:63], v[136:139], v[128:131], v[48:63]
  v_mul_f32 v220, s56, v220
  v_mul_f32 v221, s56, v221
  v_mul_f32 v222, s56, v222
  v_mul_f32 v223, s56, v223
  s_waitcnt lgkmcnt(8)
  v_mfma_f32_32x32x16_bf16 v[64:79], v[136:139], v[132:135], v[64:79]
  s_waitcnt lgkmcnt(0)
  s_barrier
  ds_read_b128 v[112:115], v2 offset:4096
  ds_read_b64_tr_b16 v[120:121], v7 offset:49152
  ds_read_b64_tr_b16 v[122:123], v7 offset:49664
  ds_read_b128 v[116:119], v2 offset:28672
  v_mul_f32 v224, s56, v224
  v_mul_f32 v225, s56, v225
  v_mul_f32 v226, s56, v226
  v_mul_f32 v227, s56, v227
  v_mfma_f32_32x32x16_bf16 v[80:95], v[128:131], v[140:143], v[80:95]
  ds_read_b64_tr_b16 v[124:125], v7 offset:57344
  ds_read_b64_tr_b16 v[126:127], v7 offset:57856
  v_mul_f32 v228, s56, v228
  v_mul_f32 v229, s56, v229
  v_mul_f32 v230, s56, v230
  v_mul_f32 v231, s56, v231
  v_mfma_f32_32x32x16_bf16 v[96:111], v[132:135], v[140:143], v[96:111]
  ds_read_b128 v[128:131], v3 offset:4096
  ds_read_b64_tr_b16 v[136:137], v7 offset:51200
  v_mul_f32 v232, s56, v232
  v_mul_f32 v233, s56, v233
  v_mul_f32 v234, s56, v234
  v_mul_f32 v235, s56, v235
  v_mfma_f32_32x32x16_bf16 v[48:63], v[152:155], v[144:147], v[48:63]
  ds_read_b64_tr_b16 v[138:139], v7 offset:51712
  ds_read_b128 v[132:135], v3 offset:28672
  v_cvt_pk_bf16_f32 v236, v220, v221
  v_cvt_pk_bf16_f32 v237, v222, v223
  v_cvt_pk_bf16_f32 v238, v224, v225
  v_cvt_pk_bf16_f32 v239, v226, v227
  v_mfma_f32_32x32x16_bf16 v[64:79], v[152:155], v[148:151], v[64:79]
  ds_read_b64_tr_b16 v[140:141], v7 offset:59392
  ds_read_b64_tr_b16 v[142:143], v7 offset:59904
  v_cvt_pk_bf16_f32 v240, v228, v229
  v_cvt_pk_bf16_f32 v241, v230, v231
  v_cvt_pk_bf16_f32 v242, v232, v233
  v_cvt_pk_bf16_f32 v243, v234, v235
  v_mfma_f32_32x32x16_bf16 v[80:95], v[144:147], v[156:159], v[80:95]
  v_lshlrev_b32 v15, 16, v236
  v_sub_f32 v220, v220, v15
  v_and_b32 v15, 0xffff0000, v236
  v_sub_f32 v221, v221, v15
  v_mfma_f32_32x32x16_bf16 v[96:111], v[148:151], v[156:159], v[96:111]
  ds_read_b128 v[144:147], v4 offset:4096
  ds_read_b64_tr_b16 v[152:153], v7 offset:53248
  v_lshlrev_b32 v15, 16, v237
  v_sub_f32 v222, v222, v15
  v_and_b32 v15, 0xffff0000, v237
  v_sub_f32 v223, v223, v15
  s_waitcnt lgkmcnt(11)
  v_mfma_f32_32x32x16_bf16 v[48:63], v[120:123], v[112:115], v[48:63]
  ds_read_b64_tr_b16 v[154:155], v7 offset:53760
  ds_read_b128 v[148:151], v4 offset:28672
  v_lshlrev_b32 v15, 16, v238
  v_sub_f32 v224, v224, v15
  v_and_b32 v15, 0xffff0000, v238
  v_sub_f32 v225, v225, v15
  s_waitcnt lgkmcnt(12)
  v_mfma_f32_32x32x16_bf16 v[64:79], v[120:123], v[116:119], v[64:79]
  ds_read_b64_tr_b16 v[156:157], v7 offset:61440
  ds_read_b64_tr_b16 v[158:159], v7 offset:61952
  v_lshlrev_b32 v15, 16, v239
  v_sub_f32 v226, v226, v15
  v_and_b32 v15, 0xffff0000, v239
  v_sub_f32 v227, v227, v15
  s_waitcnt lgkmcnt(12)
  v_mfma_f32_32x32x16_bf16 v[80:95], v[112:115], v[124:127], v[80:95]
  v_lshlrev_b32 v15, 16, v240
  v_sub_f32 v228, v228, v15
  v_and_b32 v15, 0xffff0000, v240
  v_sub_f32 v229, v229, v15
  v_mfma_f32_32x32x16_bf16 v[96:111], v[116:119], v[124:127], v[96:111]
  ds_read_b128 v[112:115], v5 offset:4096
  ds_read_b64_tr_b16 v[120:121], v7 offset:55296
  v_lshlrev_b32 v15, 16, v241
  v_sub_f32 v230, v230, v15
  v_and_b32 v15, 0xffff0000, v241
  v_sub_f32 v231, v231, v15
  s_waitcnt lgkmcnt(11)
  v_mfma_f32_32x32x16_bf16 v[48:63], v[136:139], v[128:131], v[48:63]
  ds_read_b64_tr_b16 v[122:123], v7 offset:55808
  ds_read_b128 v[116:119], v5 offset:28672
  v_lshlrev_b32 v15, 16, v242
  v_sub_f32 v232, v232, v15
  v_and_b32 v15, 0xffff0000, v242
  v_sub_f32 v233, v233, v15
  s_waitcnt lgkmcnt(12)
  v_mfma_f32_32x32x16_bf16 v[64:79], v[136:139], v[132:135], v[64:79]
  ds_read_b64_tr_b16 v[124:125], v7 offset:63488
  ds_read_b64_tr_b16 v[126:127], v7 offset:64000
  v_lshlrev_b32 v15, 16, v243
  v_sub_f32 v234, v234, v15
  v_and_b32 v15, 0xffff0000, v243
  v_sub_f32 v235, v235, v15
  s_waitcnt lgkmcnt(12)
  v_mfma_f32_32x32x16_bf16 v[80:95], v[128:131], v[140:143], v[80:95]
  v_cvt_pk_bf16_f32 v244, v220, v221
  v_cvt_pk_bf16_f32 v245, v222, v223
  v_cvt_pk_bf16_f32 v246, v224, v225
  v_cvt_pk_bf16_f32 v247, v226, v227
  v_mfma_f32_32x32x16_bf16 v[96:111], v[132:135], v[140:143], v[96:111]
  v_cvt_pk_bf16_f32 v248, v228, v229
  v_cvt_pk_bf16_f32 v249, v230, v231
  v_cvt_pk_bf16_f32 v250, v232, v233
  v_cvt_pk_bf16_f32 v251, v234, v235
  s_waitcnt lgkmcnt(9)
  v_mfma_f32_32x32x16_bf16 v[48:63], v[152:155], v[144:147], v[48:63]
  s_waitcnt lgkmcnt(8)
  v_mfma_f32_32x32x16_bf16 v[64:79], v[152:155], v[148:151], v[64:79]
  s_waitcnt lgkmcnt(0)
  s_barrier
  ds_read_b128 v[128:131], v2 offset:0
  ds_read_b64_tr_b16 v[136:137], v6 offset:8192
  ds_read_b64_tr_b16 v[138:139], v6 offset:8704
  ds_read_b128 v[132:135], v2 offset:24576
  v_mfma_f32_32x32x16_bf16 v[80:95], v[144:147], v[156:159], v[80:95]
  ds_read_b64_tr_b16 v[140:141], v6 offset:32768
  ds_read_b64_tr_b16 v[142:143], v6 offset:33280
  v_mfma_f32_32x32x16_bf16 v[96:111], v[148:151], v[156:159], v[96:111]
  ds_read_b128 v[144:147], v3 offset:0
  ds_read_b64_tr_b16 v[152:153], v6 offset:10240
  v_mfma_f32_32x32x16_bf16 v[48:63], v[120:123], v[112:115], v[48:63]
  ds_read_b64_tr_b16 v[154:155], v6 offset:10752
  ds_read_b128 v[148:151], v3 offset:24576
  v_mfma_f32_32x32x16_bf16 v[64:79], v[120:123], v[116:119], v[64:79]
  ds_read_b64_tr_b16 v[156:157], v6 offset:34816
  ds_read_b64_tr_b16 v[158:159], v6 offset:35328
  v_mfma_f32_32x32x16_bf16 v[80:95], v[112:115], v[124:127], v[80:95]
  v_mfma_f32_32x32x16_bf16 v[96:111], v[116:119], v[124:127], v[96:111]
  ds_read_b128 v[112:115], v4 offset:0
  ds_read_b64_tr_b16 v[120:121], v6 offset:20480
  s_waitcnt lgkmcnt(11)
  v_mfma_f32_32x32x16_bf16 v[48:63], v[136:139], v[128:131], v[48:63]
  ds_read_b64_tr_b16 v[122:123], v6 offset:20992
  ds_read_b128 v[116:119], v4 offset:24576
  s_waitcnt lgkmcnt(12)
  v_mfma_f32_32x32x16_bf16 v[64:79], v[136:139], v[132:135], v[64:79]
  ds_read_b64_tr_b16 v[124:125], v6 offset:45056
  ds_read_b64_tr_b16 v[126:127], v6 offset:45568
  s_waitcnt lgkmcnt(12)
  v_mfma_f32_32x32x16_bf16 v[80:95], v[128:131], v[140:143], v[80:95]
  v_mfma_f32_32x32x16_bf16 v[96:111], v[132:135], v[140:143], v[96:111]
  ds_read_b128 v[128:131], v5 offset:0
  ds_read_b64_tr_b16 v[136:137], v6 offset:22528
  s_waitcnt lgkmcnt(11)
  v_mfma_f32_32x32x16_bf16 v[48:63], v[152:155], v[144:147], v[48:63]
  ds_read_b64_tr_b16 v[138:139], v6 offset:23040
  ds_read_b128 v[132:135], v5 offset:24576
  buffer_load_dword v252, v252, s[32:35], 0 offen sc1
  s_waitcnt lgkmcnt(12)
  v_mfma_f32_32x32x16_bf16 v[64:79], v[152:155], v[148:151], v[64:79]
  ds_read_b64_tr_b16 v[140:141], v6 offset:47104
  ds_read_b64_tr_b16 v[142:143], v6 offset:47616
  s_waitcnt lgkmcnt(12)
  v_mfma_f32_32x32x16_bf16 v[80:95], v[144:147], v[156:159], v[80:95]
  v_mfma_f32_32x32x16_bf16 v[96:111], v[148:151], v[156:159], v[96:111]
  s_waitcnt lgkmcnt(9)
  v_mfma_f32_32x32x16_bf16 v[48:63], v[120:123], v[112:115], v[48:63]
  s_waitcnt lgkmcnt(8)
  v_mfma_f32_32x32x16_bf16 v[64:79], v[120:123], v[116:119], v[64:79]
  s_waitcnt lgkmcnt(0)
  s_barrier
  ds_read_b128 v[144:147], v2 offset:16384
  ds_read_b64_tr_b16 v[152:153], v6 offset:57344
  ds_read_b64_tr_b16 v[154:155], v6 offset:57856
  ds_read_b128 v[148:151], v2 offset:40960
  v_mfma_f32_32x32x16_bf16 v[80:95], v[112:115], v[124:127], v[80:95]
  ds_read_b64_tr_b16 v[156:157], v7 offset:16384
  ds_read_b64_tr_b16 v[158:159], v7 offset:16896
  v_mfma_f32_32x32x16_bf16 v[96:111], v[116:119], v[124:127], v[96:111]
  ds_read_b128 v[112:115], v3 offset:16384
  ds_read_b64_tr_b16 v[120:121], v6 offset:59392
  v_mfma_f32_32x32x16_bf16 v[48:63], v[136:139], v[128:131], v[48:63]
  ds_read_b64_tr_b16 v[122:123], v6 offset:59904
  ds_read_b128 v[116:119], v3 offset:40960
  v_mfma_f32_32x32x16_bf16 v[64:79], v[136:139], v[132:135], v[64:79]
  ds_read_b64_tr_b16 v[124:125], v7 offset:18432
  ds_read_b64_tr_b16 v[126:127], v7 offset:18944
  v_mfma_f32_32x32x16_bf16 v[80:95], v[128:131], v[140:143], v[80:95]
  v_mfma_f32_32x32x16_bf16 v[96:111], v[132:135], v[140:143], v[96:111]
  ds_read_b128 v[128:131], v4 offset:16384
  ds_read_b64_tr_b16 v[136:137], v7 offset:4096
  s_waitcnt lgkmcnt(11)
  v_mfma_f32_32x32x16_bf16 v[48:63], v[152:155], v[144:147], v[48:63]
  ds_read_b64_tr_b16 v[138:139], v7 offset:4608
  ds_read_b128 v[132:135], v4 offset:40960
  s_waitcnt lgkmcnt(12)
  v_mfma_f32_32x32x16_bf16 v[64:79], v[152:155], v[148:151], v[64:79]
  ds_read_b64_tr_b16 v[140:141], v7 offset:28672
  ds_read_b64_tr_b16 v[142:143], v7 offset:29184
  s_waitcnt lgkmcnt(12)
  v_mfma_f32_32x32x16_bf16 v[80:95], v[144:147], v[156:159], v[80:95]
  v_mfma_f32_32x32x16_bf16 v[96:111], v[148:151], v[156:159], v[96:111]
  ds_read_b128 v[144:147], v5 offset:16384
  ds_read_b64_tr_b16 v[152:153], v7 offset:6144
  s_waitcnt lgkmcnt(11)
  v_mfma_f32_32x32x16_bf16 v[48:63], v[120:123], v[112:115], v[48:63]
  ds_read_b64_tr_b16 v[154:155], v7 offset:6656
  ds_read_b128 v[148:151], v5 offset:40960
  s_waitcnt lgkmcnt(12)
  v_mfma_f32_32x32x16_bf16 v[64:79], v[120:123], v[116:119], v[64:79]
  ds_read_b64_tr_b16 v[156:157], v7 offset:30720
  ds_read_b64_tr_b16 v[158:159], v7 offset:31232
  s_waitcnt lgkmcnt(12)
  v_mfma_f32_32x32x16_bf16 v[80:95], v[112:115], v[124:127], v[80:95]
  v_mfma_f32_32x32x16_bf16 v[96:111], v[116:119], v[124:127], v[96:111]
  s_waitcnt lgkmcnt(9)
  v_mfma_f32_32x32x16_bf16 v[48:63], v[136:139], v[128:131], v[48:63]
  s_waitcnt lgkmcnt(8)
  v_mfma_f32_32x32x16_bf16 v[64:79], v[136:139], v[132:135], v[64:79]
  s_waitcnt lgkmcnt(0)
  s_barrier
  ds_read_b128 v[112:115], v2 offset:12288
  ds_read_b64_tr_b16 v[120:121], v10 offset:0
  ds_read_b64_tr_b16 v[122:123], v10 offset:512
  ds_read_b128 v[116:119], v2 offset:36864
  v_mfma_f32_32x32x16_bf16 v[80:95], v[128:131], v[140:143], v[80:95]
  v_mfma_f32_32x32x16_bf16 v[96:111], v[132:135], v[140:143], v[96:111]
  ds_read_b128 v[124:127], v3 offset:12288
  ds_read_b64_tr_b16 v[132:133], v10 offset:2048
  v_mfma_f32_32x32x16_bf16 v[48:63], v[152:155], v[144:147], v[48:63]
  ds_read_b64_tr_b16 v[134:135], v10 offset:2560
  ds_read_b128 v[128:131], v3 offset:36864
  s_waitcnt vmcnt(0)
  s_xor_b32 s6, s52, s18
  v_cmp_ne_u32 vcc, s6, v252
  s_nop 1
  v_mfma_f32_32x32x16_bf16 v[64:79], v[152:155], v[148:151], v[64:79]
  s_cmp_eq_u64 vcc, 0
  s_cselect_b32 s19, 1, 0
  s_lshl_b32 s6, s2, 7
  s_add_u32 s6, s6, 10110976
  v_mfma_f32_32x32x16_bf16 v[80:95], v[144:147], v[156:159], v[80:95]
  s_cmp_eq_u32 s23, 0
  s_cselect_b64 exec, -1, 0
  buffer_store_dword v253, v218, s[32:35], s6 offen sc1
  s_mov_b64 exec, -1
  v_mfma_f32_32x32x16_bf16 v[96:111], v[148:151], v[156:159], v[96:111]
  ds_read_b128 v[136:139], v4 offset:12288
  ds_read_b64_tr_b16 v[144:145], v10 offset:4096
  s_waitcnt lgkmcnt(7)
  v_mfma_f32_32x32x16_bf16 v[48:63], v[120:123], v[112:115], v[48:63]
  ds_read_b64_tr_b16 v[146:147], v10 offset:4608
  ds_read_b128 v[140:143], v4 offset:36864
  ds_read_b128 v[148:151], v5 offset:12288
  s_waitcnt lgkmcnt(9)
  v_mfma_f32_32x32x16_bf16 v[64:79], v[120:123], v[116:119], v[64:79]
  ds_read_b64_tr_b16 v[156:157], v10 offset:6144
  ds_read_b64_tr_b16 v[158:159], v10 offset:6656
  s_waitcnt lgkmcnt(8)
  v_mfma_f32_32x32x16_bf16 v[48:63], v[132:135], v[124:127], v[48:63]
  ds_read_b128 v[152:155], v5 offset:36864
  s_waitcnt lgkmcnt(8)
  v_mfma_f32_32x32x16_bf16 v[64:79], v[132:135], v[128:131], v[64:79]
  s_waitcnt lgkmcnt(0)
  s_barrier
  ds_read_b128 v[112:115], v11 offset:8192
  ds_read_b64_tr_b16 v[120:121], v10 offset:8192
  ds_read_b64_tr_b16 v[122:123], v10 offset:8704
  ds_read_b128 v[116:119], v11 offset:12288
  v_mfma_f32_32x32x16_bf16 v[48:63], v[144:147], v[136:139], v[48:63]
  ds_read_b128 v[124:127], v12 offset:8192
  ds_read_b64_tr_b16 v[132:133], v10 offset:10240
  ds_read_b64_tr_b16 v[134:135], v10 offset:10752
  v_mfma_f32_32x32x16_bf16 v[64:79], v[144:147], v[140:143], v[64:79]
  ds_read_b128 v[128:131], v12 offset:12288
  ds_read_b128 v[136:139], v13 offset:8192
  v_mfma_f32_32x32x16_bf16 v[48:63], v[156:159], v[148:151], v[48:63]
  ds_read_b64_tr_b16 v[144:145], v10 offset:12288
  ds_read_b64_tr_b16 v[146:147], v10 offset:12800
  v_mfma_f32_32x32x16_bf16 v[64:79], v[156:159], v[152:155], v[64:79]
  ds_read_b128 v[140:143], v13 offset:12288
  ds_read_b128 v[148:151], v14 offset:8192
  s_waitcnt lgkmcnt(10)
  v_mfma_f32_32x32x16_bf16 v[48:63], v[120:123], v[112:115], v[48:63]
  ds_read_b64_tr_b16 v[156:157], v10 offset:14336
  ds_read_b64_tr_b16 v[158:159], v10 offset:14848
  s_waitcnt lgkmcnt(11)
  v_mfma_f32_32x32x16_bf16 v[64:79], v[120:123], v[116:119], v[64:79]
  ds_read_b128 v[152:155], v14 offset:12288
  s_waitcnt lgkmcnt(9)
  v_mfma_f32_32x32x16_bf16 v[48:63], v[132:135], v[124:127], v[48:63]
  s_waitcnt lgkmcnt(8)
  v_mfma_f32_32x32x16_bf16 v[64:79], v[132:135], v[128:131], v[64:79]
  s_waitcnt lgkmcnt(0)
  s_barrier
  ds_read_b128 v[112:115], v2 offset:12288
  ds_read_b64_tr_b16 v[120:121], v7 offset:49152
  ds_read_b64_tr_b16 v[122:123], v7 offset:49664
  ds_read_b128 v[116:119], v2 offset:36864
  v_mfma_f32_32x32x16_bf16 v[48:63], v[144:147], v[136:139], v[48:63]
  ds_read_b128 v[124:127], v3 offset:12288
  ds_read_b64_tr_b16 v[132:133], v7 offset:51200
  ds_read_b64_tr_b16 v[134:135], v7 offset:51712
  v_mfma_f32_32x32x16_bf16 v[64:79], v[144:147], v[140:143], v[64:79]
  ds_read_b128 v[128:131], v3 offset:36864
  ds_read_b128 v[136:139], v4 offset:12288
  v_mfma_f32_32x32x16_bf16 v[48:63], v[156:159], v[148:151], v[48:63]
  ds_read_b64_tr_b16 v[144:145], v7 offset:53248
  ds_read_b64_tr_b16 v[146:147], v7 offset:53760
  v_mfma_f32_32x32x16_bf16 v[64:79], v[156:159], v[152:155], v[64:79]
  ds_read_b128 v[140:143], v4 offset:36864
  ds_read_b128 v[148:151], v5 offset:12288
  s_waitcnt lgkmcnt(10)
  v_mfma_f32_32x32x16_bf16 v[80:95], v[112:115], v[120:123], v[80:95]
  ds_read_b64_tr_b16 v[156:157], v7 offset:55296
  ds_read_b64_tr_b16 v[158:159], v7 offset:55808
  s_waitcnt lgkmcnt(11)
  v_mfma_f32_32x32x16_bf16 v[96:111], v[116:119], v[120:123], v[96:111]
  ds_read_b128 v[152:155], v5 offset:36864
  ds_read_b128 v[112:115], v11 offset:8192
  v_cvt_pk_bf16_f32 v180, v56, v57
  v_cvt_pk_bf16_f32 v181, v58, v59
  v_cvt_pk_bf16_f32 v182, v60, v61
  v_cvt_pk_bf16_f32 v183, v62, v63
  s_waitcnt lgkmcnt(10)
  v_mfma_f32_32x32x16_bf16 v[80:95], v[124:127], v[132:135], v[80:95]
  ds_read_b64_tr_b16 v[120:121], v7 offset:57344
  ds_read_b64_tr_b16 v[122:123], v7 offset:57856
  v_cvt_pk_bf16_f32 v188, v72, v73
  v_cvt_pk_bf16_f32 v189, v74, v75
  v_cvt_pk_bf16_f32 v190, v76, v77
  v_cvt_pk_bf16_f32 v191, v78, v79
  v_mfma_f32_32x32x16_bf16 v[220:235], v[240:243], v[180:183], 0
  s_waitcnt lgkmcnt(11)
  v_mfma_f32_32x32x16_bf16 v[96:111], v[128:131], v[132:135], v[96:111]
  ds_read_b128 v[116:119], v11 offset:12288
  ds_read_b128 v[124:127], v12 offset:8192
  v_cvt_pk_bf16_f32 v176, v48, v49
  v_cvt_pk_bf16_f32 v177, v50, v51
  v_cvt_pk_bf16_f32 v178, v52, v53
  v_cvt_pk_bf16_f32 v179, v54, v55
  v_mfma_f32_32x32x16_bf16 v[220:235], v[248:251], v[180:183], v[220:235]
  s_waitcnt lgkmcnt(10)
  v_mfma_f32_32x32x16_bf16 v[80:95], v[136:139], v[144:147], v[80:95]
  ds_read_b64_tr_b16 v[132:133], v7 offset:59392
  ds_read_b64_tr_b16 v[134:135], v7 offset:59904
  v_cvt_pk_bf16_f32 v184, v64, v65
  v_cvt_pk_bf16_f32 v185, v66, v67
  v_cvt_pk_bf16_f32 v186, v68, v69
  v_cvt_pk_bf16_f32 v187, v70, v71
  v_mfma_f32_32x32x16_bf16 v[192:207], v[240:243], v[188:191], 0
  s_waitcnt lgkmcnt(11)
  v_mfma_f32_32x32x16_bf16 v[96:111], v[140:143], v[144:147], v[96:111]
  ds_read_b128 v[128:131], v12 offset:12288
  ds_read_b128 v[136:139], v13 offset:8192
  v_mfma_f32_32x32x16_bf16 v[192:207], v[248:251], v[188:191], v[192:207]
  s_waitcnt lgkmcnt(10)
  v_mfma_f32_32x32x16_bf16 v[80:95], v[148:151], v[156:159], v[80:95]
  ds_read_b64_tr_b16 v[144:145], v7 offset:61440
  ds_read_b64_tr_b16 v[146:147], v7 offset:61952
  v_exp_f32 v220, v220
  v_exp_f32 v221, v221
  v_exp_f32 v222, v222
  s_waitcnt lgkmcnt(11)
  v_mfma_f32_32x32x16_bf16 v[96:111], v[152:155], v[156:159], v[96:111]
  ds_read_b128 v[140:143], v13 offset:12288
  ds_read_b128 v[148:151], v14 offset:8192
  v_exp_f32 v223, v223
  v_exp_f32 v224, v224
  v_exp_f32 v225, v225
  s_waitcnt lgkmcnt(10)
  v_mfma_f32_32x32x16_bf16 v[80:95], v[112:115], v[120:123], v[80:95]
  ds_read_b64_tr_b16 v[156:157], v7 offset:63488
  ds_read_b64_tr_b16 v[158:159], v7 offset:64000
  v_exp_f32 v226, v226
  v_exp_f32 v227, v227
  v_exp_f32 v228, v228
  s_waitcnt lgkmcnt(11)
  v_mfma_f32_32x32x16_bf16 v[96:111], v[116:119], v[120:123], v[96:111]
  ds_read_b128 v[152:155], v14 offset:12288
  v_exp_f32 v229, v229
  v_exp_f32 v230, v230
  v_exp_f32 v231, v231
  s_waitcnt lgkmcnt(9)
  v_mfma_f32_32x32x16_bf16 v[80:95], v[124:127], v[132:135], v[80:95]
  v_exp_f32 v232, v232
  v_exp_f32 v233, v233
  v_exp_f32 v234, v234
  s_waitcnt lgkmcnt(8)
  v_mfma_f32_32x32x16_bf16 v[96:111], v[128:131], v[132:135], v[96:111]
  v_exp_f32 v235, v235
  v_exp_f32 v192, v192
  v_exp_f32 v193, v193
  s_waitcnt lgkmcnt(5)
  v_mfma_f32_32x32x16_bf16 v[80:95], v[136:139], v[144:147], v[80:95]
  v_exp_f32 v194, v194
  v_exp_f32 v195, v195
  v_exp_f32 v196, v196
  s_waitcnt lgkmcnt(4)
  v_mfma_f32_32x32x16_bf16 v[96:111], v[140:143], v[144:147], v[96:111]
  v_exp_f32 v197, v197
  v_exp_f32 v198, v198
  v_exp_f32 v199, v199
  s_waitcnt lgkmcnt(1)
  v_mfma_f32_32x32x16_bf16 v[80:95], v[148:151], v[156:159], v[80:95]
  v_exp_f32 v200, v200
  v_exp_f32 v201, v201
  v_exp_f32 v202, v202
  s_waitcnt lgkmcnt(0)
  v_mfma_f32_32x32x16_bf16 v[96:111], v[152:155], v[156:159], v[96:111]
  v_exp_f32 v203, v203
  v_exp_f32 v204, v204
  v_exp_f32 v205, v205
  s_branch M_A2
PE5:
.p2align 12
PG6:
WA2:
  s_branch WA_RET
L_A2:
  s_waitcnt vmcnt(12)
  s_barrier
  buffer_load_dword v252, v252, s[32:35], 0 offen sc1
  s_add_u32 m0, s99, 143360
  s_add_u32 s95, s87, 295936
  buffer_load_dwordx4 v189, s[28:31], s95 offen lds
  s_add_u32 m0, s99, 114688
  s_add_u32 s95, s87, 2048
  buffer_load_dwordx4 v189, s[28:31], s95 offen lds
  s_add_u32 m0, s99, 118784
  s_add_u32 s95, s87, 100352
  buffer_load_dwordx4 v189, s[28:31], s95 offen lds
  s_add_u32 m0, s99, 122880
  s_add_u32 s95, s87, 198656
  buffer_load_dwordx4 v189, s[28:31], s95 offen lds
  s_add_u32 m0, s99, 126976
  s_add_u32 s95, s87, 296960
  buffer_load_dwordx4 v189, s[28:31], s95 offen lds
  s_add_u32 m0, s99, 98304
  s_add_u32 s95, s87, 196608
  buffer_load_dwordx4 v189, s[28:31], s95 offen lds
  s_waitcnt vmcnt(12)
  s_barrier
  s_add_u32 m0, s99, 102400
  s_add_u32 s95, s87, 294912
  buffer_load_dwordx4 v189, s[28:31], s95 offen lds
  s_add_u32 m0, s99, 147456
  s_add_u32 s95, s85, 0
  buffer_load_dwordx4 v189, s[28:31], s95 offen lds
  s_add_u32 m0, s99, 151552
  s_add_u32 s95, s85, 98304
  buffer_load_dwordx4 v189, s[28:31], s95 offen lds
  s_add_u32 m0, s99, 8192
  s_add_u32 s95, s85, 196608
  buffer_load_dwordx4 v189, s[28:31], s95 offen lds
  s_add_u32 m0, s99, 20480
  s_add_u32 s95, s85, 294912
  buffer_load_dwordx4 v189, s[28:31], s95 offen lds
  s_add_u32 m0, s99, 32768
  s_add_u32 s95, s86, 0
  buffer_load_dwordx4 v189, s[28:31], s95 offen lds
  s_add_u32 m0, s99, 45056
  s_add_u32 s95, s86, 98304
  buffer_load_dwordx4 v189, s[28:31], s95 offen lds
  s_waitcnt vmcnt(12)
  s_barrier
  s_add_u32 m0, s99, 57344
  s_add_u32 s95, s86, 196608
  buffer_load_dwordx4 v189, s[28:31], s95 offen lds
  s_add_u32 m0, s99, 69632
  s_add_u32 s95, s86, 294912
  buffer_load_dwordx4 v189, s[28:31], s95 offen lds
  s_add_u32 m0, s99, 81920
  s_add_u32 s95, s87, 0
  buffer_load_dwordx4 v189, s[28:31], s95 offen lds
  s_add_u32 m0, s99, 94208
  s_add_u32 s95, s87, 98304
  buffer_load_dwordx4 v189, s[28:31], s95 offen lds
  s_waitcnt vmcnt(12)
  s_xor_b32 s6, s52, s18
  v_cmp_ne_u32 vcc, s6, v252
  s_nop 1
  s_cmp_eq_u64 vcc, 0
  s_cselect_b32 s19, 1, 0
  s_barrier
  buffer_load_dword v197, v196, s[40:43], s53 offen
  v_add_u32 v196, s53, v196
  global_load_dword v197, v196, s[72:73]
  s_waitcnt vmcnt(2)
  s_waitcnt vmcnt(2)
  s_barrier
  ds_read_b128 v[112:115], v11 offset:8192
  ds_read_b64_tr_b16 v[120:121], v7 offset:32768
  ds_read_b64_tr_b16 v[122:123], v7 offset:33280
  ds_read_b128 v[116:119], v11 offset:12288
  ds_read_b128 v[124:127], v12 offset:8192
  ds_read_b64_tr_b16 v[132:133], v7 offset:34816
  ds_read_b64_tr_b16 v[134:135], v7 offset:35328
  ds_read_b128 v[128:131], v12 offset:12288
  ds_read_b128 v[136:139], v13 offset:8192
  ds_read_b64_tr_b16 v[144:145], v7 offset:36864
  ds_read_b64_tr_b16 v[146:147], v7 offset:37376
  ds_read_b128 v[140:143], v13 offset:12288
  s_waitcnt lgkmcnt(9)
  v_mfma_f32_32x32x16_bf16 v[16:31], v[120:123], v[112:115], v[16:31]
  ds_read_b128 v[148:151], v14 offset:8192
  ds_read_b64_tr_b16 v[156:157], v7 offset:38912
  ds_read_b64_tr_b16 v[158:159], v7 offset:39424
  s_waitcnt lgkmcnt(11)
  v_mfma_f32_32x32x16_bf16 v[32:47], v[120:123], v[116:119], v[32:47]
  ds_read_b128 v[152:155], v14 offset:12288
  ds_read_b64_tr_b16 v[120:121], v10 offset:16384
  s_waitcnt lgkmcnt(10)
  v_mfma_f32_32x32x16_bf16 v[16:31], v[132:135], v[124:127], v[16:31]
  ds_read_b64_tr_b16 v[122:123], v10 offset:16896
  s_waitcnt lgkmcnt(10)
  v_mfma_f32_32x32x16_bf16 v[32:47], v[132:135], v[128:131], v[32:47]
  ds_read_b64_tr_b16 v[132:133], v10 offset:18432
  ds_read_b64_tr_b16 v[134:135], v10 offset:18944
  s_waitcnt lgkmcnt(9)
  v_mfma_f32_32x32x16_bf16 v[16:31], v[144:147], v[136:139], v[16:31]
  s_waitcnt lgkmcnt(8)
  v_mfma_f32_32x32x16_bf16 v[32:47], v[144:147], v[140:143], v[32:47]
  ds_read_b64_tr_b16 v[144:145], v10 offset:20480
  ds_read_b64_tr_b16 v[146:147], v10 offset:20992
  s_waitcnt lgkmcnt(7)
  v_mfma_f32_32x32x16_bf16 v[16:31], v[156:159], v[148:151], v[16:31]
  s_waitcnt lgkmcnt(6)
  v_mfma_f32_32x32x16_bf16 v[32:47], v[156:159], v[152:155], v[32:47]
  ds_read_b64_tr_b16 v[156:157], v10 offset:22528
  ds_read_b64_tr_b16 v[158:159], v10 offset:23040
  s_waitcnt lgkmcnt(6)
  v_mfma_f32_32x32x16_bf16 v[16:31], v[120:123], v[64:67], v[16:31]
  v_mfma_f32_32x32x16_bf16 v[32:47], v[120:123], v[68:71], v[32:47]
  s_waitcnt lgkmcnt(4)
  v_mfma_f32_32x32x16_bf16 v[16:31], v[132:135], v[72:75], v[16:31]
  v_mfma_f32_32x32x16_bf16 v[32:47], v[132:135], v[76:79], v[32:47]
  s_waitcnt lgkmcnt(0)
  s_barrier
  ds_read_b128 v[112:115], v2 offset:4096
  ds_read_b64_tr_b16 v[120:121], v6 offset:8192
  ds_read_b64_tr_b16 v[122:123], v6 offset:8704
  ds_read_b128 v[116:119], v2 offset:28672
  v_mfma_f32_32x32x16_bf16 v[16:31], v[144:147], v[80:83], v[16:31]
  ds_read_b128 v[124:127], v3 offset:4096
  ds_read_b64_tr_b16 v[132:133], v6 offset:10240
  ds_read_b64_tr_b16 v[134:135], v6 offset:10752
  v_mfma_f32_32x32x16_bf16 v[32:47], v[144:147], v[84:87], v[32:47]
  ds_read_b128 v[128:131], v3 offset:28672
  ds_read_b128 v[136:139], v4 offset:4096
  v_mfma_f32_32x32x16_bf16 v[16:31], v[156:159], v[88:91], v[16:31]
  ds_read_b64_tr_b16 v[144:145], v6 offset:20480
  ds_read_b64_tr_b16 v[146:147], v6 offset:20992
  v_mfma_f32_32x32x16_bf16 v[32:47], v[156:159], v[92:95], v[32:47]
  ds_read_b128 v[140:143], v4 offset:28672
  ds_read_b128 v[148:151], v5 offset:4096
  s_waitcnt lgkmcnt(10)
  v_mfma_f32_32x32x16_bf16 v[16:31], v[120:123], v[112:115], v[16:31]
  ds_read_b64_tr_b16 v[156:157], v6 offset:22528
  ds_read_b64_tr_b16 v[158:159], v6 offset:23040
  s_waitcnt lgkmcnt(11)
  v_mfma_f32_32x32x16_bf16 v[32:47], v[120:123], v[116:119], v[32:47]
  ds_read_b128 v[152:155], v5 offset:28672
  ds_read_b128 v[112:115], v2 offset:0
  s_waitcnt lgkmcnt(10)
  v_mfma_f32_32x32x16_bf16 v[16:31], v[132:135], v[124:127], v[16:31]
  ds_read_b64_tr_b16 v[120:121], v6 offset:32768
  ds_read_b64_tr_b16 v[122:123], v6 offset:33280
  s_waitcnt lgkmcnt(11)
  v_mfma_f32_32x32x16_bf16 v[32:47], v[132:135], v[128:131], v[32:47]
  ds_read_b128 v[116:119], v2 offset:24576
  ds_read_b128 v[124:127], v3 offset:0
  s_waitcnt lgkmcnt(10)
  v_mfma_f32_32x32x16_bf16 v[16:31], v[144:147], v[136:139], v[16:31]
  ds_read_b64_tr_b16 v[132:133], v6 offset:34816
  ds_read_b64_tr_b16 v[134:135], v6 offset:35328
  s_waitcnt lgkmcnt(11)
  v_mfma_f32_32x32x16_bf16 v[32:47], v[144:147], v[140:143], v[32:47]
  ds_read_b128 v[128:131], v3 offset:24576
  ds_read_b128 v[136:139], v4 offset:0
  s_waitcnt lgkmcnt(10)
  v_mfma_f32_32x32x16_bf16 v[16:31], v[156:159], v[148:151], v[16:31]
  ds_read_b64_tr_b16 v[144:145], v6 offset:45056
  ds_read_b64_tr_b16 v[146:147], v6 offset:45568
  s_waitcnt lgkmcnt(11)
  v_mfma_f32_32x32x16_bf16 v[32:47], v[156:159], v[152:155], v[32:47]
  ds_read_b128 v[140:143], v4 offset:24576
  ds_read_b128 v[148:151], v5 offset:0
  s_waitcnt lgkmcnt(10)
  v_mfma_f32_32x32x16_bf16 v[16:31], v[120:123], v[112:115], v[16:31]
  ds_read_b64_tr_b16 v[156:157], v6 offset:47104
  ds_read_b64_tr_b16 v[158:159], v6 offset:47616
  s_waitcnt lgkmcnt(11)
  v_mfma_f32_32x32x16_bf16 v[32:47], v[120:123], v[116:119], v[32:47]
  ds_read_b128 v[152:155], v5 offset:24576
  ds_read_b128 v[112:115], v2 offset:16384
  s_waitcnt lgkmcnt(10)
  v_mfma_f32_32x32x16_bf16 v[16:31], v[132:135], v[124:127], v[16:31]
  ds_read_b64_tr_b16 v[120:121], v6 offset:57344
  ds_read_b64_tr_b16 v[122:123], v6 offset:57856
  s_waitcnt lgkmcnt(11)
  v_mfma_f32_32x32x16_bf16 v[32:47], v[132:135], v[128:131], v[32:47]
  ds_read_b128 v[116:119], v2 offset:40960
  ds_read_b128 v[124:127], v3 offset:16384
  s_waitcnt lgkmcnt(10)
  v_mfma_f32_32x32x16_bf16 v[16:31], v[144:147], v[136:139], v[16:31]
  ds_read_b64_tr_b16 v[132:133], v6 offset:59392
  ds_read_b64_tr_b16 v[134:135], v6 offset:59904
  s_waitcnt lgkmcnt(11)
  v_mfma_f32_32x32x16_bf16 v[32:47], v[144:147], v[140:143], v[32:47]
  ds_read_b128 v[128:131], v3 offset:40960
  ds_read_b128 v[136:139], v4 offset:16384
  s_waitcnt lgkmcnt(10)
  v_mfma_f32_32x32x16_bf16 v[16:31], v[156:159], v[148:151], v[16:31]
  ds_read_b64_tr_b16 v[144:145], v7 offset:4096
  ds_read_b64_tr_b16 v[146:147], v7 offset:4608
  s_waitcnt lgkmcnt(11)
  v_mfma_f32_32x32x16_bf16 v[32:47], v[156:159], v[152:155], v[32:47]
  ds_read_b128 v[140:143], v4 offset:40960
  ds_read_b128 v[148:151], v5 offset:16384
  s_waitcnt lgkmcnt(10)
  v_mfma_f32_32x32x16_bf16 v[16:31], v[120:123], v[112:115], v[16:31]
  ds_read_b64_tr_b16 v[156:157], v7 offset:6144
  ds_read_b64_tr_b16 v[158:159], v7 offset:6656
  s_waitcnt lgkmcnt(11)
  v_mfma_f32_32x32x16_bf16 v[32:47], v[120:123], v[116:119], v[32:47]
  ds_read_b128 v[152:155], v5 offset:40960
  ds_read_b128 v[112:115], v2 offset:12288
  s_waitcnt lgkmcnt(10)
  v_mfma_f32_32x32x16_bf16 v[16:31], v[132:135], v[124:127], v[16:31]
  ds_read_b64_tr_b16 v[120:121], v7 offset:16384
  ds_read_b64_tr_b16 v[122:123], v7 offset:16896
  s_waitcnt lgkmcnt(11)
  v_mfma_f32_32x32x16_bf16 v[32:47], v[132:135], v[128:131], v[32:47]
  ds_read_b128 v[116:119], v2 offset:36864
  ds_read_b128 v[124:127], v3 offset:12288
  s_waitcnt lgkmcnt(10)
  v_mfma_f32_32x32x16_bf16 v[16:31], v[144:147], v[136:139], v[16:31]
  ds_read_b64_tr_b16 v[132:133], v7 offset:18432
  ds_read_b64_tr_b16 v[134:135], v7 offset:18944
  s_waitcnt lgkmcnt(11)
  v_mfma_f32_32x32x16_bf16 v[32:47], v[144:147], v[140:143], v[32:47]
  ds_read_b128 v[128:131], v3 offset:36864
  ds_read_b128 v[136:139], v4 offset:12288
  s_waitcnt lgkmcnt(10)
  v_mfma_f32_32x32x16_bf16 v[16:31], v[156:159], v[148:151], v[16:31]
  ds_read_b64_tr_b16 v[144:145], v7 offset:28672
  ds_read_b64_tr_b16 v[146:147], v7 offset:29184
  s_waitcnt lgkmcnt(11)
  v_mfma_f32_32x32x16_bf16 v[32:47], v[156:159], v[152:155], v[32:47]
  ds_read_b128 v[140:143], v4 offset:36864
  ds_read_b128 v[148:151], v5 offset:12288
  s_waitcnt lgkmcnt(10)
  v_mfma_f32_32x32x16_bf16 v[16:31], v[120:123], v[112:115], v[16:31]
  ds_read_b64_tr_b16 v[156:157], v7 offset:30720
  ds_read_b64_tr_b16 v[158:159], v7 offset:31232
  s_waitcnt lgkmcnt(11)
  v_mfma_f32_32x32x16_bf16 v[32:47], v[120:123], v[116:119], v[32:47]
  ds_read_b128 v[152:155], v5 offset:36864
  s_waitcnt lgkmcnt(9)
  v_mfma_f32_32x32x16_bf16 v[16:31], v[132:135], v[124:127], v[16:31]
  s_waitcnt lgkmcnt(8)
  v_mfma_f32_32x32x16_bf16 v[32:47], v[132:135], v[128:131], v[32:47]
  s_waitcnt lgkmcnt(5)
  v_mfma_f32_32x32x16_bf16 v[16:31], v[144:147], v[136:139], v[16:31]
  s_waitcnt lgkmcnt(4)
  v_mfma_f32_32x32x16_bf16 v[32:47], v[144:147], v[140:143], v[32:47]
  s_waitcnt lgkmcnt(1)
  v_mfma_f32_32x32x16_bf16 v[16:31], v[156:159], v[148:151], v[16:31]
  s_waitcnt lgkmcnt(0)
  v_mfma_f32_32x32x16_bf16 v[32:47], v[156:159], v[152:155], v[32:47]
  v_mfma_f32_32x32x16_bf16 v[220:235], v[48:51], v[52:55], 0
  s_nop 15
  v_mul_f32 v220, s56, v220
  v_mul_f32 v221, s56, v221
  v_mul_f32 v222, s56, v222
  v_mul_f32 v223, s56, v223
  v_mul_f32 v224, s56, v224
  v_mul_f32 v225, s56, v225
  v_mul_f32 v226, s56, v226
  v_mul_f32 v227, s56, v227
  v_mul_f32 v228, s56, v228
  v_mul_f32 v229, s56, v229
  v_mul_f32 v230, s56, v230
  v_mul_f32 v231, s56, v231
  v_mul_f32 v232, s56, v232
  v_mul_f32 v233, s56, v233
  v_mul_f32 v234, s56, v234
  v_mul_f32 v235, s56, v235
  v_cvt_pk_bf16_f32 v236, v220, v221
  v_cvt_pk_bf16_f32 v237, v222, v223
  v_cvt_pk_bf16_f32 v238, v224, v225
  v_cvt_pk_bf16_f32 v239, v226, v227
  v_cvt_pk_bf16_f32 v240, v228, v229
  v_cvt_pk_bf16_f32 v241, v230, v231
  v_cvt_pk_bf16_f32 v242, v232, v233
  v_cvt_pk_bf16_f32 v243, v234, v235
  v_lshlrev_b32 v15, 16, v236
  v_sub_f32 v220, v220, v15
  v_and_b32 v15, 0xffff0000, v236
  v_sub_f32 v221, v221, v15
  v_lshlrev_b32 v15, 16, v237
  v_sub_f32 v222, v222, v15
  v_and_b32 v15, 0xffff0000, v237
  v_sub_f32 v223, v223, v15
  v_lshlrev_b32 v15, 16, v238
  v_sub_f32 v224, v224, v15
  v_and_b32 v15, 0xffff0000, v238
  v_sub_f32 v225, v225, v15
  v_lshlrev_b32 v15, 16, v239
  v_sub_f32 v226, v226, v15
  v_and_b32 v15, 0xffff0000, v239
  v_sub_f32 v227, v227, v15
  v_lshlrev_b32 v15, 16, v240
  v_sub_f32 v228, v228, v15
  v_and_b32 v15, 0xffff0000, v240
  v_sub_f32 v229, v229, v15
  v_lshlrev_b32 v15, 16, v241
  v_sub_f32 v230, v230, v15
  v_and_b32 v15, 0xffff0000, v241
  v_sub_f32 v231, v231, v15
  v_lshlrev_b32 v15, 16, v242
  v_sub_f32 v232, v232, v15
  v_and_b32 v15, 0xffff0000, v242
  v_sub_f32 v233, v233, v15
  v_lshlrev_b32 v15, 16, v243
  v_sub_f32 v234, v234, v15
  v_and_b32 v15, 0xffff0000, v243
  v_sub_f32 v235, v235, v15
  v_cvt_pk_bf16_f32 v244, v220, v221
  v_cvt_pk_bf16_f32 v245, v222, v223
  v_cvt_pk_bf16_f32 v246, v224, v225
  v_cvt_pk_bf16_f32 v247, v226, v227
  v_cvt_pk_bf16_f32 v248, v228, v229
  v_cvt_pk_bf16_f32 v249, v230, v231
  v_cvt_pk_bf16_f32 v250, v232, v233
  v_cvt_pk_bf16_f32 v251, v234, v235
  v_cvt_pk_bf16_f32 v80, v16, v17
  v_cvt_pk_bf16_f32 v81, v18, v19
  v_cvt_pk_bf16_f32 v82, v20, v21
  v_cvt_pk_bf16_f32 v83, v22, v23
  v_cvt_pk_bf16_f32 v84, v24, v25
  v_cvt_pk_bf16_f32 v85, v26, v27
  v_cvt_pk_bf16_f32 v86, v28, v29
  v_cvt_pk_bf16_f32 v87, v30, v31
  v_cvt_pk_bf16_f32 v88, v32, v33
  v_cvt_pk_bf16_f32 v89, v34, v35
  v_cvt_pk_bf16_f32 v90, v36, v37
  v_cvt_pk_bf16_f32 v91, v38, v39
  v_cvt_pk_bf16_f32 v92, v40, v41
  v_cvt_pk_bf16_f32 v93, v42, v43
  v_cvt_pk_bf16_f32 v94, v44, v45
  v_cvt_pk_bf16_f32 v95, v46, v47
  s_nop 1
  v_mfma_f32_32x32x16_bf16 v[16:31], v[236:239], v[80:83], 0
  v_mfma_f32_32x32x16_bf16 v[32:47], v[240:243], v[84:87], 0
  v_mfma_f32_32x32x16_bf16 v[48:63], v[236:239], v[88:91], 0
  v_mfma_f32_32x32x16_bf16 v[64:79], v[240:243], v[92:95], 0
  v_mfma_f32_32x32x16_bf16 v[16:31], v[244:247], v[80:83], v[16:31]
  v_mfma_f32_32x32x16_bf16 v[32:47], v[248:251], v[84:87], v[32:47]
  v_mfma_f32_32x32x16_bf16 v[48:63], v[244:247], v[88:91], v[48:63]
  v_mfma_f32_32x32x16_bf16 v[64:79], v[248:251], v[92:95], v[64:79]
  s_nop 8
  v_exp_f32 v16, v16
  v_exp_f32 v32, v32
  v_exp_f32 v48, v48
  v_exp_f32 v64, v64
  v_exp_f32 v17, v17
  v_exp_f32 v33, v33
  v_exp_f32 v49, v49
  v_exp_f32 v65, v65
  v_exp_f32 v18, v18
  v_exp_f32 v34, v34
  v_exp_f32 v50, v50
  v_exp_f32 v66, v66
  v_exp_f32 v19, v19
  v_exp_f32 v35, v35
  v_exp_f32 v51, v51
  v_exp_f32 v67, v67
  v_exp_f32 v20, v20
  v_exp_f32 v36, v36
  v_exp_f32 v52, v52
  v_exp_f32 v68, v68
  v_exp_f32 v21, v21
  v_exp_f32 v37, v37
  v_exp_f32 v53, v53
  v_exp_f32 v69, v69
  v_exp_f32 v22, v22
  v_exp_f32 v38, v38
  v_exp_f32 v54, v54
  v_exp_f32 v70, v70
  v_exp_f32 v23, v23
  v_exp_f32 v39, v39
  v_exp_f32 v55, v55
  v_exp_f32 v71, v71
  v_exp_f32 v24, v24
  v_exp_f32 v40, v40
  v_exp_f32 v56, v56
  v_exp_f32 v72, v72
  v_exp_f32 v25, v25
  v_exp_f32 v41, v41
  v_exp_f32 v57, v57
  v_exp_f32 v73, v73
  v_exp_f32 v26, v26
  v_exp_f32 v42, v42
  v_exp_f32 v58, v58
  v_exp_f32 v74, v74
  v_exp_f32 v27, v27
  v_exp_f32 v43, v43
  v_exp_f32 v59, v59
  v_exp_f32 v75, v75
  v_exp_f32 v28, v28
  v_exp_f32 v44, v44
  v_exp_f32 v60, v60
  v_exp_f32 v76, v76
  v_exp_f32 v29, v29
  v_exp_f32 v45, v45
  v_exp_f32 v61, v61
  v_exp_f32 v77, v77
  v_exp_f32 v30, v30
  v_exp_f32 v46, v46
  v_exp_f32 v62, v62
  v_exp_f32 v78, v78
  v_exp_f32 v31, v31
  v_exp_f32 v47, v47
  v_exp_f32 v63, v63
  v_exp_f32 v79, v79
  v_pk_add_f32 v[144:145], v[16:17], v[18:19]
  v_pk_add_f32 v[148:149], v[32:33], v[34:35]
  v_pk_add_f32 v[152:153], v[48:49], v[50:51]
  v_pk_add_f32 v[156:157], v[64:65], v[66:67]
  v_pk_add_f32 v[146:147], v[24:25], v[26:27]
  v_pk_add_f32 v[150:151], v[40:41], v[42:43]
  v_pk_add_f32 v[154:155], v[56:57], v[58:59]
  v_pk_add_f32 v[158:159], v[72:73], v[74:75]
  v_pk_add_f32 v[144:145], v[144:145], v[20:21]
  v_pk_add_f32 v[148:149], v[148:149], v[36:37]
  v_pk_add_f32 v[152:153], v[152:153], v[52:53]
  v_pk_add_f32 v[156:157], v[156:157], v[68:69]
  v_pk_add_f32 v[146:147], v[146:147], v[28:29]
  v_pk_add_f32 v[150:151], v[150:151], v[44:45]
  v_pk_add_f32 v[154:155], v[154:155], v[60:61]
  v_pk_add_f32 v[158:159], v[158:159], v[76:77]
  v_pk_add_f32 v[144:145], v[144:145], v[22:23]
  v_pk_add_f32 v[148:149], v[148:149], v[38:39]
  v_pk_add_f32 v[152:153], v[152:153], v[54:55]
  v_pk_add_f32 v[156:157], v[156:157], v[70:71]
  v_pk_add_f32 v[146:147], v[146:147], v[30:31]
  v_pk_add_f32 v[150:151], v[150:151], v[46:47]
  v_pk_add_f32 v[154:155], v[154:155], v[62:63]
  v_pk_add_f32 v[158:159], v[158:159], v[78:79]
  v_add_f32 v144, v144, v145
  v_add_f32 v148, v148, v149
  v_add_f32 v152, v152, v153
  v_add_f32 v156, v156, v157
  v_add_f32 v145, v146, v147
  v_add_f32 v149, v150, v151
  v_add_f32 v153, v154, v155
  v_add_f32 v157, v158, v159
  v_permlane32_swap_b32 v144, v145
  v_permlane32_swap_b32 v148, v149
  v_permlane32_swap_b32 v152, v153
  v_permlane32_swap_b32 v156, v157
  v_add_f32 v144, v144, v145
  v_add_f32 v148, v148, v149
  v_add_f32 v152, v152, v153
  v_add_f32 v156, v156, v157
  v_max3_f32 v145, v144, v148, v152
  v_max_f32 v145, v145, v156
  v_cmp_lt_f32 vcc, s57, v145
  s_cbranch_vccnz FMq
FMDq:
  v_rcp_f32 v144, v144
  v_rcp_f32 v148, v148
  v_rcp_f32 v152, v152
  v_rcp_f32 v156, v156
  v_mov_b32 v146, v144
  v_mov_b32 v150, v148
  v_mov_b32 v154, v152
  v_mov_b32 v158, v156
  v_permlane32_swap_b32 v144, v146
  v_permlane32_swap_b32 v148, v150
  v_permlane32_swap_b32 v152, v154
  v_permlane32_swap_b32 v156, v158
  v_pk_mul_f32 v[16:17], v[16:17], v[144:145] op_sel_hi:[1,0]
  v_pk_mul_f32 v[18:19], v[18:19], v[144:145] op_sel_hi:[1,0]
  v_pk_mul_f32 v[20:21], v[20:21], v[144:145] op_sel_hi:[1,0]
  v_pk_mul_f32 v[22:23], v[22:23], v[144:145] op_sel_hi:[1,0]
  v_pk_mul_f32 v[24:25], v[24:25], v[146:147] op_sel_hi:[1,0]
  v_pk_mul_f32 v[26:27], v[26:27], v[146:147] op_sel_hi:[1,0]
  v_pk_mul_f32 v[28:29], v[28:29], v[146:147] op_sel_hi:[1,0]
  v_pk_mul_f32 v[30:31], v[30:31], v[146:147] op_sel_hi:[1,0]
  v_cvt_pk_bf16_f32 v112, v16, v17
  v_cvt_pk_bf16_f32 v113, v18, v19
  v_cvt_pk_bf16_f32 v114, v20, v21
  v_cvt_pk_bf16_f32 v115, v22, v23
  v_cvt_pk_bf16_f32 v116, v24, v25
  v_cvt_pk_bf16_f32 v117, v26, v27
  v_cvt_pk_bf16_f32 v118, v28, v29
  v_cvt_pk_bf16_f32 v119, v30, v31
  buffer_load_dwordx4 v[172:175], v170, s[32:35], s10 offen offset:0 sc1
  buffer_load_dwordx4 v[176:179], v170, s[32:35], s10 offen offset:640 sc1
  buffer_load_dwordx4 v[180:183], v170, s[32:35], s10 offen offset:1280 sc1
  buffer_load_dwordx4 v[184:187], v170, s[32:35], s10 offen offset:1920 sc1
  buffer_load_dwordx4 v[188:191], v170, s[32:35], s10 offen offset:2560 sc1
  buffer_load_dwordx4 v[192:195], v170, s[32:35], s10 offen offset:3200 sc1
  v_pk_mul_f32 v[32:33], v[32:33], v[148:149] op_sel_hi:[1,0]
  v_pk_mul_f32 v[34:35], v[34:35], v[148:149] op_sel_hi:[1,0]
  v_pk_mul_f32 v[36:37], v[36:37], v[148:149] op_sel_hi:[1,0]
  v_pk_mul_f32 v[38:39], v[38:39], v[148:149] op_sel_hi:[1,0]
  v_pk_mul_f32 v[40:41], v[40:41], v[150:151] op_sel_hi:[1,0]
  v_pk_mul_f32 v[42:43], v[42:43], v[150:151] op_sel_hi:[1,0]
  v_pk_mul_f32 v[44:45], v[44:45], v[150:151] op_sel_hi:[1,0]
  v_pk_mul_f32 v[46:47], v[46:47], v[150:151] op_sel_hi:[1,0]
  v_cvt_pk_bf16_f32 v120, v32, v33
  v_cvt_pk_bf16_f32 v121, v34, v35
  v_cvt_pk_bf16_f32 v122, v36, v37
  v_cvt_pk_bf16_f32 v123, v38, v39
  v_cvt_pk_bf16_f32 v124, v40, v41
  v_cvt_pk_bf16_f32 v125, v42, v43
  v_cvt_pk_bf16_f32 v126, v44, v45
  v_cvt_pk_bf16_f32 v127, v46, v47
  v_pk_mul_f32 v[48:49], v[48:49], v[152:153] op_sel_hi:[1,0]
  v_pk_mul_f32 v[50:51], v[50:51], v[152:153] op_sel_hi:[1,0]
  v_pk_mul_f32 v[52:53], v[52:53], v[152:153] op_sel_hi:[1,0]
  v_pk_mul_f32 v[54:55], v[54:55], v[152:153] op_sel_hi:[1,0]
  v_pk_mul_f32 v[56:57], v[56:57], v[154:155] op_sel_hi:[1,0]
  v_pk_mul_f32 v[58:59], v[58:59], v[154:155] op_sel_hi:[1,0]
  v_pk_mul_f32 v[60:61], v[60:61], v[154:155] op_sel_hi:[1,0]
  v_pk_mul_f32 v[62:63], v[62:63], v[154:155] op_sel_hi:[1,0]
  v_cvt_pk_bf16_f32 v128, v48, v49
  v_cvt_pk_bf16_f32 v129, v50, v51
  v_cvt_pk_bf16_f32 v130, v52, v53
  v_cvt_pk_bf16_f32 v131, v54, v55
  v_cvt_pk_bf16_f32 v132, v56, v57
  v_cvt_pk_bf16_f32 v133, v58, v59
  v_cvt_pk_bf16_f32 v134, v60, v61
  v_cvt_pk_bf16_f32 v135, v62, v63
  v_pk_mul_f32 v[64:65], v[64:65], v[156:157] op_sel_hi:[1,0]
  v_pk_mul_f32 v[66:67], v[66:67], v[156:157] op_sel_hi:[1,0]
  v_pk_mul_f32 v[68:69], v[68:69], v[156:157] op_sel_hi:[1,0]
  v_pk_mul_f32 v[70:71], v[70:71], v[156:157] op_sel_hi:[1,0]
  v_pk_mul_f32 v[72:73], v[72:73], v[158:159] op_sel_hi:[1,0]
  v_pk_mul_f32 v[74:75], v[74:75], v[158:159] op_sel_hi:[1,0]
  v_pk_mul_f32 v[76:77], v[76:77], v[158:159] op_sel_hi:[1,0]
  v_pk_mul_f32 v[78:79], v[78:79], v[158:159] op_sel_hi:[1,0]
  v_cvt_pk_bf16_f32 v136, v64, v65
  v_cvt_pk_bf16_f32 v137, v66, v67
  v_cvt_pk_bf16_f32 v138, v68, v69
  v_cvt_pk_bf16_f32 v139, v70, v71
  v_cvt_pk_bf16_f32 v140, v72, v73
  v_cvt_pk_bf16_f32 v141, v74, v75
  v_cvt_pk_bf16_f32 v142, v76, v77
  v_cvt_pk_bf16_f32 v143, v78, v79
  s_lshl_b32 s5, s22, 12
  s_add_u32 s80, s61, s5
  s_xor_b32 s81, s80, 4096
  s_xor_b32 s82, s80, 8192
  s_xor_b32 s83, s80, 12288
  s_xor_b32 s84, s80, 16384
  s_xor_b32 s85, s80, 20480
  s_xor_b32 s86, s80, 24576
  s_xor_b32 s87, s80, 28672
  s_bfe_u32 s5, s12, 0x2000f
  s_and_b32 s6, s12, 0xc00
  v_lshl_add_u32 v2, s5, 12, v1
  s_and_b32 s5, s23, 3
  v_add_u32 v2, s6, v2
  v_lshl_add_u32 v3, s5, 12, v1
  s_branch L_A3
PE6:
.p2align 12
PG7:
WA:
  s_branch WA2
M_A2:
  v_exp_f32 v206, v206
  v_exp_f32 v207, v207
  v_mfma_f32_32x32x16_bf16 v[112:127], v[236:239], v[176:179], 0
  s_not_b64 exec, s[58:59]
  v_cvt_pk_bf16_f32 v32, v80, v81
  v_cvt_pk_bf16_f32 v33, v82, v83
  v_cvt_pk_bf16_f32 v34, v84, v85
  v_cvt_pk_bf16_f32 v35, v86, v87
  v_cvt_pk_bf16_f32 v36, v88, v89
  v_cvt_pk_bf16_f32 v37, v90, v91
  v_cvt_pk_bf16_f32 v38, v92, v93
  s_mov_b64 exec, -1
  v_mfma_f32_32x32x16_bf16 v[112:127], v[244:247], v[176:179], v[112:127]
  s_not_b64 exec, s[58:59]
  v_cvt_pk_bf16_f32 v39, v94, v95
  v_cvt_pk_bf16_f32 v40, v96, v97
  v_cvt_pk_bf16_f32 v41, v98, v99
  v_cvt_pk_bf16_f32 v42, v100, v101
  v_cvt_pk_bf16_f32 v43, v102, v103
  v_cvt_pk_bf16_f32 v44, v104, v105
  v_cvt_pk_bf16_f32 v45, v106, v107
  v_cvt_pk_bf16_f32 v46, v108, v109
  v_cvt_pk_bf16_f32 v47, v110, v111
  s_mov_b64 exec, -1
  v_mfma_f32_32x32x16_bf16 v[144:159], v[236:239], v[184:187], 0
  s_mov_b64 exec, s[58:59]
  v_cvt_pk_bf16_f32 v16, v80, v81
  v_cvt_pk_bf16_f32 v17, v82, v83
  v_cvt_pk_bf16_f32 v18, v84, v85
  v_cvt_pk_bf16_f32 v19, v86, v87
  v_cvt_pk_bf16_f32 v20, v88, v89
  v_cvt_pk_bf16_f32 v21, v90, v91
  v_cvt_pk_bf16_f32 v22, v92, v93
  s_mov_b64 exec, -1
  v_mfma_f32_32x32x16_bf16 v[144:159], v[244:247], v[184:187], v[144:159]
  s_mov_b64 exec, s[58:59]
  v_cvt_pk_bf16_f32 v23, v94, v95
  v_cvt_pk_bf16_f32 v24, v96, v97
  v_cvt_pk_bf16_f32 v25, v98, v99
  v_cvt_pk_bf16_f32 v26, v100, v101
  v_cvt_pk_bf16_f32 v27, v102, v103
  v_cvt_pk_bf16_f32 v28, v104, v105
  v_cvt_pk_bf16_f32 v29, v106, v107
  v_cvt_pk_bf16_f32 v30, v108, v109
  v_cvt_pk_bf16_f32 v31, v110, v111
  s_mov_b64 exec, -1
  v_pk_add_f32 v[84:85], v[220:221], v[222:223]
  v_pk_add_f32 v[92:93], v[192:193], v[194:195]
  v_pk_add_f32 v[86:87], v[228:229], v[230:231]
  v_pk_add_f32 v[94:95], v[200:201], v[202:203]
  v_pk_add_f32 v[84:85], v[84:85], v[224:225]
  v_pk_add_f32 v[92:93], v[92:93], v[196:197]
  v_pk_add_f32 v[86:87], v[86:87], v[232:233]
  v_pk_add_f32 v[94:95], v[94:95], v[204:205]
  v_pk_add_f32 v[84:85], v[84:85], v[226:227]
  v_pk_add_f32 v[92:93], v[92:93], v[198:199]
  v_pk_add_f32 v[86:87], v[86:87], v[234:235]
  v_pk_add_f32 v[94:95], v[94:95], v[206:207]
  v_add_f32 v84, v84, v85
  v_add_f32 v92, v92, v93
  v_add_f32 v85, v86, v87
  v_add_f32 v93, v94, v95
  s_nop 0
  v_permlane32_swap_b32 v84, v85
  v_permlane32_swap_b32 v92, v93
  s_nop 0
  v_add_f32 v84, v84, v85
  v_add_f32 v92, v92, v93
  v_max_f32 v85, v84, v92
  v_cmp_lt_f32 vcc, s57, v85
  s_cbranch_vccnz FMk
FMDk:
  v_rcp_f32 v84, v84
  v_rcp_f32 v92, v92
  v_mov_b32 v86, v84
  v_mov_b32 v94, v92
  s_nop 0
  v_permlane32_swap_b32 v84, v86
  v_permlane32_swap_b32 v92, v94
  s_nop 0
  v_mul_f32 v220, v220, v84
  v_mul_f32 v221, v221, v84
  v_mul_f32 v222, v222, v84
  v_mul_f32 v223, v223, v84
  v_mul_f32 v224, v224, v84
  v_mul_f32 v225, v225, v84
  v_mul_f32 v226, v226, v84
  v_mul_f32 v227, v227, v84
  v_cvt_pk_bf16_f32 v220, v220, v221
  v_cvt_pk_bf16_f32 v221, v222, v223
  v_cvt_pk_bf16_f32 v222, v224, v225
  v_cvt_pk_bf16_f32 v223, v226, v227
  v_mul_f32 v228, v228, v86
  v_mul_f32 v229, v229, v86
  v_mfma_f32_32x32x16_bf16 v[48:63], v[220:223], v[168:171], 0
  v_mul_f32 v230, v230, v86
  v_mul_f32 v231, v231, v86
  v_mul_f32 v232, v232, v86
  v_mul_f32 v233, v233, v86
  v_mul_f32 v234, v234, v86
  v_mul_f32 v235, v235, v86
  v_cvt_pk_bf16_f32 v224, v228, v229
  v_cvt_pk_bf16_f32 v225, v230, v231
  v_cvt_pk_bf16_f32 v226, v232, v233
  v_cvt_pk_bf16_f32 v227, v234, v235
  v_mul_f32 v192, v192, v92
  v_mul_f32 v193, v193, v92
  v_mfma_f32_32x32x16_bf16 v[48:63], v[224:227], v[172:175], v[48:63]
  v_mul_f32 v194, v194, v92
  v_mul_f32 v195, v195, v92
  v_mul_f32 v196, v196, v92
  v_mul_f32 v197, v197, v92
  v_mul_f32 v198, v198, v92
  v_mul_f32 v199, v199, v92
  v_cvt_pk_bf16_f32 v192, v192, v193
  v_cvt_pk_bf16_f32 v193, v194, v195
  v_cvt_pk_bf16_f32 v194, v196, v197
  v_cvt_pk_bf16_f32 v195, v198, v199
  v_mul_f32 v200, v200, v94
  v_mul_f32 v201, v201, v94
  v_mfma_f32_32x32x16_bf16 v[64:79], v[192:195], v[168:171], 0
  v_mul_f32 v202, v202, v94
  v_mul_f32 v203, v203, v94
  v_mul_f32 v204, v204, v94
  v_mul_f32 v205, v205, v94
  v_mul_f32 v206, v206, v94
  v_mul_f32 v207, v207, v94
  v_cvt_pk_bf16_f32 v196, v200, v201
  v_cvt_pk_bf16_f32 v197, v202, v203
  v_cvt_pk_bf16_f32 v198, v204, v205
  v_cvt_pk_bf16_f32 v199, v206, v207
  v_cvt_pk_bf16_f32 v48, v48, v49
  v_cvt_pk_bf16_f32 v49, v50, v51
  v_mfma_f32_32x32x16_bf16 v[64:79], v[196:199], v[172:175], v[64:79]
  v_cvt_pk_bf16_f32 v50, v52, v53
  v_cvt_pk_bf16_f32 v51, v54, v55
  v_cvt_pk_bf16_f32 v52, v56, v57
  v_cvt_pk_bf16_f32 v53, v58, v59
  v_cvt_pk_bf16_f32 v54, v60, v61
  v_cvt_pk_bf16_f32 v55, v62, v63
  buffer_load_dword v213, v213, s[32:35], 0 offen
  v_exp_f32 v112, v112
  v_exp_f32 v113, v113
  v_mfma_f32_32x32x16_bf16 v[96:111], v[48:51], v[32:35], 0
  v_exp_f32 v114, v114
  v_exp_f32 v115, v115
  v_exp_f32 v116, v116
  v_exp_f32 v117, v117
  v_mfma_f32_32x32x16_bf16 v[96:111], v[52:55], v[36:39], v[96:111]
  v_cvt_pk_bf16_f32 v64, v64, v65
  v_cvt_pk_bf16_f32 v65, v66, v67
  v_cvt_pk_bf16_f32 v66, v68, v69
  v_cvt_pk_bf16_f32 v67, v70, v71
  v_cvt_pk_bf16_f32 v68, v72, v73
  v_cvt_pk_bf16_f32 v69, v74, v75
  v_cvt_pk_bf16_f32 v70, v76, v77
  v_cvt_pk_bf16_f32 v71, v78, v79
  v_exp_f32 v118, v118
  v_exp_f32 v119, v119
  v_mfma_f32_32x32x16_bf16 v[96:111], v[64:67], v[40:43], v[96:111]
  v_exp_f32 v120, v120
  v_exp_f32 v121, v121
  v_exp_f32 v122, v122
  v_exp_f32 v123, v123
  v_mfma_f32_32x32x16_bf16 v[96:111], v[68:71], v[44:47], v[96:111]
  v_exp_f32 v124, v124
  v_exp_f32 v125, v125
  v_exp_f32 v126, v126
  v_exp_f32 v127, v127
  v_exp_f32 v144, v144
  v_exp_f32 v145, v145
  v_exp_f32 v146, v146
  v_exp_f32 v147, v147
  v_exp_f32 v148, v148
  v_exp_f32 v149, v149
  v_exp_f32 v150, v150
  v_exp_f32 v151, v151
  ds_write_b128 v208, v[96:99] offset:0
  v_exp_f32 v152, v152
  v_exp_f32 v153, v153
  ds_write_b128 v208, v[100:103] offset:1024
  v_exp_f32 v154, v154
  v_exp_f32 v155, v155
  ds_write_b128 v208, v[104:107] offset:2048
  v_exp_f32 v156, v156
  v_exp_f32 v157, v157
  ds_write_b128 v208, v[108:111] offset:3072
  v_exp_f32 v158, v158
  v_exp_f32 v159, v159
  v_pk_add_f32 v[80:81], v[112:113], v[114:115]
  v_pk_add_f32 v[88:89], v[144:145], v[146:147]
  v_pk_add_f32 v[82:83], v[120:121], v[122:123]
  v_pk_add_f32 v[90:91], v[152:153], v[154:155]
  v_pk_add_f32 v[80:81], v[80:81], v[116:117]
  v_pk_add_f32 v[88:89], v[88:89], v[148:149]
  v_pk_add_f32 v[82:83], v[82:83], v[124:125]
  v_pk_add_f32 v[90:91], v[90:91], v[156:157]
  v_pk_add_f32 v[80:81], v[80:81], v[118:119]
  v_pk_add_f32 v[88:89], v[88:89], v[150:151]
  v_pk_add_f32 v[82:83], v[82:83], v[126:127]
  v_pk_add_f32 v[90:91], v[90:91], v[158:159]
  v_add_f32 v80, v80, v81
  v_add_f32 v88, v88, v89
  v_add_f32 v81, v82, v83
  v_add_f32 v89, v90, v91
  s_nop 0
  v_permlane32_swap_b32 v80, v81
  v_permlane32_swap_b32 v88, v89
  s_nop 0
  v_add_f32 v80, v80, v81
  v_add_f32 v88, v88, v89
  v_max_f32 v81, v80, v88
  v_cmp_lt_f32 vcc, s57, v81
  s_cbranch_vccnz FMl
FMDl:
  v_rcp_f32 v80, v80
  v_rcp_f32 v88, v88
  v_mov_b32 v82, v80
  v_mov_b32 v90, v88
  s_nop 0
  v_permlane32_swap_b32 v80, v82
  v_permlane32_swap_b32 v88, v90
  s_nop 0
  s_waitcnt lgkmcnt(0)
  s_barrier
  ds_read_b128 v[128:131], v209 offset:0
  ds_read_b128 v[132:135], v209 offset:1024
  ds_read_b128 v[136:139], v209 offset:2048
  ds_read_b128 v[140:143], v209 offset:3072
  v_mul_f32 v112, v112, v80
  v_mul_f32 v113, v113, v80
  v_mul_f32 v114, v114, v80
  v_mul_f32 v115, v115, v80
  v_mul_f32 v116, v116, v80
  v_mul_f32 v117, v117, v80
  v_mul_f32 v118, v118, v80
  v_mul_f32 v119, v119, v80
  v_cvt_pk_bf16_f32 v112, v112, v113
  v_cvt_pk_bf16_f32 v113, v114, v115
  v_cvt_pk_bf16_f32 v114, v116, v117
  v_cvt_pk_bf16_f32 v115, v118, v119
  v_mul_f32 v120, v120, v82
  v_mul_f32 v121, v121, v82
  v_mfma_f32_32x32x16_bf16 v[48:63], v[112:115], v[168:171], 0
  v_mul_f32 v122, v122, v82
  v_mul_f32 v123, v123, v82
  v_mul_f32 v124, v124, v82
  v_mul_f32 v125, v125, v82
  v_mul_f32 v126, v126, v82
  v_mul_f32 v127, v127, v82
  v_cvt_pk_bf16_f32 v116, v120, v121
  v_cvt_pk_bf16_f32 v117, v122, v123
  v_cvt_pk_bf16_f32 v118, v124, v125
  v_cvt_pk_bf16_f32 v119, v126, v127
  v_mul_f32 v144, v144, v88
  v_mul_f32 v145, v145, v88
  v_mfma_f32_32x32x16_bf16 v[48:63], v[116:119], v[172:175], v[48:63]
  v_mul_f32 v146, v146, v88
  v_mul_f32 v147, v147, v88
  v_mul_f32 v148, v148, v88
  v_mul_f32 v149, v149, v88
  v_mul_f32 v150, v150, v88
  v_mul_f32 v151, v151, v88
  v_cvt_pk_bf16_f32 v144, v144, v145
  v_cvt_pk_bf16_f32 v145, v146, v147
  v_cvt_pk_bf16_f32 v146, v148, v149
  v_cvt_pk_bf16_f32 v147, v150, v151
  v_mul_f32 v152, v152, v90
  v_mul_f32 v153, v153, v90
  v_mfma_f32_32x32x16_bf16 v[64:79], v[144:147], v[168:171], 0
  v_mul_f32 v154, v154, v90
  v_mul_f32 v155, v155, v90
  v_mul_f32 v156, v156, v90
  v_mul_f32 v157, v157, v90
  v_mul_f32 v158, v158, v90
  v_mul_f32 v159, v159, v90
  v_cvt_pk_bf16_f32 v148, v152, v153
  v_cvt_pk_bf16_f32 v149, v154, v155
  v_cvt_pk_bf16_f32 v150, v156, v157
  v_cvt_pk_bf16_f32 v151, v158, v159
  v_cvt_pk_bf16_f32 v48, v48, v49
  v_cvt_pk_bf16_f32 v49, v50, v51
  v_mfma_f32_32x32x16_bf16 v[64:79], v[148:151], v[172:175], v[64:79]
  v_cvt_pk_bf16_f32 v50, v52, v53
  v_cvt_pk_bf16_f32 v51, v54, v55
  v_cvt_pk_bf16_f32 v52, v56, v57
  v_cvt_pk_bf16_f32 v53, v58, v59
  v_cvt_pk_bf16_f32 v54, v60, v61
  v_cvt_pk_bf16_f32 v55, v62, v63
  s_waitcnt lgkmcnt(0)
  v_mov_b32 v115, v253
  v_mov_b32 v119, v253
  v_mfma_f32_32x32x16_bf16 v[128:143], v[48:51], v[16:19], v[128:143]
  v_mov_b32 v122, v253
  v_mov_b32 v123, v253
  v_cvt_pk_bf16_f32 v64, v64, v65
  v_cvt_pk_bf16_f32 v65, v66, v67
  v_cvt_pk_bf16_f32 v66, v68, v69
  v_cvt_pk_bf16_f32 v67, v70, v71
  v_mfma_f32_32x32x16_bf16 v[128:143], v[52:55], v[20:23], v[128:143]
  v_cvt_pk_bf16_f32 v68, v72, v73
  v_cvt_pk_bf16_f32 v69, v74, v75
  v_mfma_f32_32x32x16_bf16 v[128:143], v[64:67], v[24:27], v[128:143]
  v_cvt_pk_bf16_f32 v70, v76, v77
  v_cvt_pk_bf16_f32 v71, v78, v79
  s_nop 1
  v_mfma_f32_32x32x16_bf16 v[128:143], v[68:71], v[28:31], v[128:143]
  s_mov_b64 exec, s[10:11]
  s_nop 10
  v_cvt_pk_bf16_f32 v112, v128, v129
  v_cvt_pk_bf16_f32 v113, v130, v131
  v_cvt_pk_bf16_f32 v114, v132, v133
  v_cvt_pk_bf16_f32 v120, v134, v135
  v_cvt_pk_bf16_f32 v116, v136, v137
  v_cvt_pk_bf16_f32 v117, v138, v139
  v_cvt_pk_bf16_f32 v118, v140, v141
  v_cvt_pk_bf16_f32 v121, v142, v143
  buffer_store_dwordx4 v[112:115], v210, s[32:35], s12 offen sc1
  buffer_store_dwordx4 v[116:119], v210, s[32:35], s13 offen sc1
  buffer_store_dwordx4 v[120:123], v210, s[32:35], s14 offen sc1
  s_mov_b64 exec, -1
  buffer_load_dword v15, v212, s[40:43], s62 offen offset:384
  s_barrier
  s_add_u32 m0, s99, 98304
  s_xor_b32 s5, s53, 0
  buffer_load_dwordx4 v211, s[40:43], s5 offen lds
  s_add_u32 m0, s99, 102400
  s_xor_b32 s5, s53, 32768
  buffer_load_dwordx4 v211, s[40:43], s5 offen lds
  s_add_u32 m0, s99, 106496
  s_xor_b32 s5, s53, 65536
  buffer_load_dwordx4 v211, s[40:43], s5 offen lds
  s_add_u32 m0, s99, 110592
  s_xor_b32 s5, s53, 98304
  buffer_load_dwordx4 v211, s[40:43], s5 offen lds
  s_add_u32 m0, s99, 114688
  s_xor_b32 s5, s53, 131072
  buffer_load_dwordx4 v211, s[40:43], s5 offen lds
  s_add_u32 m0, s99, 118784
  s_xor_b32 s5, s53, 163840
  buffer_load_dwordx4 v211, s[40:43], s5 offen lds
  s_add_u32 m0, s99, 122880
  s_xor_b32 s5, s53, 196608
  buffer_load_dwordx4 v211, s[40:43], s5 offen lds
  s_add_u32 m0, s99, 126976
  s_xor_b32 s5, s53, 229376
  buffer_load_dwordx4 v211, s[40:43], s5 offen lds
  s_add_u32 m0, s99, 131072
  s_xor_b32 s5, s53, 262144
  buffer_load_dwordx4 v211, s[40:43], s5 offen lds
  s_add_u32 m0, s99, 135168
  s_xor_b32 s5, s53, 294912
  buffer_load_dwordx4 v211, s[40:43], s5 offen lds
  s_add_u32 m0, s99, 139264
  s_xor_b32 s5, s53, 327680
  buffer_load_dwordx4 v211, s[40:43], s5 offen lds
  s_add_u32 m0, s99, 143360
  s_xor_b32 s5, s53, 360448
  buffer_load_dwordx4 v211, s[40:43], s5 offen lds
  s_add_u32 m0, s99, 147456
  s_xor_b32 s5, s53, 393216
  buffer_load_dwordx4 v211, s[40:43], s5 offen lds
  s_add_u32 m0, s99, 151552
  s_xor_b32 s5, s53, 425984
  buffer_load_dwordx4 v211, s[40:43], s5 offen lds
  s_add_u32 m0, s99, 155648
  s_xor_b32 s5, s53, 458752
  buffer_load_dwordx4 v211, s[40:43], s5 offen lds
  s_add_u32 m0, s99, 159744
  s_xor_b32 s5, s53, 491520
  buffer_load_dwordx4 v211, s[40:43], s5 offen lds
  s_cmp_eq_u32 s23, 3
  s_cbranch_scc1 M_A4
  s_mov_b64 exec, s[10:11]
  v_mov_b32 v80, 0
  v_mov_b32 v81, 0
  v_mov_b32 v82, 0
  v_mov_b32 v83, 0
  v_mov_b32 v84, 0
  v_mov_b32 v85, 0
  s_mov_b32 s8, 0x00003f80
  s_mov_b32 s9, 0x3f800000
  s_waitcnt vmcnt(17)
  s_mov_b32 s12, s15
  s_add_u32 s13, s15, 3840
  s_add_u32 s14, s15, 7680
  buffer_load_dwordx4 v[144:147], v210, s[32:35], s12 offen offset:0 sc1
  buffer_load_dwordx4 v[148:151], v210, s[32:35], s12 offen offset:640 sc1
  buffer_load_dwordx4 v[152:155], v210, s[32:35], s12 offen offset:1280 sc1
  buffer_load_dwordx4 v[156:159], v210, s[32:35], s12 offen offset:1920 sc1
  buffer_load_dwordx4 v[160:163], v210, s[32:35], s12 offen offset:2560 sc1
  buffer_load_dwordx4 v[164:167], v210, s[32:35], s12 offen offset:3200 sc1
  buffer_load_dwordx4 v[168:171], v210, s[32:35], s13 offen offset:0 sc1
  buffer_load_dwordx4 v[172:175], v210, s[32:35], s13 offen offset:640 sc1
  buffer_load_dwordx4 v[176:179], v210, s[32:35], s13 offen offset:1280 sc1
  buffer_load_dwordx4 v[180:183], v210, s[32:35], s13 offen offset:1920 sc1
  buffer_load_dwordx4 v[184:187], v210, s[32:35], s13 offen offset:2560 sc1
  buffer_load_dwordx4 v[188:191], v210, s[32:35], s13 offen offset:3200 sc1
  buffer_load_dwordx4 v[192:195], v210, s[32:35], s14 offen offset:0 sc1
  buffer_load_dwordx4 v[196:199], v210, s[32:35], s14 offen offset:640 sc1
  buffer_load_dwordx4 v[200:203], v210, s[32:35], s14 offen offset:1280 sc1
  buffer_load_dwordx4 v[204:207], v210, s[32:35], s14 offen offset:1920 sc1
  s_mov_b32 s7, 4000
  s_branch TP_C4
TP_L4:
  s_sleep 1
  s_cmp_lg_u64 s[64:65], 0
  s_cselect_b64 exec, s[10:11], 0
  buffer_load_dwordx4 v[144:147], v210, s[32:35], s12 offen offset:0 sc1
  s_cmp_lg_u64 s[66:67], 0
  s_cselect_b64 exec, s[10:11], 0
  buffer_load_dwordx4 v[148:151], v210, s[32:35], s12 offen offset:640 sc1
  s_cmp_lg_u64 s[68:69], 0
  s_cselect_b64 exec, s[10:11], 0
  buffer_load_dwordx4 v[152:155], v210, s[32:35], s12 offen offset:1280 sc1
  s_cmp_lg_u64 s[70:71], 0
  s_cselect_b64 exec, s[10:11], 0
  buffer_load_dwordx4 v[156:159], v210, s[32:35], s12 offen offset:1920 sc1
  s_cmp_lg_u64 s[72:73], 0
  s_cselect_b64 exec, s[10:11], 0
  buffer_load_dwordx4 v[160:163], v210, s[32:35], s12 offen offset:2560 sc1
  s_cmp_lg_u64 s[74:75], 0
  s_cselect_b64 exec, s[10:11], 0
  buffer_load_dwordx4 v[164:167], v210, s[32:35], s12 offen offset:3200 sc1
  s_cmp_lg_u64 s[76:77], 0
  s_cselect_b64 exec, s[10:11], 0
  buffer_load_dwordx4 v[168:171], v210, s[32:35], s13 offen offset:0 sc1
  s_cmp_lg_u64 s[78:79], 0
  s_cselect_b64 exec, s[10:11], 0
  buffer_load_dwordx4 v[172:175], v210, s[32:35], s13 offen offset:640 sc1
  s_cmp_lg_u64 s[80:81], 0
  s_cselect_b64 exec, s[10:11], 0
  buffer_load_dwordx4 v[176:179], v210, s[32:35], s13 offen offset:1280 sc1
  s_cmp_lg_u64 s[82:83], 0
  s_cselect_b64 exec, s[10:11], 0
  buffer_load_dwordx4 v[180:183], v210, s[32:35], s13 offen offset:1920 sc1
  s_cmp_lg_u64 s[84:85], 0
  s_cselect_b64 exec, s[10:11], 0
  buffer_load_dwordx4 v[184:187], v210, s[32:35], s13 offen offset:2560 sc1
  s_cmp_lg_u64 s[86:87], 0
  s_cselect_b64 exec, s[10:11], 0
  buffer_load_dwordx4 v[188:191], v210, s[32:35], s13 offen offset:3200 sc1
  s_cmp_lg_u64 s[88:89], 0
  s_cselect_b64 exec, s[10:11], 0
  buffer_load_dwordx4 v[192:195], v210, s[32:35], s14 offen offset:0 sc1
  s_cmp_lg_u64 s[90:91], 0
  s_cselect_b64 exec, s[10:11], 0
  buffer_load_dwordx4 v[196:199], v210, s[32:35], s14 offen offset:640 sc1
  s_cmp_lg_u64 s[92:93], 0
  s_cselect_b64 exec, s[10:11], 0
  buffer_load_dwordx4 v[200:203], v210, s[32:35], s14 offen offset:1280 sc1
  s_cmp_lg_u64 s[94:95], 0
  s_cselect_b64 exec, s[10:11], 0
  buffer_load_dwordx4 v[204:207], v210, s[32:35], s14 offen offset:1920 sc1
  s_mov_b64 exec, s[10:11]
  v_mov_b32 v80, 0
  v_mov_b32 v81, 0
  v_mov_b32 v82, 0
  v_mov_b32 v83, 0
  v_mov_b32 v84, 0
  v_mov_b32 v85, 0
  s_waitcnt vmcnt(0)
TP_C4:
  s_waitcnt vmcnt(15)
  v_cmp_ne_u32 s[64:65], s52, v147
  v_dot2c_f32_bf16 v80, s8, v144
  v_dot2c_f32_bf16 v81, s9, v144
  v_dot2c_f32_bf16 v82, s8, v145
  v_dot2c_f32_bf16 v83, s9, v145
  v_dot2c_f32_bf16 v84, s8, v146
  v_dot2c_f32_bf16 v85, s9, v146
  s_mov_b64 vcc, s[64:65]
  s_waitcnt vmcnt(14)
  v_cmp_ne_u32 s[66:67], s52, v151
  v_dot2c_f32_bf16 v80, s8, v148
  v_dot2c_f32_bf16 v81, s9, v148
  v_dot2c_f32_bf16 v82, s8, v149
  v_dot2c_f32_bf16 v83, s9, v149
  v_dot2c_f32_bf16 v84, s8, v150
  v_dot2c_f32_bf16 v85, s9, v150
  s_or_b64 vcc, vcc, s[66:67]
  s_waitcnt vmcnt(13)
  v_cmp_ne_u32 s[68:69], s52, v155
  v_dot2c_f32_bf16 v80, s8, v152
  v_dot2c_f32_bf16 v81, s9, v152
  v_dot2c_f32_bf16 v82, s8, v153
  v_dot2c_f32_bf16 v83, s9, v153
  v_dot2c_f32_bf16 v84, s8, v154
  v_dot2c_f32_bf16 v85, s9, v154
  s_or_b64 vcc, vcc, s[68:69]
  s_waitcnt vmcnt(12)
  v_cmp_ne_u32 s[70:71], s52, v159
  v_dot2c_f32_bf16 v80, s8, v156
  v_dot2c_f32_bf16 v81, s9, v156
  v_dot2c_f32_bf16 v82, s8, v157
  v_dot2c_f32_bf16 v83, s9, v157
  v_dot2c_f32_bf16 v84, s8, v158
  v_dot2c_f32_bf16 v85, s9, v158
  s_or_b64 vcc, vcc, s[70:71]
  s_waitcnt vmcnt(11)
  v_cmp_ne_u32 s[72:73], s52, v163
  v_dot2c_f32_bf16 v80, s8, v160
  v_dot2c_f32_bf16 v81, s9, v160
  v_dot2c_f32_bf16 v82, s8, v161
  v_dot2c_f32_bf16 v83, s9, v161
  v_dot2c_f32_bf16 v84, s8, v162
  v_dot2c_f32_bf16 v85, s9, v162
  s_or_b64 vcc, vcc, s[72:73]
  s_waitcnt vmcnt(10)
  v_cmp_ne_u32 s[74:75], s52, v167
  v_dot2c_f32_bf16 v80, s8, v164
  v_dot2c_f32_bf16 v81, s9, v164
  v_dot2c_f32_bf16 v82, s8, v165
  v_dot2c_f32_bf16 v83, s9, v165
  v_dot2c_f32_bf16 v84, s8, v166
  v_dot2c_f32_bf16 v85, s9, v166
  s_or_b64 vcc, vcc, s[74:75]
  s_waitcnt vmcnt(9)
  v_cmp_ne_u32 s[76:77], s52, v171
  v_dot2c_f32_bf16 v80, s8, v168
  v_dot2c_f32_bf16 v81, s9, v168
  v_dot2c_f32_bf16 v82, s8, v169
  v_dot2c_f32_bf16 v83, s9, v169
  v_dot2c_f32_bf16 v84, s8, v170
  v_dot2c_f32_bf16 v85, s9, v170
  s_or_b64 vcc, vcc, s[76:77]
  s_waitcnt vmcnt(8)
  v_cmp_ne_u32 s[78:79], s52, v175
  v_dot2c_f32_bf16 v80, s8, v172
  v_dot2c_f32_bf16 v81, s9, v172
  v_dot2c_f32_bf16 v82, s8, v173
  v_dot2c_f32_bf16 v83, s9, v173
  v_dot2c_f32_bf16 v84, s8, v174
  v_dot2c_f32_bf16 v85, s9, v174
  s_or_b64 vcc, vcc, s[78:79]
  s_waitcnt vmcnt(7)
  v_cmp_ne_u32 s[80:81], s52, v179
  v_dot2c_f32_bf16 v80, s8, v176
  v_dot2c_f32_bf16 v81, s9, v176
  v_dot2c_f32_bf16 v82, s8, v177
  v_dot2c_f32_bf16 v83, s9, v177
  v_dot2c_f32_bf16 v84, s8, v178
  v_dot2c_f32_bf16 v85, s9, v178
  s_or_b64 vcc, vcc, s[80:81]
  s_waitcnt vmcnt(6)
  v_cmp_ne_u32 s[82:83], s52, v183
  v_dot2c_f32_bf16 v80, s8, v180
  v_dot2c_f32_bf16 v81, s9, v180
  v_dot2c_f32_bf16 v82, s8, v181
  v_dot2c_f32_bf16 v83, s9, v181
  v_dot2c_f32_bf16 v84, s8, v182
  v_dot2c_f32_bf16 v85, s9, v182
  s_or_b64 vcc, vcc, s[82:83]
  s_waitcnt vmcnt(5)
  v_cmp_ne_u32 s[84:85], s52, v187
  v_dot2c_f32_bf16 v80, s8, v184
  v_dot2c_f32_bf16 v81, s9, v184
  v_dot2c_f32_bf16 v82, s8, v185
  v_dot2c_f32_bf16 v83, s9, v185
  v_dot2c_f32_bf16 v84, s8, v186
  v_dot2c_f32_bf16 v85, s9, v186
  s_or_b64 vcc, vcc, s[84:85]
  s_waitcnt vmcnt(4)
  v_cmp_ne_u32 s[86:87], s52, v191
  v_dot2c_f32_bf16 v80, s8, v188
  v_dot2c_f32_bf16 v81, s9, v188
  v_dot2c_f32_bf16 v82, s8, v189
  v_dot2c_f32_bf16 v83, s9, v189
  v_dot2c_f32_bf16 v84, s8, v190
  v_dot2c_f32_bf16 v85, s9, v190
  s_or_b64 vcc, vcc, s[86:87]
  s_waitcnt vmcnt(3)
  v_cmp_ne_u32 s[88:89], s52, v195
  v_dot2c_f32_bf16 v80, s8, v192
  v_dot2c_f32_bf16 v81, s9, v192
  v_dot2c_f32_bf16 v82, s8, v193
  v_dot2c_f32_bf16 v83, s9, v193
  v_dot2c_f32_bf16 v84, s8, v194
  v_dot2c_f32_bf16 v85, s9, v194
  s_or_b64 vcc, vcc, s[88:89]
  s_waitcnt vmcnt(2)
  v_cmp_ne_u32 s[90:91], s52, v199
  v_dot2c_f32_bf16 v80, s8, v196
  v_dot2c_f32_bf16 v81, s9, v196
  v_dot2c_f32_bf16 v82, s8, v197
  v_dot2c_f32_bf16 v83, s9, v197
  v_dot2c_f32_bf16 v84, s8, v198
  v_dot2c_f32_bf16 v85, s9, v198
  s_or_b64 vcc, vcc, s[90:91]
  s_waitcnt vmcnt(1)
  v_cmp_ne_u32 s[92:93], s52, v203
  v_dot2c_f32_bf16 v80, s8, v200
  v_dot2c_f32_bf16 v81, s9, v200
  v_dot2c_f32_bf16 v82, s8, v201
  v_dot2c_f32_bf16 v83, s9, v201
  v_dot2c_f32_bf16 v84, s8, v202
  v_dot2c_f32_bf16 v85, s9, v202
  s_or_b64 vcc, vcc, s[92:93]
  s_waitcnt vmcnt(0)
  v_cmp_ne_u32 s[94:95], s52, v207
  v_dot2c_f32_bf16 v80, s8, v204
  v_dot2c_f32_bf16 v81, s9, v204
  v_dot2c_f32_bf16 v82, s8, v205
  v_dot2c_f32_bf16 v83, s9, v205
  v_dot2c_f32_bf16 v84, s8, v206
  v_dot2c_f32_bf16 v85, s9, v206
  s_or_b64 vcc, vcc, s[94:95]
  s_sub_u32 s7, s7, 1
  s_cbranch_scc1 TP_D4
  s_cbranch_vccnz TP_L4
TP_D4:
  v_mov_b32 v147, v253
  s_nop 1
  v_cvt_pk_bf16_f32 v144, v80, v81
  v_cvt_pk_bf16_f32 v145, v82, v83
  v_cvt_pk_bf16_f32 v146, v84, v85
  s_cmp_eq_u32 s19, 0
  s_cbranch_scc1 DU_A5
  buffer_store_dwordx4 v[144:147], v210, s[32:35], s16 offen
DU_B5:
  s_mov_b64 exec, -1
  s_endpgm
M_A4:
  s_waitcnt vmcnt(0)
  s_endpgm
PE7:
.p2align 12
PG8:
POLL_L3:
  s_sleep 1
  buffer_load_dword v12, v198, s[32:35], 0 offen sc1
  s_waitcnt vmcnt(0)
  v_cmp_ne_u32 vcc, s52, v12
  s_sub_u32 s7, s7, 1
  s_cbranch_scc1 POLL_T3
  s_cbranch_vccnz POLL_L3
  s_branch POLL_D3
POLL_T3:
  s_branch POLL_D3
L_A3:
  s_mov_b32 s7, 4000
  s_branch TP_C1
TP_L1:
  s_sleep 1
  s_cmp_lg_u64 s[64:65], 0
  s_cselect_b64 exec, -1, 0
  buffer_load_dwordx4 v[172:175], v170, s[32:35], s10 offen offset:0 sc1
  s_cmp_lg_u64 s[66:67], 0
  s_cselect_b64 exec, -1, 0
  buffer_load_dwordx4 v[176:179], v170, s[32:35], s10 offen offset:640 sc1
  s_cmp_lg_u64 s[68:69], 0
  s_cselect_b64 exec, -1, 0
  buffer_load_dwordx4 v[180:183], v170, s[32:35], s10 offen offset:1280 sc1
  s_cmp_lg_u64 s[70:71], 0
  s_cselect_b64 exec, -1, 0
  buffer_load_dwordx4 v[184:187], v170, s[32:35], s10 offen offset:1920 sc1
  s_cmp_lg_u64 s[72:73], 0
  s_cselect_b64 exec, -1, 0
  buffer_load_dwordx4 v[188:191], v170, s[32:35], s10 offen offset:2560 sc1
  s_cmp_lg_u64 s[74:75], 0
  s_cselect_b64 exec, -1, 0
  buffer_load_dwordx4 v[192:195], v170, s[32:35], s10 offen offset:3200 sc1
  s_mov_b64 exec, -1
TP_C1:
  s_waitcnt vmcnt(0)
  v_cmp_ne_u32 s[64:65], s52, v175
  v_cmp_ne_u32 s[66:67], s52, v179
  v_cmp_ne_u32 s[68:69], s52, v183
  v_cmp_ne_u32 s[70:71], s52, v187
  v_cmp_ne_u32 s[72:73], s52, v191
  v_cmp_ne_u32 s[74:75], s52, v195
  s_mov_b64 vcc, s[64:65]
  s_or_b64 vcc, vcc, s[66:67]
  s_or_b64 vcc, vcc, s[68:69]
  s_or_b64 vcc, vcc, s[70:71]
  s_or_b64 vcc, vcc, s[72:73]
  s_or_b64 vcc, vcc, s[74:75]
  s_sub_u32 s7, s7, 1
  s_cbranch_scc1 TP_D1
  s_cbranch_vccnz TP_L1
TP_D1:
  v_mov_b32 v175, v180
  v_mov_b32 v179, v181
  v_mov_b32 v187, v192
  v_mov_b32 v191, v193
  s_nop 1
  v_mfma_f32_32x32x16_bf16 v[16:31], v[172:175], v[112:115], 0
  v_mfma_f32_32x32x16_bf16 v[16:31], v[176:179], v[116:119], v[16:31]
  v_mfma_f32_32x32x16_bf16 v[32:47], v[184:187], v[120:123], 0
  v_mfma_f32_32x32x16_bf16 v[32:47], v[188:191], v[124:127], v[32:47]
  s_cmp_eq_u32 s19, 0
  s_nop 3
  s_cbranch_scc1 OS_A
  v_add_f32 v144, 0x358637bd, v24
  v_rcp_f32 v144, v144
  v_mfma_f32_32x32x16_bf16 v[48:63], v[172:175], v[128:131], 0
  v_mul_f32 v16, v16, v144
  v_mul_f32 v17, v17, v144
  v_mul_f32 v18, v18, v144
  v_mul_f32 v19, v19, v144
  v_mul_f32 v20, v20, v144
  v_mfma_f32_32x32x16_bf16 v[48:63], v[176:179], v[132:135], v[48:63]
  v_mul_f32 v21, v21, v144
  v_mul_f32 v22, v22, v144
  v_mul_f32 v23, v23, v144
  v_cvt_pk_bf16_f32 v80, v16, v17
  v_cvt_pk_bf16_f32 v81, v18, v19
  v_cvt_pk_bf16_f32 v82, v20, v21
  v_cvt_pk_bf16_f32 v83, v22, v23
  buffer_store_dwordx4 v[80:83], v1, s[32:35], s12 offen offset:0
  v_add_f32 v144, 0x358637bd, v40
  v_rcp_f32 v144, v144
  v_mfma_f32_32x32x16_bf16 v[64:79], v[184:187], v[136:139], 0
  v_mul_f32 v32, v32, v144
  v_mul_f32 v33, v33, v144
  v_mul_f32 v34, v34, v144
  v_mul_f32 v35, v35, v144
  v_mul_f32 v36, v36, v144
  v_mfma_f32_32x32x16_bf16 v[64:79], v[188:191], v[140:143], v[64:79]
  v_mul_f32 v37, v37, v144
  v_mul_f32 v38, v38, v144
  v_mul_f32 v39, v39, v144
  v_cvt_pk_bf16_f32 v84, v32, v33
  v_cvt_pk_bf16_f32 v85, v34, v35
  v_cvt_pk_bf16_f32 v86, v36, v37
  v_cvt_pk_bf16_f32 v87, v38, v39
  buffer_store_dwordx4 v[84:87], v1, s[32:35], s12 offen offset:1024
  v_add_f32 v144, 0x358637bd, v56
  v_rcp_f32 v144, v144
  s_nop 0
  v_mul_f32 v48, v48, v144
  v_mul_f32 v49, v49, v144
  v_mul_f32 v50, v50, v144
  v_mul_f32 v51, v51, v144
  v_mul_f32 v52, v52, v144
  v_mul_f32 v53, v53, v144
  v_mul_f32 v54, v54, v144
  v_mul_f32 v55, v55, v144
  v_cvt_pk_bf16_f32 v88, v48, v49
  v_cvt_pk_bf16_f32 v89, v50, v51
  v_cvt_pk_bf16_f32 v90, v52, v53
  v_cvt_pk_bf16_f32 v91, v54, v55
  buffer_store_dwordx4 v[88:91], v1, s[32:35], s13 offen offset:0
  v_add_f32 v144, 0x358637bd, v72
  v_rcp_f32 v144, v144
  s_nop 0
  v_mul_f32 v64, v64, v144
  v_mul_f32 v65, v65, v144
  v_mul_f32 v66, v66, v144
  v_mul_f32 v67, v67, v144
  v_mul_f32 v68, v68, v144
  v_mul_f32 v69, v69, v144
  v_mul_f32 v70, v70, v144
  v_mul_f32 v71, v71, v144
  v_cvt_pk_bf16_f32 v92, v64, v65
  v_cvt_pk_bf16_f32 v93, v66, v67
  v_cvt_pk_bf16_f32 v94, v68, v69
  v_cvt_pk_bf16_f32 v95, v70, v71
  buffer_store_dwordx4 v[92:95], v1, s[32:35], s13 offen offset:1024
OS_B:
  s_mov_b64 exec, 15
  s_waitcnt vmcnt(0)
  s_cmp_eq_u32 s19, 0
  s_cbranch_scc1 DU_A2
  buffer_store_dword v253, v171, s[32:35], s14 offen
DU_B2:
  s_mov_b64 exec, -1
  s_barrier
  buffer_load_dword v12, v198, s[32:35], 0 offen sc1
  ds_write_b128 v2, v[80:83] offset:0
  ds_write_b128 v2, v[84:87] offset:1024
  ds_write_b128 v2, v[88:91] offset:4096
  ds_write_b128 v2, v[92:95] offset:5120
  s_waitcnt lgkmcnt(0)
  s_barrier
  ds_read_b128 v[16:19], v3 offset:0
  ds_read_b128 v[20:23], v3 offset:1024
  ds_read_b128 v[24:27], v3 offset:2048
  ds_read_b128 v[28:31], v3 offset:3072
  s_waitcnt vmcnt(0) lgkmcnt(0)
  v_cmp_ne_u32 vcc, s52, v12
  s_mov_b32 s7, 4000
  s_cbranch_vccnz POLL_L3
POLL_D3:
  buffer_load_dwordx4 v[32:35], v1, s[32:35], s81 offen offset:0 sc1
  buffer_load_dwordx4 v[36:39], v1, s[32:35], s81 offen offset:1024 sc1
  buffer_load_dwordx4 v[40:43], v1, s[32:35], s81 offen offset:2048 sc1
  buffer_load_dwordx4 v[44:47], v1, s[32:35], s81 offen offset:3072 sc1
  buffer_load_dwordx4 v[48:51], v1, s[32:35], s82 offen offset:0 sc1
  buffer_load_dwordx4 v[52:55], v1, s[32:35], s82 offen offset:1024 sc1
  buffer_load_dwordx4 v[56:59], v1, s[32:35], s82 offen offset:2048 sc1
  buffer_load_dwordx4 v[60:63], v1, s[32:35], s82 offen offset:3072 sc1
  buffer_load_dwordx4 v[64:67], v1, s[32:35], s83 offen offset:0 sc1
  buffer_load_dwordx4 v[68:71], v1, s[32:35], s83 offen offset:1024 sc1
  buffer_load_dwordx4 v[72:75], v1, s[32:35], s83 offen offset:2048 sc1
  buffer_load_dwordx4 v[76:79], v1, s[32:35], s83 offen offset:3072 sc1
  buffer_load_dwordx4 v[80:83], v1, s[32:35], s84 offen offset:0 sc1
  buffer_load_dwordx4 v[84:87], v1, s[32:35], s84 offen offset:1024 sc1
  ds_read_b64_tr_b16 v[176:177], v199 offset:0
  ds_read_b64_tr_b16 v[178:179], v199 offset:1024
  ds_read_b64_tr_b16 v[180:181], v200 offset:0
  ds_read_b64_tr_b16 v[182:183], v200 offset:1024
  ds_read_b64_tr_b16 v[184:185], v199 offset:2048
  ds_read_b64_tr_b16 v[186:187], v199 offset:3072
  ds_read_b64_tr_b16 v[188:189], v200 offset:2048
  ds_read_b64_tr_b16 v[190:191], v200 offset:3072
  s_mov_b32 s7, 4000
  ds_read_b64_tr_b16 v[224:225], v199 offset:4096
  ds_read_b64_tr_b16 v[226:227], v199 offset:5120
  ds_read_b64_tr_b16 v[228:229], v200 offset:4096
  ds_read_b64_tr_b16 v[230:231], v200 offset:5120
  s_waitcnt lgkmcnt(10)
  v_mfma_f32_32x32x16_bf16 v[144:159], v[176:179], v[16:19], 0
  s_waitcnt lgkmcnt(8)
  v_mfma_f32_32x32x16_bf16 v[160:175], v[180:183], v[16:19], 0
  ds_read_b64_tr_b16 v[176:177], v199 offset:6144
  ds_read_b64_tr_b16 v[178:179], v199 offset:7168
  ds_read_b64_tr_b16 v[180:181], v200 offset:6144
  ds_read_b64_tr_b16 v[182:183], v200 offset:7168
  s_waitcnt lgkmcnt(10)
  v_mfma_f32_32x32x16_bf16 v[144:159], v[184:187], v[20:23], v[144:159]
  s_waitcnt lgkmcnt(8)
  v_mfma_f32_32x32x16_bf16 v[160:175], v[188:191], v[20:23], v[160:175]
  ds_read_b64_tr_b16 v[184:185], v199 offset:8192
  ds_read_b64_tr_b16 v[186:187], v199 offset:9216
  ds_read_b64_tr_b16 v[188:189], v200 offset:8192
  ds_read_b64_tr_b16 v[190:191], v200 offset:9216
  s_waitcnt lgkmcnt(10)
  v_mfma_f32_32x32x16_bf16 v[144:159], v[224:227], v[24:27], v[144:159]
  s_waitcnt lgkmcnt(8)
  v_mfma_f32_32x32x16_bf16 v[160:175], v[228:231], v[24:27], v[160:175]
  ds_read_b64_tr_b16 v[224:225], v199 offset:10240
  ds_read_b64_tr_b16 v[226:227], v199 offset:11264
  ds_read_b64_tr_b16 v[228:229], v200 offset:10240
  ds_read_b64_tr_b16 v[230:231], v200 offset:11264
  s_waitcnt lgkmcnt(10)
  v_mfma_f32_32x32x16_bf16 v[144:159], v[176:179], v[28:31], v[144:159]
  s_waitcnt lgkmcnt(8)
  v_mfma_f32_32x32x16_bf16 v[160:175], v[180:183], v[28:31], v[160:175]
  ds_read_b64_tr_b16 v[176:177], v199 offset:12288
  ds_read_b64_tr_b16 v[178:179], v199 offset:13312
  ds_read_b64_tr_b16 v[180:181], v200 offset:12288
  ds_read_b64_tr_b16 v[182:183], v200 offset:13312
  s_waitcnt vmcnt(13)
  s_waitcnt lgkmcnt(10)
  v_mfma_f32_32x32x16_bf16 v[144:159], v[184:187], v[32:35], v[144:159]
  buffer_load_dwordx4 v[88:91], v1, s[32:35], s84 offen offset:2048 sc1
  s_waitcnt lgkmcnt(8)
  v_mfma_f32_32x32x16_bf16 v[160:175], v[188:191], v[32:35], v[160:175]
  ds_read_b64_tr_b16 v[184:185], v199 offset:14336
  ds_read_b64_tr_b16 v[186:187], v199 offset:15360
  ds_read_b64_tr_b16 v[188:189], v200 offset:14336
  ds_read_b64_tr_b16 v[190:191], v200 offset:15360
  s_waitcnt vmcnt(13)
  s_waitcnt lgkmcnt(10)
  v_mfma_f32_32x32x16_bf16 v[144:159], v[224:227], v[36:39], v[144:159]
  buffer_load_dwordx4 v[92:95], v1, s[32:35], s84 offen offset:3072 sc1
  s_waitcnt lgkmcnt(8)
  v_mfma_f32_32x32x16_bf16 v[160:175], v[228:231], v[36:39], v[160:175]
  ds_read_b64_tr_b16 v[224:225], v199 offset:16384
  ds_read_b64_tr_b16 v[226:227], v199 offset:17408
  ds_read_b64_tr_b16 v[228:229], v200 offset:16384
  ds_read_b64_tr_b16 v[230:231], v200 offset:17408
  s_waitcnt vmcnt(13)
  s_waitcnt lgkmcnt(10)
  v_mfma_f32_32x32x16_bf16 v[144:159], v[176:179], v[40:43], v[144:159]
  buffer_load_dwordx4 v[96:99], v1, s[32:35], s85 offen offset:0 sc1
  s_waitcnt lgkmcnt(8)
  v_mfma_f32_32x32x16_bf16 v[160:175], v[180:183], v[40:43], v[160:175]
  ds_read_b64_tr_b16 v[176:177], v199 offset:18432
  ds_read_b64_tr_b16 v[178:179], v199 offset:19456
  ds_read_b64_tr_b16 v[180:181], v200 offset:18432
  ds_read_b64_tr_b16 v[182:183], v200 offset:19456
  s_waitcnt vmcnt(13)
  s_waitcnt lgkmcnt(10)
  v_mfma_f32_32x32x16_bf16 v[144:159], v[184:187], v[44:47], v[144:159]
  buffer_load_dwordx4 v[100:103], v1, s[32:35], s85 offen offset:1024 sc1
  s_waitcnt lgkmcnt(8)
  v_mfma_f32_32x32x16_bf16 v[160:175], v[188:191], v[44:47], v[160:175]
  ds_read_b64_tr_b16 v[184:185], v199 offset:20480
  ds_read_b64_tr_b16 v[186:187], v199 offset:21504
  ds_read_b64_tr_b16 v[188:189], v200 offset:20480
  ds_read_b64_tr_b16 v[190:191], v200 offset:21504
  s_waitcnt vmcnt(13)
  s_waitcnt lgkmcnt(10)
  v_mfma_f32_32x32x16_bf16 v[144:159], v[224:227], v[48:51], v[144:159]
  buffer_load_dwordx4 v[104:107], v1, s[32:35], s85 offen offset:2048 sc1
  s_waitcnt lgkmcnt(8)
  v_mfma_f32_32x32x16_bf16 v[160:175], v[228:231], v[48:51], v[160:175]
  ds_read_b64_tr_b16 v[224:225], v199 offset:22528
  ds_read_b64_tr_b16 v[226:227], v199 offset:23552
  ds_read_b64_tr_b16 v[228:229], v200 offset:22528
  ds_read_b64_tr_b16 v[230:231], v200 offset:23552
  s_waitcnt vmcnt(13)
  s_waitcnt lgkmcnt(10)
  v_mfma_f32_32x32x16_bf16 v[144:159], v[176:179], v[52:55], v[144:159]
  buffer_load_dwordx4 v[108:111], v1, s[32:35], s85 offen offset:3072 sc1
  s_waitcnt lgkmcnt(8)
  v_mfma_f32_32x32x16_bf16 v[160:175], v[180:183], v[52:55], v[160:175]
  ds_read_b64_tr_b16 v[176:177], v199 offset:24576
  ds_read_b64_tr_b16 v[178:179], v199 offset:25600
  ds_read_b64_tr_b16 v[180:181], v200 offset:24576
  ds_read_b64_tr_b16 v[182:183], v200 offset:25600
  s_waitcnt vmcnt(13)
  s_waitcnt lgkmcnt(10)
  v_mfma_f32_32x32x16_bf16 v[144:159], v[184:187], v[56:59], v[144:159]
  buffer_load_dwordx4 v[112:115], v1, s[32:35], s86 offen offset:0 sc1
  s_waitcnt lgkmcnt(8)
  v_mfma_f32_32x32x16_bf16 v[160:175], v[188:191], v[56:59], v[160:175]
  ds_read_b64_tr_b16 v[184:185], v199 offset:26624
  ds_read_b64_tr_b16 v[186:187], v199 offset:27648
  ds_read_b64_tr_b16 v[188:189], v200 offset:26624
  ds_read_b64_tr_b16 v[190:191], v200 offset:27648
  s_waitcnt vmcnt(13)
  s_waitcnt lgkmcnt(10)
  v_mfma_f32_32x32x16_bf16 v[144:159], v[224:227], v[60:63], v[144:159]
  buffer_load_dwordx4 v[116:119], v1, s[32:35], s86 offen offset:1024 sc1
  s_waitcnt lgkmcnt(8)
  v_mfma_f32_32x32x16_bf16 v[160:175], v[228:231], v[60:63], v[160:175]
  ds_read_b64_tr_b16 v[224:225], v199 offset:28672
  ds_read_b64_tr_b16 v[226:227], v199 offset:29696
  ds_read_b64_tr_b16 v[228:229], v200 offset:28672
  ds_read_b64_tr_b16 v[230:231], v200 offset:29696
  s_waitcnt vmcnt(13)
  s_waitcnt lgkmcnt(10)
  v_mfma_f32_32x32x16_bf16 v[144:159], v[176:179], v[64:67], v[144:159]
  buffer_load_dwordx4 v[120:123], v1, s[32:35], s86 offen offset:2048 sc1
  s_waitcnt lgkmcnt(8)
  v_mfma_f32_32x32x16_bf16 v[160:175], v[180:183], v[64:67], v[160:175]
  ds_read_b64_tr_b16 v[176:177], v199 offset:30720
  ds_read_b64_tr_b16 v[178:179], v199 offset:31744
  ds_read_b64_tr_b16 v[180:181], v200 offset:30720
  ds_read_b64_tr_b16 v[182:183], v200 offset:31744
  s_waitcnt vmcnt(13)
  s_waitcnt lgkmcnt(10)
  v_mfma_f32_32x32x16_bf16 v[144:159], v[184:187], v[68:71], v[144:159]
  buffer_load_dwordx4 v[124:127], v1, s[32:35], s86 offen offset:3072 sc1
  s_waitcnt lgkmcnt(8)
  v_mfma_f32_32x32x16_bf16 v[160:175], v[188:191], v[68:71], v[160:175]
  ds_read_b64_tr_b16 v[184:185], v199 offset:32768
  ds_read_b64_tr_b16 v[186:187], v199 offset:33792
  ds_read_b64_tr_b16 v[188:189], v200 offset:32768
  ds_read_b64_tr_b16 v[190:191], v200 offset:33792
  s_waitcnt vmcnt(13)
  s_waitcnt lgkmcnt(10)
  v_mfma_f32_32x32x16_bf16 v[144:159], v[224:227], v[72:75], v[144:159]
  buffer_load_dwordx4 v[128:131], v1, s[32:35], s87 offen offset:0 sc1
  s_waitcnt lgkmcnt(8)
  v_mfma_f32_32x32x16_bf16 v[160:175], v[228:231], v[72:75], v[160:175]
  ds_read_b64_tr_b16 v[224:225], v199 offset:34816
  ds_read_b64_tr_b16 v[226:227], v199 offset:35840
  ds_read_b64_tr_b16 v[228:229], v200 offset:34816
  ds_read_b64_tr_b16 v[230:231], v200 offset:35840
  s_waitcnt vmcnt(13)
  s_waitcnt lgkmcnt(10)
  v_mfma_f32_32x32x16_bf16 v[144:159], v[176:179], v[76:79], v[144:159]
  buffer_load_dwordx4 v[132:135], v1, s[32:35], s87 offen offset:1024 sc1
  s_waitcnt lgkmcnt(8)
  v_mfma_f32_32x32x16_bf16 v[160:175], v[180:183], v[76:79], v[160:175]
  ds_read_b64_tr_b16 v[176:177], v199 offset:36864
  ds_read_b64_tr_b16 v[178:179], v199 offset:37888
  ds_read_b64_tr_b16 v[180:181], v200 offset:36864
  ds_read_b64_tr_b16 v[182:183], v200 offset:37888
  s_waitcnt vmcnt(13)
  s_waitcnt lgkmcnt(10)
  v_mfma_f32_32x32x16_bf16 v[144:159], v[184:187], v[80:83], v[144:159]
  buffer_load_dwordx4 v[136:139], v1, s[32:35], s87 offen offset:2048 sc1
  s_waitcnt lgkmcnt(8)
  v_mfma_f32_32x32x16_bf16 v[160:175], v[188:191], v[80:83], v[160:175]
  ds_read_b64_tr_b16 v[184:185], v199 offset:38912
  ds_read_b64_tr_b16 v[186:187], v199 offset:39936
  ds_read_b64_tr_b16 v[188:189], v200 offset:38912
  ds_read_b64_tr_b16 v[190:191], v200 offset:39936
  s_waitcnt vmcnt(13)
  s_waitcnt lgkmcnt(10)
  v_mfma_f32_32x32x16_bf16 v[144:159], v[224:227], v[84:87], v[144:159]
  buffer_load_dwordx4 v[140:143], v1, s[32:35], s87 offen offset:3072 sc1
  s_waitcnt lgkmcnt(8)
  v_mfma_f32_32x32x16_bf16 v[160:175], v[228:231], v[84:87], v[160:175]
  ds_read_b64_tr_b16 v[224:225], v199 offset:40960
  ds_read_b64_tr_b16 v[226:227], v199 offset:41984
  ds_read_b64_tr_b16 v[228:229], v200 offset:40960
  ds_read_b64_tr_b16 v[230:231], v200 offset:41984
  s_waitcnt vmcnt(13)
  s_waitcnt lgkmcnt(10)
  v_mfma_f32_32x32x16_bf16 v[144:159], v[176:179], v[88:91], v[144:159]
  s_waitcnt lgkmcnt(8)
  v_mfma_f32_32x32x16_bf16 v[160:175], v[180:183], v[88:91], v[160:175]
  ds_read_b64_tr_b16 v[176:177], v199 offset:43008
  ds_read_b64_tr_b16 v[178:179], v199 offset:44032
  ds_read_b64_tr_b16 v[180:181], v200 offset:43008
  ds_read_b64_tr_b16 v[182:183], v200 offset:44032
  s_waitcnt vmcnt(12)
  s_waitcnt lgkmcnt(10)
  v_mfma_f32_32x32x16_bf16 v[144:159], v[184:187], v[92:95], v[144:159]
  s_waitcnt lgkmcnt(8)
  v_mfma_f32_32x32x16_bf16 v[160:175], v[188:191], v[92:95], v[160:175]
  ds_read_b64_tr_b16 v[184:185], v199 offset:45056
  ds_read_b64_tr_b16 v[186:187], v199 offset:46080
  ds_read_b64_tr_b16 v[188:189], v200 offset:45056
  ds_read_b64_tr_b16 v[190:191], v200 offset:46080
  s_waitcnt vmcnt(11)
  s_waitcnt lgkmcnt(10)
  v_mfma_f32_32x32x16_bf16 v[144:159], v[224:227], v[96:99], v[144:159]
  s_waitcnt lgkmcnt(8)
  v_mfma_f32_32x32x16_bf16 v[160:175], v[228:231], v[96:99], v[160:175]
  ds_read_b64_tr_b16 v[224:225], v199 offset:47104
  ds_read_b64_tr_b16 v[226:227], v199 offset:48128
  ds_read_b64_tr_b16 v[228:229], v200 offset:47104
  ds_read_b64_tr_b16 v[230:231], v200 offset:48128
  s_waitcnt vmcnt(10)
  s_waitcnt lgkmcnt(10)
  v_mfma_f32_32x32x16_bf16 v[144:159], v[176:179], v[100:103], v[144:159]
  s_waitcnt lgkmcnt(8)
  v_mfma_f32_32x32x16_bf16 v[160:175], v[180:183], v[100:103], v[160:175]
  ds_read_b64_tr_b16 v[176:177], v199 offset:49152
  ds_read_b64_tr_b16 v[178:179], v199 offset:50176
  ds_read_b64_tr_b16 v[180:181], v200 offset:49152
  ds_read_b64_tr_b16 v[182:183], v200 offset:50176
  s_waitcnt vmcnt(9)
  s_waitcnt lgkmcnt(10)
  v_mfma_f32_32x32x16_bf16 v[144:159], v[184:187], v[104:107], v[144:159]
  s_waitcnt lgkmcnt(8)
  v_mfma_f32_32x32x16_bf16 v[160:175], v[188:191], v[104:107], v[160:175]
  ds_read_b64_tr_b16 v[184:185], v199 offset:51200
  ds_read_b64_tr_b16 v[186:187], v199 offset:52224
  ds_read_b64_tr_b16 v[188:189], v200 offset:51200
  ds_read_b64_tr_b16 v[190:191], v200 offset:52224
  s_waitcnt vmcnt(8)
  s_waitcnt lgkmcnt(10)
  v_mfma_f32_32x32x16_bf16 v[144:159], v[224:227], v[108:111], v[144:159]
  s_waitcnt lgkmcnt(8)
  v_mfma_f32_32x32x16_bf16 v[160:175], v[228:231], v[108:111], v[160:175]
  ds_read_b64_tr_b16 v[224:225], v199 offset:53248
  ds_read_b64_tr_b16 v[226:227], v199 offset:54272
  ds_read_b64_tr_b16 v[228:229], v200 offset:53248
  ds_read_b64_tr_b16 v[230:231], v200 offset:54272
  s_waitcnt vmcnt(7)
  s_waitcnt lgkmcnt(10)
  v_mfma_f32_32x32x16_bf16 v[144:159], v[176:179], v[112:115], v[144:159]
  s_waitcnt lgkmcnt(8)
  v_mfma_f32_32x32x16_bf16 v[160:175], v[180:183], v[112:115], v[160:175]
  ds_read_b64_tr_b16 v[176:177], v199 offset:55296
  ds_read_b64_tr_b16 v[178:179], v199 offset:56320
  ds_read_b64_tr_b16 v[180:181], v200 offset:55296
  ds_read_b64_tr_b16 v[182:183], v200 offset:56320
  s_waitcnt vmcnt(6)
  s_waitcnt lgkmcnt(10)
  v_mfma_f32_32x32x16_bf16 v[144:159], v[184:187], v[116:119], v[144:159]
  s_waitcnt lgkmcnt(8)
  v_mfma_f32_32x32x16_bf16 v[160:175], v[188:191], v[116:119], v[160:175]
  ds_read_b64_tr_b16 v[184:185], v199 offset:57344
  ds_read_b64_tr_b16 v[186:187], v199 offset:58368
  ds_read_b64_tr_b16 v[188:189], v200 offset:57344
  ds_read_b64_tr_b16 v[190:191], v200 offset:58368
  s_waitcnt vmcnt(5)
  s_waitcnt lgkmcnt(10)
  v_mfma_f32_32x32x16_bf16 v[144:159], v[224:227], v[120:123], v[144:159]
  s_waitcnt lgkmcnt(8)
  v_mfma_f32_32x32x16_bf16 v[160:175], v[228:231], v[120:123], v[160:175]
  ds_read_b64_tr_b16 v[224:225], v199 offset:59392
  ds_read_b64_tr_b16 v[226:227], v199 offset:60416
  ds_read_b64_tr_b16 v[228:229], v200 offset:59392
  ds_read_b64_tr_b16 v[230:231], v200 offset:60416
  s_waitcnt vmcnt(4)
  s_waitcnt lgkmcnt(10)
  v_mfma_f32_32x32x16_bf16 v[144:159], v[176:179], v[124:127], v[144:159]
  s_waitcnt lgkmcnt(8)
  v_mfma_f32_32x32x16_bf16 v[160:175], v[180:183], v[124:127], v[160:175]
  ds_read_b64_tr_b16 v[176:177], v199 offset:61440
  ds_read_b64_tr_b16 v[178:179], v199 offset:62464
  ds_read_b64_tr_b16 v[180:181], v200 offset:61440
  ds_read_b64_tr_b16 v[182:183], v200 offset:62464
  s_waitcnt vmcnt(3)
  s_waitcnt lgkmcnt(10)
  v_mfma_f32_32x32x16_bf16 v[144:159], v[184:187], v[128:131], v[144:159]
  s_waitcnt lgkmcnt(8)
  v_mfma_f32_32x32x16_bf16 v[160:175], v[188:191], v[128:131], v[160:175]
  ds_read_b64_tr_b16 v[184:185], v199 offset:63488
  ds_read_b64_tr_b16 v[186:187], v199 offset:64512
  ds_read_b64_tr_b16 v[188:189], v200 offset:63488
  ds_read_b64_tr_b16 v[190:191], v200 offset:64512
  s_waitcnt vmcnt(2)
  s_waitcnt lgkmcnt(10)
  v_mfma_f32_32x32x16_bf16 v[144:159], v[224:227], v[132:135], v[144:159]
  s_waitcnt lgkmcnt(8)
  v_mfma_f32_32x32x16_bf16 v[160:175], v[228:231], v[132:135], v[160:175]
  s_waitcnt vmcnt(1)
  s_waitcnt lgkmcnt(6)
  v_mfma_f32_32x32x16_bf16 v[144:159], v[176:179], v[136:139], v[144:159]
  s_waitcnt lgkmcnt(4)
  v_mfma_f32_32x32x16_bf16 v[160:175], v[180:183], v[136:139], v[160:175]
  s_waitcnt vmcnt(0)
  s_waitcnt lgkmcnt(2)
  v_mfma_f32_32x32x16_bf16 v[144:159], v[184:187], v[140:143], v[144:159]
  s_waitcnt lgkmcnt(0)
  v_mfma_f32_32x32x16_bf16 v[160:175], v[188:191], v[140:143], v[160:175]
  s_nop 11
  s_mov_b32 vcc_lo, 0x55555555
  s_mov_b32 vcc_hi, 0x55555555
  v_cvt_pk_bf16_f32 v16, v144, v145
  v_cvt_pk_bf16_f32 v17, v146, v147
  v_cvt_pk_bf16_f32 v20, v148, v149
  v_cvt_pk_bf16_f32 v21, v150, v151
  v_cvt_pk_bf16_f32 v24, v152, v153
  v_cvt_pk_bf16_f32 v25, v154, v155
  v_cvt_pk_bf16_f32 v28, v156, v157
  v_cvt_pk_bf16_f32 v29, v158, v159
  v_cvt_pk_bf16_f32 v18, v160, v161
  v_cvt_pk_bf16_f32 v19, v162, v163
  v_cvt_pk_bf16_f32 v22, v164, v165
  v_cvt_pk_bf16_f32 v23, v166, v167
  v_cvt_pk_bf16_f32 v26, v168, v169
  v_cvt_pk_bf16_f32 v27, v170, v171
  v_cvt_pk_bf16_f32 v30, v172, v173
  v_cvt_pk_bf16_f32 v31, v174, v175
  s_nop 0
  v_permlane32_swap_b32 v16, v18
  v_permlane32_swap_b32 v17, v19
  v_permlane32_swap_b32 v20, v22
  v_permlane32_swap_b32 v21, v23
  v_permlane32_swap_b32 v24, v26
  v_permlane32_swap_b32 v25, v27
  v_permlane32_swap_b32 v28, v30
  v_permlane32_swap_b32 v29, v31
  v_cndmask_b32_dpp v32, v20, v16, vcc quad_perm:[1,0,3,2] row_mask:0xf bank_mask:0xf
  v_cndmask_b32_dpp v33, v21, v17, vcc quad_perm:[1,0,3,2] row_mask:0xf bank_mask:0xf
  v_cndmask_b32_dpp v34, v22, v18, vcc quad_perm:[1,0,3,2] row_mask:0xf bank_mask:0xf
  v_cndmask_b32_dpp v35, v23, v19, vcc quad_perm:[1,0,3,2] row_mask:0xf bank_mask:0xf
  v_cndmask_b32_dpp v40, v28, v24, vcc quad_perm:[1,0,3,2] row_mask:0xf bank_mask:0xf
  v_cndmask_b32_dpp v41, v29, v25, vcc quad_perm:[1,0,3,2] row_mask:0xf bank_mask:0xf
  v_cndmask_b32_dpp v42, v30, v26, vcc quad_perm:[1,0,3,2] row_mask:0xf bank_mask:0xf
  v_cndmask_b32_dpp v43, v31, v27, vcc quad_perm:[1,0,3,2] row_mask:0xf bank_mask:0xf
  s_mov_b32 vcc_lo, 0xaaaaaaaa
  s_mov_b32 vcc_hi, 0xaaaaaaaa
  v_cndmask_b32_dpp v36, v16, v20, vcc quad_perm:[1,0,3,2] row_mask:0xf bank_mask:0xf
  v_cndmask_b32_dpp v37, v17, v21, vcc quad_perm:[1,0,3,2] row_mask:0xf bank_mask:0xf
  v_cndmask_b32_dpp v38, v18, v22, vcc quad_perm:[1,0,3,2] row_mask:0xf bank_mask:0xf
  v_cndmask_b32_dpp v39, v19, v23, vcc quad_perm:[1,0,3,2] row_mask:0xf bank_mask:0xf
  v_cndmask_b32_dpp v44, v24, v28, vcc quad_perm:[1,0,3,2] row_mask:0xf bank_mask:0xf
  v_cndmask_b32_dpp v45, v25, v29, vcc quad_perm:[1,0,3,2] row_mask:0xf bank_mask:0xf
  v_cndmask_b32_dpp v46, v26, v30, vcc quad_perm:[1,0,3,2] row_mask:0xf bank_mask:0xf
  v_cndmask_b32_dpp v47, v27, v31, vcc quad_perm:[1,0,3,2] row_mask:0xf bank_mask:0xf
  s_mov_b32 vcc_lo, 0x33333333
  s_mov_b32 vcc_hi, 0x33333333
  v_cndmask_b32_dpp v16, v40, v32, vcc quad_perm:[2,3,0,1] row_mask:0xf bank_mask:0xf
  v_cndmask_b32_dpp v17, v41, v33, vcc quad_perm:[2,3,0,1] row_mask:0xf bank_mask:0xf
  v_cndmask_b32_dpp v18, v42, v34, vcc quad_perm:[2,3,0,1] row_mask:0xf bank_mask:0xf
  v_cndmask_b32_dpp v19, v43, v35, vcc quad_perm:[2,3,0,1] row_mask:0xf bank_mask:0xf
  buffer_store_dwordx4 v[16:19], v201, s[44:47], s60 offen offset:0
  v_cndmask_b32_dpp v20, v44, v36, vcc quad_perm:[2,3,0,1] row_mask:0xf bank_mask:0xf
  v_cndmask_b32_dpp v21, v45, v37, vcc quad_perm:[2,3,0,1] row_mask:0xf bank_mask:0xf
  v_cndmask_b32_dpp v22, v46, v38, vcc quad_perm:[2,3,0,1] row_mask:0xf bank_mask:0xf
  v_cndmask_b32_dpp v23, v47, v39, vcc quad_perm:[2,3,0,1] row_mask:0xf bank_mask:0xf
  buffer_store_dwordx4 v[20:23], v201, s[44:47], s60 offen offset:2048
  s_mov_b32 vcc_lo, 0xcccccccc
  s_mov_b32 vcc_hi, 0xcccccccc
  v_cndmask_b32_dpp v24, v32, v40, vcc quad_perm:[2,3,0,1] row_mask:0xf bank_mask:0xf
  v_cndmask_b32_dpp v25, v33, v41, vcc quad_perm:[2,3,0,1] row_mask:0xf bank_mask:0xf
  v_cndmask_b32_dpp v26, v34, v42, vcc quad_perm:[2,3,0,1] row_mask:0xf bank_mask:0xf
  v_cndmask_b32_dpp v27, v35, v43, vcc quad_perm:[2,3,0,1] row_mask:0xf bank_mask:0xf
  s_add_u32 s60, s60, 4096
  buffer_store_dwordx4 v[24:27], v201, s[44:47], s60 offen offset:0
  v_cndmask_b32_dpp v28, v36, v44, vcc quad_perm:[2,3,0,1] row_mask:0xf bank_mask:0xf
  v_cndmask_b32_dpp v29, v37, v45, vcc quad_perm:[2,3,0,1] row_mask:0xf bank_mask:0xf
  v_cndmask_b32_dpp v30, v38, v46, vcc quad_perm:[2,3,0,1] row_mask:0xf bank_mask:0xf
  v_cndmask_b32_dpp v31, v39, v47, vcc quad_perm:[2,3,0,1] row_mask:0xf bank_mask:0xf
  buffer_store_dwordx4 v[28:31], v201, s[44:47], s60 offen offset:2048
  s_endpgm
PE8:
.p2align 12
PG9:
W0:
  s_branch W8
V0:
  ds_read_b128 v[72:75], v192 offset:8192
  ds_read_b128 v[76:79], v192 offset:23552
  s_nop 5
  v_pk_mul_f32 v[24:25], v[24:25], s[8:9]
  v_pk_mul_f32 v[26:27], v[26:27], s[8:9]
  v_pk_mul_f32 v[28:29], v[28:29], s[8:9]
  v_pk_mul_f32 v[30:31], v[30:31], s[8:9]
  v_cvt_pk_bf16_f32 v24, v24, v25
  v_cvt_pk_bf16_f32 v25, v26, v27
  v_cvt_pk_bf16_f32 v26, v28, v29
  v_cvt_pk_bf16_f32 v27, v30, v31
  ds_write_b128 v194, v[24:27] offset:4096
  v_pk_mul_f32 v[32:33], v[32:33], s[8:9]
  v_pk_mul_f32 v[34:35], v[34:35], s[8:9]
  v_pk_mul_f32 v[36:37], v[36:37], s[8:9]
  v_pk_mul_f32 v[38:39], v[38:39], s[8:9]
  v_cvt_pk_bf16_f32 v32, v32, v33
  v_cvt_pk_bf16_f32 v33, v34, v35
  v_cvt_pk_bf16_f32 v34, v36, v37
  v_cvt_pk_bf16_f32 v35, v38, v39
  ds_write_b128 v194, v[32:35] offset:0
  ds_write_b32 v171, v170
  v_pk_mul_f32 v[16:17], v[16:17], s[8:9]
  v_pk_mul_f32 v[18:19], v[18:19], s[8:9]
  v_pk_mul_f32 v[20:21], v[20:21], s[8:9]
  v_pk_mul_f32 v[22:23], v[22:23], s[8:9]
  v_pk_mul_f32 v[40:41], v[40:41], s[8:9]
  v_pk_mul_f32 v[42:43], v[42:43], s[8:9]
  v_pk_mul_f32 v[44:45], v[44:45], s[8:9]
  v_pk_mul_f32 v[46:47], v[46:47], s[8:9]
  v_cvt_pk_bf16_f32 v64, v16, v17
  v_cvt_pk_bf16_f32 v65, v18, v19
  v_cvt_pk_bf16_f32 v66, v20, v21
  v_cvt_pk_bf16_f32 v67, v22, v23
  v_cvt_pk_bf16_f32 v68, v40, v41
  v_cvt_pk_bf16_f32 v69, v42, v43
  s_waitcnt lgkmcnt(4)
  v_mfma_f32_32x32x16_bf16 v[96:111], v[72:75], v[64:67], v[220:235]
  v_cvt_pk_bf16_f32 v70, v44, v45
  v_cvt_pk_bf16_f32 v71, v46, v47
  s_nop 1
  s_waitcnt lgkmcnt(3)
  v_mfma_f32_32x32x16_bf16 v[112:127], v[76:79], v[68:71], v[220:235]
  ds_read_b128 v[72:75], v192 offset:22528
  s_nop 7
  v_exp_f32 v96, v96
  v_exp_f32 v97, v97
  v_exp_f32 v98, v98
  v_exp_f32 v99, v99
  v_exp_f32 v100, v100
  v_exp_f32 v101, v101
  v_exp_f32 v102, v102
  v_exp_f32 v103, v103
  v_cvt_pk_bf16_f32 v80, v96, v97
  v_exp_f32 v104, v104
  v_exp_f32 v105, v105
  v_cvt_pk_bf16_f32 v81, v98, v99
  v_exp_f32 v106, v106
  v_exp_f32 v107, v107
  s_mov_b64 exec, s[58:59]
  ds_read_b128 v[88:91], v193 offset:8192
  ds_read_b128 v[92:95], v193 offset:8704
  s_mov_b64 exec, -1
  v_cvt_pk_bf16_f32 v82, v100, v101
  v_cvt_pk_bf16_f32 v83, v102, v103
  v_exp_f32 v108, v108
  v_exp_f32 v109, v109
  v_cvt_pk_bf16_f32 v84, v104, v105
  v_exp_f32 v110, v110
  v_exp_f32 v111, v111
  v_cvt_pk_bf16_f32 v85, v106, v107
  v_cvt_pk_bf16_f32 v86, v108, v109
  v_cvt_pk_bf16_f32 v87, v110, v111
  s_waitcnt lgkmcnt(0)
  v_mfma_f32_32x32x16_bf16 v[96:111], v[72:75], v[68:71], 0
  ds_read_b128 v[76:79], v192 offset:21504
  v_exp_f32 v112, v112
  v_exp_f32 v113, v113
  v_exp_f32 v114, v114
  v_exp_f32 v115, v115
  v_exp_f32 v116, v116
  v_exp_f32 v117, v117
  v_mfma_f32_32x32x16_bf16 v[128:143], v[88:91], v[80:83], 0
  v_exp_f32 v118, v118
  v_exp_f32 v119, v119
  v_cvt_pk_bf16_f32 v80, v112, v113
  v_exp_f32 v120, v120
  v_exp_f32 v121, v121
  v_cvt_pk_bf16_f32 v81, v114, v115
  v_exp_f32 v122, v122
  v_exp_f32 v123, v123
  v_mfma_f32_32x32x16_bf16 v[128:143], v[92:95], v[84:87], v[128:143]
  s_mov_b64 exec, s[58:59]
  ds_read_b128 v[88:91], v193 offset:23552
  ds_read_b128 v[92:95], v193 offset:24064
  s_mov_b64 exec, -1
  v_cvt_pk_bf16_f32 v82, v116, v117
  v_cvt_pk_bf16_f32 v83, v118, v119
  v_exp_f32 v124, v124
  v_exp_f32 v125, v125
  v_cvt_pk_bf16_f32 v84, v120, v121
  v_exp_f32 v126, v126
  v_exp_f32 v127, v127
  v_cvt_pk_bf16_f32 v85, v122, v123
  v_cvt_pk_bf16_f32 v86, v124, v125
  v_cvt_pk_bf16_f32 v87, v126, v127
  s_waitcnt lgkmcnt(0)
  v_mfma_f32_32x32x16_bf16 v[112:127], v[76:79], v[68:71], 0
  ds_read_b128 v[72:75], v192 offset:20480
  v_exp_f32 v96, v96
  v_exp_f32 v97, v97
  v_exp_f32 v98, v98
  v_exp_f32 v99, v99
  v_exp_f32 v100, v100
  v_exp_f32 v101, v101
  v_mfma_f32_32x32x16_bf16 v[144:159], v[88:91], v[80:83], 0
  v_exp_f32 v102, v102
  v_exp_f32 v103, v103
  v_cvt_pk_bf16_f32 v80, v96, v97
  v_exp_f32 v104, v104
  v_exp_f32 v105, v105
  v_cvt_pk_bf16_f32 v81, v98, v99
  v_exp_f32 v106, v106
  v_exp_f32 v107, v107
  v_mfma_f32_32x32x16_bf16 v[144:159], v[92:95], v[84:87], v[144:159]
  s_mov_b64 exec, s[58:59]
  ds_read_b128 v[88:91], v193 offset:22528
  ds_read_b128 v[92:95], v193 offset:23040
  s_mov_b64 exec, -1
  v_cvt_pk_bf16_f32 v82, v100, v101
  v_cvt_pk_bf16_f32 v83, v102, v103
  v_exp_f32 v108, v108
  v_exp_f32 v109, v109
  v_cvt_pk_bf16_f32 v84, v104, v105
  v_exp_f32 v110, v110
  v_exp_f32 v111, v111
  v_cvt_pk_bf16_f32 v85, v106, v107
  v_cvt_pk_bf16_f32 v86, v108, v109
  v_cvt_pk_bf16_f32 v87, v110, v111
  s_waitcnt lgkmcnt(0)
  v_mfma_f32_32x32x16_bf16 v[96:111], v[72:75], v[68:71], 0
  v_exp_f32 v112, v112
  v_exp_f32 v113, v113
  v_exp_f32 v114, v114
  v_exp_f32 v115, v115
  v_exp_f32 v116, v116
  v_exp_f32 v117, v117
  v_mfma_f32_32x32x16_bf16 v[144:159], v[88:91], v[80:83], v[144:159]
  v_exp_f32 v118, v118
  v_exp_f32 v119, v119
  v_cvt_pk_bf16_f32 v80, v112, v113
  v_exp_f32 v120, v120
  v_exp_f32 v121, v121
  v_cvt_pk_bf16_f32 v81, v114, v115
  v_exp_f32 v122, v122
  v_exp_f32 v123, v123
  v_mfma_f32_32x32x16_bf16 v[144:159], v[92:95], v[84:87], v[144:159]
  s_mov_b64 exec, s[58:59]
  ds_read_b128 v[88:91], v193 offset:21504
  ds_read_b128 v[92:95], v193 offset:22016
  s_mov_b64 exec, -1
  v_cvt_pk_bf16_f32 v82, v116, v117
  v_cvt_pk_bf16_f32 v83, v118, v119
  v_exp_f32 v124, v124
  v_exp_f32 v125, v125
  v_cvt_pk_bf16_f32 v84, v120, v121
  v_exp_f32 v126, v126
  v_exp_f32 v127, v127
  v_cvt_pk_bf16_f32 v85, v122, v123
  v_cvt_pk_bf16_f32 v86, v124, v125
  v_cvt_pk_bf16_f32 v87, v126, v127
  s_waitcnt lgkmcnt(0)
  v_exp_f32 v96, v96
  v_exp_f32 v97, v97
  v_exp_f32 v98, v98
  v_exp_f32 v99, v99
  v_exp_f32 v100, v100
  v_exp_f32 v101, v101
  v_mfma_f32_32x32x16_bf16 v[144:159], v[88:91], v[80:83], v[144:159]
  v_exp_f32 v102, v102
  v_exp_f32 v103, v103
  v_cvt_pk_bf16_f32 v80, v96, v97
  v_exp_f32 v104, v104
  v_exp_f32 v105, v105
  v_cvt_pk_bf16_f32 v81, v98, v99
  v_exp_f32 v106, v106
  v_exp_f32 v107, v107
  v_mfma_f32_32x32x16_bf16 v[144:159], v[92:95], v[84:87], v[144:159]
  s_mov_b64 exec, s[58:59]
  ds_read_b128 v[88:91], v193 offset:20480
  ds_read_b128 v[92:95], v193 offset:20992
  s_mov_b64 exec, -1
  v_cvt_pk_bf16_f32 v82, v100, v101
  v_cvt_pk_bf16_f32 v83, v102, v103
  v_exp_f32 v108, v108
  v_exp_f32 v109, v109
  v_cvt_pk_bf16_f32 v84, v104, v105
  v_exp_f32 v110, v110
  v_exp_f32 v111, v111
  v_cvt_pk_bf16_f32 v85, v106, v107
  v_cvt_pk_bf16_f32 v86, v108, v109
  v_cvt_pk_bf16_f32 v87, v110, v111
  s_barrier
  buffer_load_dword v252, v196, s[32:35], 0 offen
  ds_read_b128 v[76:79], v192 offset:7168
  ds_read_b128 v[72:75], v192 offset:6144
  s_waitcnt lgkmcnt(3)
  v_mfma_f32_32x32x16_bf16 v[144:159], v[88:91], v[80:83], v[144:159]
  s_waitcnt lgkmcnt(2)
  v_mfma_f32_32x32x16_bf16 v[144:159], v[92:95], v[84:87], v[144:159]
  s_waitcnt lgkmcnt(1)
  v_mfma_f32_32x32x16_bf16 v[112:127], v[76:79], v[64:67], v[172:187]
  s_waitcnt lgkmcnt(0)
  v_mfma_f32_32x32x16_bf16 v[96:111], v[72:75], v[64:67], v[172:187]
  ds_read_b128 v[76:79], v192 offset:5120
  s_nop 8
  v_exp_f32 v112, v112
  v_exp_f32 v113, v113
  v_exp_f32 v114, v114
  v_exp_f32 v115, v115
  v_exp_f32 v116, v116
  v_exp_f32 v117, v117
  v_exp_f32 v118, v118
  v_exp_f32 v119, v119
  v_cvt_pk_bf16_f32 v80, v112, v113
  v_exp_f32 v120, v120
  v_exp_f32 v121, v121
  v_cvt_pk_bf16_f32 v81, v114, v115
  v_exp_f32 v122, v122
  v_exp_f32 v123, v123
  s_mov_b64 exec, s[58:59]
  ds_read_b128 v[88:91], v193 offset:7168
  ds_read_b128 v[92:95], v193 offset:7680
  s_mov_b64 exec, -1
  v_cvt_pk_bf16_f32 v82, v116, v117
  v_cvt_pk_bf16_f32 v83, v118, v119
  v_exp_f32 v124, v124
  v_exp_f32 v125, v125
  v_cvt_pk_bf16_f32 v84, v120, v121
  v_exp_f32 v126, v126
  v_exp_f32 v127, v127
  v_cvt_pk_bf16_f32 v85, v122, v123
  v_cvt_pk_bf16_f32 v86, v124, v125
  v_cvt_pk_bf16_f32 v87, v126, v127
  s_waitcnt lgkmcnt(0)
  v_mfma_f32_32x32x16_bf16 v[112:127], v[76:79], v[64:67], v[172:187]
  ds_read_b128 v[72:75], v192 offset:4096
  v_exp_f32 v96, v96
  v_exp_f32 v97, v97
  v_exp_f32 v98, v98
  v_exp_f32 v99, v99
  v_exp_f32 v100, v100
  v_exp_f32 v101, v101
  v_mfma_f32_32x32x16_bf16 v[128:143], v[88:91], v[80:83], v[128:143]
  v_exp_f32 v102, v102
  v_exp_f32 v103, v103
  v_cvt_pk_bf16_f32 v80, v96, v97
  v_exp_f32 v104, v104
  v_exp_f32 v105, v105
  v_cvt_pk_bf16_f32 v81, v98, v99
  v_exp_f32 v106, v106
  v_exp_f32 v107, v107
  v_mfma_f32_32x32x16_bf16 v[128:143], v[92:95], v[84:87], v[128:143]
  s_mov_b64 exec, s[58:59]
  ds_read_b128 v[88:91], v193 offset:6144
  ds_read_b128 v[92:95], v193 offset:6656
  s_mov_b64 exec, -1
  v_cvt_pk_bf16_f32 v82, v100, v101
  v_cvt_pk_bf16_f32 v83, v102, v103
  v_exp_f32 v108, v108
  v_exp_f32 v109, v109
  v_cvt_pk_bf16_f32 v84, v104, v105
  v_exp_f32 v110, v110
  v_exp_f32 v111, v111
  v_cvt_pk_bf16_f32 v85, v106, v107
  v_cvt_pk_bf16_f32 v86, v108, v109
  v_cvt_pk_bf16_f32 v87, v110, v111
  s_waitcnt lgkmcnt(0)
  v_mfma_f32_32x32x16_bf16 v[96:111], v[72:75], v[64:67], v[172:187]
  ds_read_b128 v[76:79], v192 offset:3072
  v_exp_f32 v112, v112
  v_exp_f32 v113, v113
  v_exp_f32 v114, v114
  v_exp_f32 v115, v115
  v_exp_f32 v116, v116
  v_exp_f32 v117, v117
  v_mfma_f32_32x32x16_bf16 v[128:143], v[88:91], v[80:83], v[128:143]
  v_exp_f32 v118, v118
  v_exp_f32 v119, v119
  v_cvt_pk_bf16_f32 v80, v112, v113
  v_exp_f32 v120, v120
  v_exp_f32 v121, v121
  v_cvt_pk_bf16_f32 v81, v114, v115
  v_exp_f32 v122, v122
  v_exp_f32 v123, v123
  v_mfma_f32_32x32x16_bf16 v[128:143], v[92:95], v[84:87], v[128:143]
  s_mov_b64 exec, s[58:59]
  ds_read_b128 v[88:91], v193 offset:5120
  ds_read_b128 v[92:95], v193 offset:5632
  s_mov_b64 exec, -1
  v_cvt_pk_bf16_f32 v82, v116, v117
  v_cvt_pk_bf16_f32 v83, v118, v119
  v_exp_f32 v124, v124
  v_exp_f32 v125, v125
  v_cvt_pk_bf16_f32 v84, v120, v121
  v_exp_f32 v126, v126
  v_exp_f32 v127, v127
  v_cvt_pk_bf16_f32 v85, v122, v123
  v_cvt_pk_bf16_f32 v86, v124, v125
  v_cvt_pk_bf16_f32 v87, v126, v127
  s_waitcnt lgkmcnt(0)
  v_mfma_f32_32x32x16_bf16 v[112:127], v[76:79], v[64:67], v[202:217]
  ds_read_b128 v[72:75], v192 offset:2048
  v_exp_f32 v96, v96
  v_exp_f32 v97, v97
  v_exp_f32 v98, v98
  v_exp_f32 v99, v99
  v_exp_f32 v100, v100
  v_exp_f32 v101, v101
  v_mfma_f32_32x32x16_bf16 v[128:143], v[88:91], v[80:83], v[128:143]
  v_exp_f32 v102, v102
  v_exp_f32 v103, v103
  v_cvt_pk_bf16_f32 v80, v96, v97
  v_exp_f32 v104, v104
  v_exp_f32 v105, v105
  v_cvt_pk_bf16_f32 v81, v98, v99
  v_exp_f32 v106, v106
  v_exp_f32 v107, v107
  v_mfma_f32_32x32x16_bf16 v[128:143], v[92:95], v[84:87], v[128:143]
  s_mov_b64 exec, s[58:59]
  ds_read_b128 v[88:91], v193 offset:4096
  ds_read_b128 v[92:95], v193 offset:4608
  s_mov_b64 exec, -1
  v_cvt_pk_bf16_f32 v82, v100, v101
  v_cvt_pk_bf16_f32 v83, v102, v103
  v_exp_f32 v108, v108
  v_exp_f32 v109, v109
  v_cvt_pk_bf16_f32 v84, v104, v105
  v_exp_f32 v110, v110
  v_exp_f32 v111, v111
  v_cvt_pk_bf16_f32 v85, v106, v107
  v_cvt_pk_bf16_f32 v86, v108, v109
  v_cvt_pk_bf16_f32 v87, v110, v111
  s_waitcnt lgkmcnt(0)
  v_mfma_f32_32x32x16_bf16 v[96:111], v[72:75], v[64:67], v[202:217]
  ds_read_b128 v[76:79], v192 offset:1024
  v_exp_f32 v112, v112
  v_exp_f32 v113, v113
  v_exp_f32 v114, v114
  v_exp_f32 v115, v115
  v_exp_f32 v116, v116
  v_exp_f32 v117, v117
  v_mfma_f32_32x32x16_bf16 v[128:143], v[88:91], v[80:83], v[128:143]
  v_exp_f32 v118, v118
  v_exp_f32 v119, v119
  v_cvt_pk_bf16_f32 v80, v112, v113
  v_exp_f32 v120, v120
  v_exp_f32 v121, v121
  v_cvt_pk_bf16_f32 v81, v114, v115
  v_exp_f32 v122, v122
  v_exp_f32 v123, v123
  v_mfma_f32_32x32x16_bf16 v[128:143], v[92:95], v[84:87], v[128:143]
  s_mov_b64 exec, s[58:59]
  ds_read_b128 v[88:91], v193 offset:3072
  ds_read_b128 v[92:95], v193 offset:3584
  s_mov_b64 exec, -1
  v_cvt_pk_bf16_f32 v82, v116, v117
  v_cvt_pk_bf16_f32 v83, v118, v119
  v_exp_f32 v124, v124
  v_exp_f32 v125, v125
  v_cvt_pk_bf16_f32 v84, v120, v121
  v_exp_f32 v126, v126
  v_exp_f32 v127, v127
  v_cvt_pk_bf16_f32 v85, v122, v123
  v_cvt_pk_bf16_f32 v86, v124, v125
  v_cvt_pk_bf16_f32 v87, v126, v127
  s_waitcnt lgkmcnt(0)
  v_mfma_f32_32x32x16_bf16 v[112:127], v[76:79], v[64:67], v[202:217]
  ds_read_b128 v[72:75], v192 offset:0
  v_exp_f32 v96, v96
  v_exp_f32 v97, v97
  v_exp_f32 v98, v98
  v_exp_f32 v99, v99
  v_exp_f32 v100, v100
  v_exp_f32 v101, v101
  v_mfma_f32_32x32x16_bf16 v[128:143], v[88:91], v[80:83], v[128:143]
  v_exp_f32 v102, v102
  v_exp_f32 v103, v103
  v_cvt_pk_bf16_f32 v80, v96, v97
  v_exp_f32 v104, v104
  v_exp_f32 v105, v105
  v_cvt_pk_bf16_f32 v81, v98, v99
  v_exp_f32 v106, v106
  v_exp_f32 v107, v107
  v_mfma_f32_32x32x16_bf16 v[128:143], v[92:95], v[84:87], v[128:143]
  s_mov_b64 exec, s[58:59]
  ds_read_b128 v[88:91], v193 offset:2048
  ds_read_b128 v[92:95], v193 offset:2560
  s_mov_b64 exec, -1
  v_cvt_pk_bf16_f32 v82, v100, v101
  v_cvt_pk_bf16_f32 v83, v102, v103
  v_exp_f32 v108, v108
  v_exp_f32 v109, v109
  v_cvt_pk_bf16_f32 v84, v104, v105
  v_exp_f32 v110, v110
  v_exp_f32 v111, v111
  v_cvt_pk_bf16_f32 v85, v106, v107
  v_cvt_pk_bf16_f32 v86, v108, v109
  v_cvt_pk_bf16_f32 v87, v110, v111
  s_waitcnt lgkmcnt(0)
  v_mfma_f32_32x32x16_bf16 v[96:111], v[72:75], v[64:67], v[236:251]
  ds_read_b128 v[76:79], v192 offset:19456
  v_exp_f32 v112, v112
  v_exp_f32 v113, v113
  v_exp_f32 v114, v114
  v_exp_f32 v115, v115
  v_exp_f32 v116, v116
  v_exp_f32 v117, v117
  v_mfma_f32_32x32x16_bf16 v[128:143], v[88:91], v[80:83], v[128:143]
  v_exp_f32 v118, v118
  v_exp_f32 v119, v119
  v_cvt_pk_bf16_f32 v80, v112, v113
  v_exp_f32 v120, v120
  v_exp_f32 v121, v121
  v_cvt_pk_bf16_f32 v81, v114, v115
  v_exp_f32 v122, v122
  v_exp_f32 v123, v123
  v_mfma_f32_32x32x16_bf16 v[128:143], v[92:95], v[84:87], v[128:143]
  s_mov_b64 exec, s[58:59]
  ds_read_b128 v[88:91], v193 offset:1024
  ds_read_b128 v[92:95], v193 offset:1536
  s_mov_b64 exec, -1
  v_cvt_pk_bf16_f32 v82, v116, v117
  v_cvt_pk_bf16_f32 v83, v118, v119
  v_exp_f32 v124, v124
  v_exp_f32 v125, v125
  v_cvt_pk_bf16_f32 v84, v120, v121
  v_exp_f32 v126, v126
  v_exp_f32 v127, v127
  v_cvt_pk_bf16_f32 v85, v122, v123
  v_cvt_pk_bf16_f32 v86, v124, v125
  v_cvt_pk_bf16_f32 v87, v126, v127
  s_waitcnt lgkmcnt(0)
  v_mfma_f32_32x32x16_bf16 v[112:127], v[76:79], v[68:71], v[172:187]
  ds_read_b128 v[72:75], v192 offset:18432
  v_exp_f32 v96, v96
  v_exp_f32 v97, v97
  v_exp_f32 v98, v98
  v_exp_f32 v99, v99
  v_exp_f32 v100, v100
  v_exp_f32 v101, v101
  v_mfma_f32_32x32x16_bf16 v[128:143], v[88:91], v[80:83], v[128:143]
  v_exp_f32 v102, v102
  v_exp_f32 v103, v103
  v_cvt_pk_bf16_f32 v80, v96, v97
  v_exp_f32 v104, v104
  v_exp_f32 v105, v105
  v_cvt_pk_bf16_f32 v81, v98, v99
  v_exp_f32 v106, v106
  v_exp_f32 v107, v107
  v_mfma_f32_32x32x16_bf16 v[128:143], v[92:95], v[84:87], v[128:143]
  s_mov_b64 exec, s[58:59]
  ds_read_b128 v[88:91], v193 offset:0
  ds_read_b128 v[92:95], v193 offset:512
  s_mov_b64 exec, -1
  v_cvt_pk_bf16_f32 v82, v100, v101
  v_cvt_pk_bf16_f32 v83, v102, v103
  v_exp_f32 v108, v108
  v_exp_f32 v109, v109
  v_cvt_pk_bf16_f32 v84, v104, v105
  v_exp_f32 v110, v110
  v_exp_f32 v111, v111
  v_cvt_pk_bf16_f32 v85, v106, v107
  v_cvt_pk_bf16_f32 v86, v108, v109
  v_cvt_pk_bf16_f32 v87, v110, v111
  s_waitcnt lgkmcnt(0)
  v_mfma_f32_32x32x16_bf16 v[96:111], v[72:75], v[68:71], v[172:187]
  ds_read_b128 v[76:79], v192 offset:17408
  v_exp_f32 v112, v112
  v_exp_f32 v113, v113
  v_exp_f32 v114, v114
  v_exp_f32 v115, v115
  v_exp_f32 v116, v116
  v_exp_f32 v117, v117
  v_mfma_f32_32x32x16_bf16 v[128:143], v[88:91], v[80:83], v[128:143]
  v_exp_f32 v118, v118
  v_exp_f32 v119, v119
  v_cvt_pk_bf16_f32 v80, v112, v113
  v_exp_f32 v120, v120
  v_exp_f32 v121, v121
  v_cvt_pk_bf16_f32 v81, v114, v115
  v_exp_f32 v122, v122
  v_exp_f32 v123, v123
  v_mfma_f32_32x32x16_bf16 v[128:143], v[92:95], v[84:87], v[128:143]
  s_mov_b64 exec, s[58:59]
  ds_read_b128 v[88:91], v193 offset:19456
  ds_read_b128 v[92:95], v193 offset:19968
  s_mov_b64 exec, -1
  v_cvt_pk_bf16_f32 v82, v116, v117
  v_cvt_pk_bf16_f32 v83, v118, v119
  v_exp_f32 v124, v124
  v_exp_f32 v125, v125
  v_cvt_pk_bf16_f32 v84, v120, v121
  v_exp_f32 v126, v126
  v_exp_f32 v127, v127
  v_cvt_pk_bf16_f32 v85, v122, v123
  v_cvt_pk_bf16_f32 v86, v124, v125
  v_cvt_pk_bf16_f32 v87, v126, v127
  v_med3_f32 v14, v136, s56, v197
  v_cmp_neq_f32 vcc, v14, v136
  s_cbranch_vccnz FB0
FBDa0:
  v_rcp_f32 v14, v136
  s_nop 0
  v_mul_f32 v128, v128, v14
  v_mul_f32 v129, v129, v14
  v_mul_f32 v130, v130, v14
  v_mul_f32 v131, v131, v14
  v_mul_f32 v132, v132, v14
  v_mul_f32 v133, v133, v14
  v_mul_f32 v134, v134, v14
  v_mul_f32 v135, v135, v14
  v_cvt_pk_bf16_f32 v56, v128, v129
  v_cvt_pk_bf16_f32 v57, v130, v131
  v_cvt_pk_bf16_f32 v58, v132, v133
  v_cvt_pk_bf16_f32 v59, v134, v135
  s_cmp_eq_u32 s19, 0
  s_cbranch_scc1 DU_A6
  buffer_store_dwordx4 v[56:59], v1, s[32:35], s12 offen
DU_B6:
  buffer_load_dword v12, v198, s[32:35], 0 offen sc1
  s_waitcnt lgkmcnt(0)
  v_mfma_f32_32x32x16_bf16 v[112:127], v[76:79], v[68:71], v[172:187]
  ds_read_b128 v[72:75], v192 offset:16384
  v_exp_f32 v96, v96
  v_exp_f32 v97, v97
  v_exp_f32 v98, v98
  v_exp_f32 v99, v99
  v_exp_f32 v100, v100
  v_exp_f32 v101, v101
  v_mfma_f32_32x32x16_bf16 v[144:159], v[88:91], v[80:83], v[144:159]
  v_exp_f32 v102, v102
  v_exp_f32 v103, v103
  v_cvt_pk_bf16_f32 v80, v96, v97
  v_exp_f32 v104, v104
  v_exp_f32 v105, v105
  v_cvt_pk_bf16_f32 v81, v98, v99
  v_exp_f32 v106, v106
  v_exp_f32 v107, v107
  v_mfma_f32_32x32x16_bf16 v[144:159], v[92:95], v[84:87], v[144:159]
  s_mov_b64 exec, s[58:59]
  ds_read_b128 v[88:91], v193 offset:18432
  ds_read_b128 v[92:95], v193 offset:18944
  s_mov_b64 exec, -1
  v_cvt_pk_bf16_f32 v82, v100, v101
  v_cvt_pk_bf16_f32 v83, v102, v103
  v_exp_f32 v108, v108
  v_exp_f32 v109, v109
  v_cvt_pk_bf16_f32 v84, v104, v105
  v_exp_f32 v110, v110
  v_exp_f32 v111, v111
  v_cvt_pk_bf16_f32 v85, v106, v107
  v_cvt_pk_bf16_f32 v86, v108, v109
  v_cvt_pk_bf16_f32 v87, v110, v111
  s_waitcnt lgkmcnt(0)
  v_mfma_f32_32x32x16_bf16 v[96:111], v[72:75], v[68:71], v[172:187]
  ds_read_b128 v[76:79], v192 offset:15360
  v_exp_f32 v112, v112
  v_exp_f32 v113, v113
  v_exp_f32 v114, v114
  v_exp_f32 v115, v115
  v_exp_f32 v116, v116
  v_exp_f32 v117, v117
  v_mfma_f32_32x32x16_bf16 v[144:159], v[88:91], v[80:83], v[144:159]
  v_exp_f32 v118, v118
  v_exp_f32 v119, v119
  v_cvt_pk_bf16_f32 v80, v112, v113
  v_exp_f32 v120, v120
  v_exp_f32 v121, v121
  v_cvt_pk_bf16_f32 v81, v114, v115
  v_exp_f32 v122, v122
  v_exp_f32 v123, v123
  v_mfma_f32_32x32x16_bf16 v[144:159], v[92:95], v[84:87], v[144:159]
  s_mov_b64 exec, s[58:59]
  ds_read_b128 v[88:91], v193 offset:17408
  ds_read_b128 v[92:95], v193 offset:17920
  s_mov_b64 exec, -1
  v_cvt_pk_bf16_f32 v82, v116, v117
  v_cvt_pk_bf16_f32 v83, v118, v119
  v_exp_f32 v124, v124
  v_exp_f32 v125, v125
  v_cvt_pk_bf16_f32 v84, v120, v121
  v_exp_f32 v126, v126
  v_exp_f32 v127, v127
  v_cvt_pk_bf16_f32 v85, v122, v123
  v_cvt_pk_bf16_f32 v86, v124, v125
  v_cvt_pk_bf16_f32 v87, v126, v127
  s_waitcnt vmcnt(0)
  v_cmp_ne_u32 vcc, s52, v12
  s_and_b64 vcc, vcc, s[16:17]
  s_mov_b32 s7, 4000
  s_cbranch_vccnz POLL_L7
POLL_D7:
  buffer_load_dword v12, v198, s[32:35], 0 offen sc1
  buffer_load_dwordx4 v[16:19], v1, s[32:35], s80 offen offset:0 sc1
  buffer_load_dwordx4 v[20:23], v1, s[32:35], s81 offen offset:0 sc1
  buffer_load_dwordx4 v[24:27], v1, s[32:35], s82 offen offset:0 sc1
  buffer_load_dwordx4 v[28:31], v1, s[32:35], s83 offen offset:0 sc1
  buffer_load_dwordx4 v[32:35], v1, s[32:35], s84 offen offset:0 sc1
  buffer_load_dwordx4 v[36:39], v1, s[32:35], s85 offen offset:0 sc1
  buffer_load_dwordx4 v[40:43], v1, s[32:35], s86 offen offset:0 sc1
  buffer_load_dwordx4 v[44:47], v1, s[32:35], s87 offen offset:0 sc1
  s_waitcnt lgkmcnt(0)
  v_mfma_f32_32x32x16_bf16 v[112:127], v[76:79], v[68:71], v[236:251]
  v_exp_f32 v96, v96
  v_exp_f32 v97, v97
  v_exp_f32 v98, v98
  v_exp_f32 v99, v99
  v_exp_f32 v100, v100
  v_exp_f32 v101, v101
  v_mfma_f32_32x32x16_bf16 v[144:159], v[88:91], v[80:83], v[144:159]
  v_exp_f32 v102, v102
  v_exp_f32 v103, v103
  v_cvt_pk_bf16_f32 v80, v96, v97
  v_exp_f32 v104, v104
  v_exp_f32 v105, v105
  v_cvt_pk_bf16_f32 v81, v98, v99
  v_exp_f32 v106, v106
  v_exp_f32 v107, v107
  v_mfma_f32_32x32x16_bf16 v[144:159], v[92:95], v[84:87], v[144:159]
  s_mov_b64 exec, s[58:59]
  ds_read_b128 v[88:91], v193 offset:16384
  ds_read_b128 v[92:95], v193 offset:16896
  s_mov_b64 exec, -1
  v_cvt_pk_bf16_f32 v82, v100, v101
  v_cvt_pk_bf16_f32 v83, v102, v103
  v_exp_f32 v108, v108
  v_exp_f32 v109, v109
  v_cvt_pk_bf16_f32 v84, v104, v105
  v_exp_f32 v110, v110
  v_exp_f32 v111, v111
  v_cvt_pk_bf16_f32 v85, v106, v107
  v_cvt_pk_bf16_f32 v86, v108, v109
  v_cvt_pk_bf16_f32 v87, v110, v111
  s_waitcnt lgkmcnt(0)
  v_exp_f32 v112, v112
  v_exp_f32 v113, v113
  v_exp_f32 v114, v114
  v_exp_f32 v115, v115
  v_exp_f32 v116, v116
  v_exp_f32 v117, v117
  v_mfma_f32_32x32x16_bf16 v[144:159], v[88:91], v[80:83], v[144:159]
  v_exp_f32 v118, v118
  v_exp_f32 v119, v119
  v_cvt_pk_bf16_f32 v80, v112, v113
  v_exp_f32 v120, v120
  v_exp_f32 v121, v121
  v_cvt_pk_bf16_f32 v81, v114, v115
  v_exp_f32 v122, v122
  v_exp_f32 v123, v123
  v_mfma_f32_32x32x16_bf16 v[144:159], v[92:95], v[84:87], v[144:159]
  s_mov_b64 exec, s[58:59]
  ds_read_b128 v[88:91], v193 offset:15360
  ds_read_b128 v[92:95], v193 offset:15872
  s_mov_b64 exec, -1
  v_cvt_pk_bf16_f32 v82, v116, v117
  v_cvt_pk_bf16_f32 v83, v118, v119
  v_exp_f32 v124, v124
  v_exp_f32 v125, v125
  v_cvt_pk_bf16_f32 v84, v120, v121
  v_exp_f32 v126, v126
  v_exp_f32 v127, v127
  v_cvt_pk_bf16_f32 v85, v122, v123
  v_cvt_pk_bf16_f32 v86, v124, v125
  v_cvt_pk_bf16_f32 v87, v126, v127
  s_branch H_FIN
PE9:
.p2align 12
PG10:
W1:
  s_branch W8
V1:
  ds_read_b128 v[72:75], v192 offset:9216
  ds_read_b128 v[76:79], v192 offset:22528
  s_nop 5
  v_pk_mul_f32 v[24:25], v[24:25], s[8:9]
  v_pk_mul_f32 v[26:27], v[26:27], s[8:9]
  v_pk_mul_f32 v[28:29], v[28:29], s[8:9]
  v_pk_mul_f32 v[30:31], v[30:31], s[8:9]
  v_cvt_pk_bf16_f32 v24, v24, v25
  v_cvt_pk_bf16_f32 v25, v26, v27
  v_cvt_pk_bf16_f32 v26, v28, v29
  v_cvt_pk_bf16_f32 v27, v30, v31
  ds_write_b128 v194, v[24:27] offset:4096
  v_pk_mul_f32 v[32:33], v[32:33], s[8:9]
  v_pk_mul_f32 v[34:35], v[34:35], s[8:9]
  v_pk_mul_f32 v[36:37], v[36:37], s[8:9]
  v_pk_mul_f32 v[38:39], v[38:39], s[8:9]
  v_cvt_pk_bf16_f32 v32, v32, v33
  v_cvt_pk_bf16_f32 v33, v34, v35
  v_cvt_pk_bf16_f32 v34, v36, v37
  v_cvt_pk_bf16_f32 v35, v38, v39
  ds_write_b128 v194, v[32:35] offset:0
  ds_write_b32 v171, v170
  v_pk_mul_f32 v[16:17], v[16:17], s[8:9]
  v_pk_mul_f32 v[18:19], v[18:19], s[8:9]
  v_pk_mul_f32 v[20:21], v[20:21], s[8:9]
  v_pk_mul_f32 v[22:23], v[22:23], s[8:9]
  v_pk_mul_f32 v[40:41], v[40:41], s[8:9]
  v_pk_mul_f32 v[42:43], v[42:43], s[8:9]
  v_pk_mul_f32 v[44:45], v[44:45], s[8:9]
  v_pk_mul_f32 v[46:47], v[46:47], s[8:9]
  v_cvt_pk_bf16_f32 v64, v16, v17
  v_cvt_pk_bf16_f32 v65, v18, v19
  v_cvt_pk_bf16_f32 v66, v20, v21
  v_cvt_pk_bf16_f32 v67, v22, v23
  v_cvt_pk_bf16_f32 v68, v40, v41
  v_cvt_pk_bf16_f32 v69, v42, v43
  s_waitcnt lgkmcnt(4)
  v_mfma_f32_32x32x16_bf16 v[96:111], v[72:75], v[64:67], v[220:235]
  v_cvt_pk_bf16_f32 v70, v44, v45
  v_cvt_pk_bf16_f32 v71, v46, v47
  s_nop 1
  s_waitcnt lgkmcnt(3)
  v_mfma_f32_32x32x16_bf16 v[112:127], v[76:79], v[68:71], v[220:235]
  ds_read_b128 v[72:75], v192 offset:8192
  s_nop 7
  v_exp_f32 v96, v96
  v_exp_f32 v97, v97
  v_exp_f32 v98, v98
  v_exp_f32 v99, v99
  v_exp_f32 v100, v100
  v_exp_f32 v101, v101
  v_exp_f32 v102, v102
  v_exp_f32 v103, v103
  v_cvt_pk_bf16_f32 v80, v96, v97
  v_exp_f32 v104, v104
  v_exp_f32 v105, v105
  v_cvt_pk_bf16_f32 v81, v98, v99
  v_exp_f32 v106, v106
  v_exp_f32 v107, v107
  s_mov_b64 exec, s[58:59]
  ds_read_b128 v[88:91], v193 offset:9216
  ds_read_b128 v[92:95], v193 offset:9728
  s_mov_b64 exec, -1
  v_cvt_pk_bf16_f32 v82, v100, v101
  v_cvt_pk_bf16_f32 v83, v102, v103
  v_exp_f32 v108, v108
  v_exp_f32 v109, v109
  v_cvt_pk_bf16_f32 v84, v104, v105
  v_exp_f32 v110, v110
  v_exp_f32 v111, v111
  v_cvt_pk_bf16_f32 v85, v106, v107
  v_cvt_pk_bf16_f32 v86, v108, v109
  v_cvt_pk_bf16_f32 v87, v110, v111
  s_waitcnt lgkmcnt(0)
  v_mfma_f32_32x32x16_bf16 v[96:111], v[72:75], v[64:67], 0
  ds_read_b128 v[76:79], v192 offset:21504
  v_exp_f32 v112, v112
  v_exp_f32 v113, v113
  v_exp_f32 v114, v114
  v_exp_f32 v115, v115
  v_exp_f32 v116, v116
  v_exp_f32 v117, v117
  v_mfma_f32_32x32x16_bf16 v[128:143], v[88:91], v[80:83], 0
  v_exp_f32 v118, v118
  v_exp_f32 v119, v119
  v_cvt_pk_bf16_f32 v80, v112, v113
  v_exp_f32 v120, v120
  v_exp_f32 v121, v121
  v_cvt_pk_bf16_f32 v81, v114, v115
  v_exp_f32 v122, v122
  v_exp_f32 v123, v123
  v_mfma_f32_32x32x16_bf16 v[128:143], v[92:95], v[84:87], v[128:143]
  s_mov_b64 exec, s[58:59]
  ds_read_b128 v[88:91], v193 offset:22528
  ds_read_b128 v[92:95], v193 offset:23040
  s_mov_b64 exec, -1
  v_cvt_pk_bf16_f32 v82, v116, v117
  v_cvt_pk_bf16_f32 v83, v118, v119
  v_exp_f32 v124, v124
  v_exp_f32 v125, v125
  v_cvt_pk_bf16_f32 v84, v120, v121
  v_exp_f32 v126, v126
  v_exp_f32 v127, v127
  v_cvt_pk_bf16_f32 v85, v122, v123
  v_cvt_pk_bf16_f32 v86, v124, v125
  v_cvt_pk_bf16_f32 v87, v126, v127
  s_waitcnt lgkmcnt(0)
  v_mfma_f32_32x32x16_bf16 v[112:127], v[76:79], v[68:71], 0
  ds_read_b128 v[72:75], v192 offset:20480
  v_exp_f32 v96, v96
  v_exp_f32 v97, v97
  v_exp_f32 v98, v98
  v_exp_f32 v99, v99
  v_exp_f32 v100, v100
  v_exp_f32 v101, v101
  v_mfma_f32_32x32x16_bf16 v[144:159], v[88:91], v[80:83], 0
  v_exp_f32 v102, v102
  v_exp_f32 v103, v103
  v_cvt_pk_bf16_f32 v80, v96, v97
  v_exp_f32 v104, v104
  v_exp_f32 v105, v105
  v_cvt_pk_bf16_f32 v81, v98, v99
  v_exp_f32 v106, v106
  v_exp_f32 v107, v107
  v_mfma_f32_32x32x16_bf16 v[144:159], v[92:95], v[84:87], v[144:159]
  s_mov_b64 exec, s[58:59]
  ds_read_b128 v[88:91], v193 offset:8192
  ds_read_b128 v[92:95], v193 offset:8704
  s_mov_b64 exec, -1
  v_cvt_pk_bf16_f32 v82, v100, v101
  v_cvt_pk_bf16_f32 v83, v102, v103
  v_exp_f32 v108, v108
  v_exp_f32 v109, v109
  v_cvt_pk_bf16_f32 v84, v104, v105
  v_exp_f32 v110, v110
  v_exp_f32 v111, v111
  v_cvt_pk_bf16_f32 v85, v106, v107
  v_cvt_pk_bf16_f32 v86, v108, v109
  v_cvt_pk_bf16_f32 v87, v110, v111
  s_waitcnt lgkmcnt(0)
  v_mfma_f32_32x32x16_bf16 v[96:111], v[72:75], v[68:71], 0
  v_exp_f32 v112, v112
  v_exp_f32 v113, v113
  v_exp_f32 v114, v114
  v_exp_f32 v115, v115
  v_exp_f32 v116, v116
  v_exp_f32 v117, v117
  v_mfma_f32_32x32x16_bf16 v[128:143], v[88:91], v[80:83], v[128:143]
  v_exp_f32 v118, v118
  v_exp_f32 v119, v119
  v_cvt_pk_bf16_f32 v80, v112, v113
  v_exp_f32 v120, v120
  v_exp_f32 v121, v121
  v_cvt_pk_bf16_f32 v81, v114, v115
  v_exp_f32 v122, v122
  v_exp_f32 v123, v123
  v_mfma_f32_32x32x16_bf16 v[128:143], v[92:95], v[84:87], v[128:143]
  s_mov_b64 exec, s[58:59]
  ds_read_b128 v[88:91], v193 offset:21504
  ds_read_b128 v[92:95], v193 offset:22016
  s_mov_b64 exec, -1
  v_cvt_pk_bf16_f32 v82, v116, v117
  v_cvt_pk_bf16_f32 v83, v118, v119
  v_exp_f32 v124, v124
  v_exp_f32 v125, v125
  v_cvt_pk_bf16_f32 v84, v120, v121
  v_exp_f32 v126, v126
  v_exp_f32 v127, v127
  v_cvt_pk_bf16_f32 v85, v122, v123
  v_cvt_pk_bf16_f32 v86, v124, v125
  v_cvt_pk_bf16_f32 v87, v126, v127
  s_waitcnt lgkmcnt(0)
  v_exp_f32 v96, v96
  v_exp_f32 v97, v97
  v_exp_f32 v98, v98
  v_exp_f32 v99, v99
  v_exp_f32 v100, v100
  v_exp_f32 v101, v101
  v_mfma_f32_32x32x16_bf16 v[144:159], v[88:91], v[80:83], v[144:159]
  v_exp_f32 v102, v102
  v_exp_f32 v103, v103
  v_cvt_pk_bf16_f32 v80, v96, v97
  v_exp_f32 v104, v104
  v_exp_f32 v105, v105
  v_cvt_pk_bf16_f32 v81, v98, v99
  v_exp_f32 v106, v106
  v_exp_f32 v107, v107
  v_mfma_f32_32x32x16_bf16 v[144:159], v[92:95], v[84:87], v[144:159]
  s_mov_b64 exec, s[58:59]
  ds_read_b128 v[88:91], v193 offset:20480
  ds_read_b128 v[92:95], v193 offset:20992
  s_mov_b64 exec, -1
  v_cvt_pk_bf16_f32 v82, v100, v101
  v_cvt_pk_bf16_f32 v83, v102, v103
  v_exp_f32 v108, v108
  v_exp_f32 v109, v109
  v_cvt_pk_bf16_f32 v84, v104, v105
  v_exp_f32 v110, v110
  v_exp_f32 v111, v111
  v_cvt_pk_bf16_f32 v85, v106, v107
  v_cvt_pk_bf16_f32 v86, v108, v109
  v_cvt_pk_bf16_f32 v87, v110, v111
  s_barrier
  buffer_load_dword v252, v196, s[32:35], 0 offen
  ds_read_b128 v[76:79], v192 offset:7168
  ds_read_b128 v[72:75], v192 offset:6144
  s_waitcnt lgkmcnt(3)
  v_mfma_f32_32x32x16_bf16 v[144:159], v[88:91], v[80:83], v[144:159]
  s_waitcnt lgkmcnt(2)
  v_mfma_f32_32x32x16_bf16 v[144:159], v[92:95], v[84:87], v[144:159]
  s_waitcnt lgkmcnt(1)
  v_mfma_f32_32x32x16_bf16 v[112:127], v[76:79], v[64:67], v[172:187]
  s_waitcnt lgkmcnt(0)
  v_mfma_f32_32x32x16_bf16 v[96:111], v[72:75], v[64:67], v[172:187]
  ds_read_b128 v[76:79], v192 offset:5120
  s_nop 8
  v_exp_f32 v112, v112
  v_exp_f32 v113, v113
  v_exp_f32 v114, v114
  v_exp_f32 v115, v115
  v_exp_f32 v116, v116
  v_exp_f32 v117, v117
  v_exp_f32 v118, v118
  v_exp_f32 v119, v119
  v_cvt_pk_bf16_f32 v80, v112, v113
  v_exp_f32 v120, v120
  v_exp_f32 v121, v121
  v_cvt_pk_bf16_f32 v81, v114, v115
  v_exp_f32 v122, v122
  v_exp_f32 v123, v123
  s_mov_b64 exec, s[58:59]
  ds_read_b128 v[88:91], v193 offset:7168
  ds_read_b128 v[92:95], v193 offset:7680
  s_mov_b64 exec, -1
  v_cvt_pk_bf16_f32 v82, v116, v117
  v_cvt_pk_bf16_f32 v83, v118, v119
  v_exp_f32 v124, v124
  v_exp_f32 v125, v125
  v_cvt_pk_bf16_f32 v84, v120, v121
  v_exp_f32 v126, v126
  v_exp_f32 v127, v127
  v_cvt_pk_bf16_f32 v85, v122, v123
  v_cvt_pk_bf16_f32 v86, v124, v125
  v_cvt_pk_bf16_f32 v87, v126, v127
  s_waitcnt lgkmcnt(0)
  v_mfma_f32_32x32x16_bf16 v[112:127], v[76:79], v[64:67], v[172:187]
  ds_read_b128 v[72:75], v192 offset:4096
  v_exp_f32 v96, v96
  v_exp_f32 v97, v97
  v_exp_f32 v98, v98
  v_exp_f32 v99, v99
  v_exp_f32 v100, v100
  v_exp_f32 v101, v101
  v_mfma_f32_32x32x16_bf16 v[128:143], v[88:91], v[80:83], v[128:143]
  v_exp_f32 v102, v102
  v_exp_f32 v103, v103
  v_cvt_pk_bf16_f32 v80, v96, v97
  v_exp_f32 v104, v104
  v_exp_f32 v105, v105
  v_cvt_pk_bf16_f32 v81, v98, v99
  v_exp_f32 v106, v106
  v_exp_f32 v107, v107
  v_mfma_f32_32x32x16_bf16 v[128:143], v[92:95], v[84:87], v[128:143]
  s_mov_b64 exec, s[58:59]
  ds_read_b128 v[88:91], v193 offset:6144
  ds_read_b128 v[92:95], v193 offset:6656
  s_mov_b64 exec, -1
  v_cvt_pk_bf16_f32 v82, v100, v101
  v_cvt_pk_bf16_f32 v83, v102, v103
  v_exp_f32 v108, v108
  v_exp_f32 v109, v109
  v_cvt_pk_bf16_f32 v84, v104, v105
  v_exp_f32 v110, v110
  v_exp_f32 v111, v111
  v_cvt_pk_bf16_f32 v85, v106, v107
  v_cvt_pk_bf16_f32 v86, v108, v109
  v_cvt_pk_bf16_f32 v87, v110, v111
  s_waitcnt lgkmcnt(0)
  v_mfma_f32_32x32x16_bf16 v[96:111], v[72:75], v[64:67], v[172:187]
  ds_read_b128 v[76:79], v192 offset:3072
  v_exp_f32 v112, v112
  v_exp_f32 v113, v113
  v_exp_f32 v114, v114
  v_exp_f32 v115, v115
  v_exp_f32 v116, v116
  v_exp_f32 v117, v117
  v_mfma_f32_32x32x16_bf16 v[128:143], v[88:91], v[80:83], v[128:143]
  v_exp_f32 v118, v118
  v_exp_f32 v119, v119
  v_cvt_pk_bf16_f32 v80, v112, v113
  v_exp_f32 v120, v120
  v_exp_f32 v121, v121
  v_cvt_pk_bf16_f32 v81, v114, v115
  v_exp_f32 v122, v122
  v_exp_f32 v123, v123
  v_mfma_f32_32x32x16_bf16 v[128:143], v[92:95], v[84:87], v[128:143]
  s_mov_b64 exec, s[58:59]
  ds_read_b128 v[88:91], v193 offset:5120
  ds_read_b128 v[92:95], v193 offset:5632
  s_mov_b64 exec, -1
  v_cvt_pk_bf16_f32 v82, v116, v117
  v_cvt_pk_bf16_f32 v83, v118, v119
  v_exp_f32 v124, v124
  v_exp_f32 v125, v125
  v_cvt_pk_bf16_f32 v84, v120, v121
  v_exp_f32 v126, v126
  v_exp_f32 v127, v127
  v_cvt_pk_bf16_f32 v85, v122, v123
  v_cvt_pk_bf16_f32 v86, v124, v125
  v_cvt_pk_bf16_f32 v87, v126, v127
  s_waitcnt lgkmcnt(0)
  v_mfma_f32_32x32x16_bf16 v[112:127], v[76:79], v[64:67], v[202:217]
  ds_read_b128 v[72:75], v192 offset:2048
  v_exp_f32 v96, v96
  v_exp_f32 v97, v97
  v_exp_f32 v98, v98
  v_exp_f32 v99, v99
  v_exp_f32 v100, v100
  v_exp_f32 v101, v101
  v_mfma_f32_32x32x16_bf16 v[128:143], v[88:91], v[80:83], v[128:143]
  v_exp_f32 v102, v102
  v_exp_f32 v103, v103
  v_cvt_pk_bf16_f32 v80, v96, v97
  v_exp_f32 v104, v104
  v_exp_f32 v105, v105
  v_cvt_pk_bf16_f32 v81, v98, v99
  v_exp_f32 v106, v106
  v_exp_f32 v107, v107
  v_mfma_f32_32x32x16_bf16 v[128:143], v[92:95], v[84:87], v[128:143]
  s_mov_b64 exec, s[58:59]
  ds_read_b128 v[88:91], v193 offset:4096
  ds_read_b128 v[92:95], v193 offset:4608
  s_mov_b64 exec, -1
  v_cvt_pk_bf16_f32 v82, v100, v101
  v_cvt_pk_bf16_f32 v83, v102, v103
  v_exp_f32 v108, v108
  v_exp_f32 v109, v109
  v_cvt_pk_bf16_f32 v84, v104, v105
  v_exp_f32 v110, v110
  v_exp_f32 v111, v111
  v_cvt_pk_bf16_f32 v85, v106, v107
  v_cvt_pk_bf16_f32 v86, v108, v109
  v_cvt_pk_bf16_f32 v87, v110, v111
  s_waitcnt lgkmcnt(0)
  v_mfma_f32_32x32x16_bf16 v[96:111], v[72:75], v[64:67], v[202:217]
  ds_read_b128 v[76:79], v192 offset:1024
  v_exp_f32 v112, v112
  v_exp_f32 v113, v113
  v_exp_f32 v114, v114
  v_exp_f32 v115, v115
  v_exp_f32 v116, v116
  v_exp_f32 v117, v117
  v_mfma_f32_32x32x16_bf16 v[128:143], v[88:91], v[80:83], v[128:143]
  v_exp_f32 v118, v118
  v_exp_f32 v119, v119
  v_cvt_pk_bf16_f32 v80, v112, v113
  v_exp_f32 v120, v120
  v_exp_f32 v121, v121
  v_cvt_pk_bf16_f32 v81, v114, v115
  v_exp_f32 v122, v122
  v_exp_f32 v123, v123
  v_mfma_f32_32x32x16_bf16 v[128:143], v[92:95], v[84:87], v[128:143]
  s_mov_b64 exec, s[58:59]
  ds_read_b128 v[88:91], v193 offset:3072
  ds_read_b128 v[92:95], v193 offset:3584
  s_mov_b64 exec, -1
  v_cvt_pk_bf16_f32 v82, v116, v117
  v_cvt_pk_bf16_f32 v83, v118, v119
  v_exp_f32 v124, v124
  v_exp_f32 v125, v125
  v_cvt_pk_bf16_f32 v84, v120, v121
  v_exp_f32 v126, v126
  v_exp_f32 v127, v127
  v_cvt_pk_bf16_f32 v85, v122, v123
  v_cvt_pk_bf16_f32 v86, v124, v125
  v_cvt_pk_bf16_f32 v87, v126, v127
  s_waitcnt lgkmcnt(0)
  v_mfma_f32_32x32x16_bf16 v[112:127], v[76:79], v[64:67], v[236:251]
  ds_read_b128 v[72:75], v192 offset:19456
  v_exp_f32 v96, v96
  v_exp_f32 v97, v97
  v_exp_f32 v98, v98
  v_exp_f32 v99, v99
  v_exp_f32 v100, v100
  v_exp_f32 v101, v101
  v_mfma_f32_32x32x16_bf16 v[128:143], v[88:91], v[80:83], v[128:143]
  v_exp_f32 v102, v102
  v_exp_f32 v103, v103
  v_cvt_pk_bf16_f32 v80, v96, v97
  v_exp_f32 v104, v104
  v_exp_f32 v105, v105
  v_cvt_pk_bf16_f32 v81, v98, v99
  v_exp_f32 v106, v106
  v_exp_f32 v107, v107
  v_mfma_f32_32x32x16_bf16 v[128:143], v[92:95], v[84:87], v[128:143]
  s_mov_b64 exec, s[58:59]
  ds_read_b128 v[88:91], v193 offset:2048
  ds_read_b128 v[92:95], v193 offset:2560
  s_mov_b64 exec, -1
  v_cvt_pk_bf16_f32 v82, v100, v101
  v_cvt_pk_bf16_f32 v83, v102, v103
  v_exp_f32 v108, v108
  v_exp_f32 v109, v109
  v_cvt_pk_bf16_f32 v84, v104, v105
  v_exp_f32 v110, v110
  v_exp_f32 v111, v111
  v_cvt_pk_bf16_f32 v85, v106, v107
  v_cvt_pk_bf16_f32 v86, v108, v109
  v_cvt_pk_bf16_f32 v87, v110, v111
  s_waitcnt lgkmcnt(0)
  v_mfma_f32_32x32x16_bf16 v[96:111], v[72:75], v[68:71], v[172:187]
  ds_read_b128 v[76:79], v192 offset:18432
  v_exp_f32 v112, v112
  v_exp_f32 v113, v113
  v_exp_f32 v114, v114
  v_exp_f32 v115, v115
  v_exp_f32 v116, v116
  v_exp_f32 v117, v117
  v_mfma_f32_32x32x16_bf16 v[128:143], v[88:91], v[80:83], v[128:143]
  v_exp_f32 v118, v118
  v_exp_f32 v119, v119
  v_cvt_pk_bf16_f32 v80, v112, v113
  v_exp_f32 v120, v120
  v_exp_f32 v121, v121
  v_cvt_pk_bf16_f32 v81, v114, v115
  v_exp_f32 v122, v122
  v_exp_f32 v123, v123
  v_mfma_f32_32x32x16_bf16 v[128:143], v[92:95], v[84:87], v[128:143]
  s_mov_b64 exec, s[58:59]
  ds_read_b128 v[88:91], v193 offset:1024
  ds_read_b128 v[92:95], v193 offset:1536
  s_mov_b64 exec, -1
  v_cvt_pk_bf16_f32 v82, v116, v117
  v_cvt_pk_bf16_f32 v83, v118, v119
  v_exp_f32 v124, v124
  v_exp_f32 v125, v125
  v_cvt_pk_bf16_f32 v84, v120, v121
  v_exp_f32 v126, v126
  v_exp_f32 v127, v127
  v_cvt_pk_bf16_f32 v85, v122, v123
  v_cvt_pk_bf16_f32 v86, v124, v125
  v_cvt_pk_bf16_f32 v87, v126, v127
  s_waitcnt lgkmcnt(0)
  v_mfma_f32_32x32x16_bf16 v[112:127], v[76:79], v[68:71], v[172:187]
  ds_read_b128 v[72:75], v192 offset:17408
  v_exp_f32 v96, v96
  v_exp_f32 v97, v97
  v_exp_f32 v98, v98
  v_exp_f32 v99, v99
  v_exp_f32 v100, v100
  v_exp_f32 v101, v101
  v_mfma_f32_32x32x16_bf16 v[128:143], v[88:91], v[80:83], v[128:143]
  v_exp_f32 v102, v102
  v_exp_f32 v103, v103
  v_cvt_pk_bf16_f32 v80, v96, v97
  v_exp_f32 v104, v104
  v_exp_f32 v105, v105
  v_cvt_pk_bf16_f32 v81, v98, v99
  v_exp_f32 v106, v106
  v_exp_f32 v107, v107
  v_mfma_f32_32x32x16_bf16 v[128:143], v[92:95], v[84:87], v[128:143]
  s_mov_b64 exec, s[58:59]
  ds_read_b128 v[88:91], v193 offset:19456
  ds_read_b128 v[92:95], v193 offset:19968
  s_mov_b64 exec, -1
  v_cvt_pk_bf16_f32 v82, v100, v101
  v_cvt_pk_bf16_f32 v83, v102, v103
  v_exp_f32 v108, v108
  v_exp_f32 v109, v109
  v_cvt_pk_bf16_f32 v84, v104, v105
  v_exp_f32 v110, v110
  v_exp_f32 v111, v111
  v_cvt_pk_bf16_f32 v85, v106, v107
  v_cvt_pk_bf16_f32 v86, v108, v109
  v_cvt_pk_bf16_f32 v87, v110, v111
  v_med3_f32 v14, v136, s56, v197
  v_cmp_neq_f32 vcc, v14, v136
  s_cbranch_vccnz FB0
FBDa1:
  v_rcp_f32 v14, v136
  s_nop 0
  v_mul_f32 v128, v128, v14
  v_mul_f32 v129, v129, v14
  v_mul_f32 v130, v130, v14
  v_mul_f32 v131, v131, v14
  v_mul_f32 v132, v132, v14
  v_mul_f32 v133, v133, v14
  v_mul_f32 v134, v134, v14
  v_mul_f32 v135, v135, v14
  v_cvt_pk_bf16_f32 v56, v128, v129
  v_cvt_pk_bf16_f32 v57, v130, v131
  v_cvt_pk_bf16_f32 v58, v132, v133
  v_cvt_pk_bf16_f32 v59, v134, v135
  s_cmp_eq_u32 s19, 0
  s_cbranch_scc1 DU_A8
  buffer_store_dwordx4 v[56:59], v1, s[32:35], s12 offen
DU_B8:
  s_waitcnt lgkmcnt(0)
  v_mfma_f32_32x32x16_bf16 v[96:111], v[72:75], v[68:71], v[172:187]
  ds_read_b128 v[76:79], v192 offset:16384
  v_exp_f32 v112, v112
  v_exp_f32 v113, v113
  v_exp_f32 v114, v114
  v_exp_f32 v115, v115
  v_exp_f32 v116, v116
  v_exp_f32 v117, v117
  v_mfma_f32_32x32x16_bf16 v[144:159], v[88:91], v[80:83], v[144:159]
  v_exp_f32 v118, v118
  v_exp_f32 v119, v119
  v_cvt_pk_bf16_f32 v80, v112, v113
  v_exp_f32 v120, v120
  v_exp_f32 v121, v121
  v_cvt_pk_bf16_f32 v81, v114, v115
  v_exp_f32 v122, v122
  v_exp_f32 v123, v123
  v_mfma_f32_32x32x16_bf16 v[144:159], v[92:95], v[84:87], v[144:159]
  s_mov_b64 exec, s[58:59]
  ds_read_b128 v[88:91], v193 offset:18432
  ds_read_b128 v[92:95], v193 offset:18944
  s_mov_b64 exec, -1
  v_cvt_pk_bf16_f32 v82, v116, v117
  v_cvt_pk_bf16_f32 v83, v118, v119
  v_exp_f32 v124, v124
  v_exp_f32 v125, v125
  v_cvt_pk_bf16_f32 v84, v120, v121
  v_exp_f32 v126, v126
  v_exp_f32 v127, v127
  v_cvt_pk_bf16_f32 v85, v122, v123
  v_cvt_pk_bf16_f32 v86, v124, v125
  v_cvt_pk_bf16_f32 v87, v126, v127
  buffer_load_dword v12, v198, s[32:35], 0 offen sc1
  s_waitcnt lgkmcnt(0)
  v_mfma_f32_32x32x16_bf16 v[112:127], v[76:79], v[68:71], v[172:187]
  ds_read_b128 v[72:75], v192 offset:15360
  v_exp_f32 v96, v96
  v_exp_f32 v97, v97
  v_exp_f32 v98, v98
  v_exp_f32 v99, v99
  v_exp_f32 v100, v100
  v_exp_f32 v101, v101
  v_mfma_f32_32x32x16_bf16 v[144:159], v[88:91], v[80:83], v[144:159]
  v_exp_f32 v102, v102
  v_exp_f32 v103, v103
  v_cvt_pk_bf16_f32 v80, v96, v97
  v_exp_f32 v104, v104
  v_exp_f32 v105, v105
  v_cvt_pk_bf16_f32 v81, v98, v99
  v_exp_f32 v106, v106
  v_exp_f32 v107, v107
  v_mfma_f32_32x32x16_bf16 v[144:159], v[92:95], v[84:87], v[144:159]
  s_mov_b64 exec, s[58:59]
  ds_read_b128 v[88:91], v193 offset:17408
  ds_read_b128 v[92:95], v193 offset:17920
  s_mov_b64 exec, -1
  v_cvt_pk_bf16_f32 v82, v100, v101
  v_cvt_pk_bf16_f32 v83, v102, v103
  v_exp_f32 v108, v108
  v_exp_f32 v109, v109
  v_cvt_pk_bf16_f32 v84, v104, v105
  v_exp_f32 v110, v110
  v_exp_f32 v111, v111
  v_cvt_pk_bf16_f32 v85, v106, v107
  v_cvt_pk_bf16_f32 v86, v108, v109
  v_cvt_pk_bf16_f32 v87, v110, v111
  s_waitcnt lgkmcnt(0)
  v_mfma_f32_32x32x16_bf16 v[96:111], v[72:75], v[68:71], v[202:217]
  ds_read_b128 v[76:79], v192 offset:14336
  v_exp_f32 v112, v112
  v_exp_f32 v113, v113
  v_exp_f32 v114, v114
  v_exp_f32 v115, v115
  v_exp_f32 v116, v116
  v_exp_f32 v117, v117
  v_mfma_f32_32x32x16_bf16 v[144:159], v[88:91], v[80:83], v[144:159]
  v_exp_f32 v118, v118
  v_exp_f32 v119, v119
  v_cvt_pk_bf16_f32 v80, v112, v113
  v_exp_f32 v120, v120
  v_exp_f32 v121, v121
  v_cvt_pk_bf16_f32 v81, v114, v115
  v_exp_f32 v122, v122
  v_exp_f32 v123, v123
  v_mfma_f32_32x32x16_bf16 v[144:159], v[92:95], v[84:87], v[144:159]
  s_mov_b64 exec, s[58:59]
  ds_read_b128 v[88:91], v193 offset:16384
  ds_read_b128 v[92:95], v193 offset:16896
  s_mov_b64 exec, -1
  v_cvt_pk_bf16_f32 v82, v116, v117
  v_cvt_pk_bf16_f32 v83, v118, v119
  v_exp_f32 v124, v124
  v_exp_f32 v125, v125
  v_cvt_pk_bf16_f32 v84, v120, v121
  v_exp_f32 v126, v126
  v_exp_f32 v127, v127
  v_cvt_pk_bf16_f32 v85, v122, v123
  v_cvt_pk_bf16_f32 v86, v124, v125
  v_cvt_pk_bf16_f32 v87, v126, v127
  s_waitcnt vmcnt(0)
  v_cmp_ne_u32 vcc, s52, v12
  s_and_b64 vcc, vcc, s[16:17]
  s_mov_b32 s7, 4000
  s_cbranch_vccnz POLL_L9
POLL_D9:
  buffer_load_dword v12, v198, s[32:35], 0 offen sc1
  buffer_load_dwordx4 v[16:19], v1, s[32:35], s80 offen offset:0 sc1
  buffer_load_dwordx4 v[20:23], v1, s[32:35], s81 offen offset:0 sc1
  buffer_load_dwordx4 v[24:27], v1, s[32:35], s82 offen offset:0 sc1
  buffer_load_dwordx4 v[28:31], v1, s[32:35], s83 offen offset:0 sc1
  buffer_load_dwordx4 v[32:35], v1, s[32:35], s84 offen offset:0 sc1
  buffer_load_dwordx4 v[36:39], v1, s[32:35], s85 offen offset:0 sc1
  buffer_load_dwordx4 v[40:43], v1, s[32:35], s86 offen offset:0 sc1
  buffer_load_dwordx4 v[44:47], v1, s[32:35], s87 offen offset:0 sc1
  s_waitcnt lgkmcnt(0)
  v_mfma_f32_32x32x16_bf16 v[112:127], v[76:79], v[68:71], v[236:251]
  v_exp_f32 v96, v96
  v_exp_f32 v97, v97
  v_exp_f32 v98, v98
  v_exp_f32 v99, v99
  v_exp_f32 v100, v100
  v_exp_f32 v101, v101
  v_mfma_f32_32x32x16_bf16 v[144:159], v[88:91], v[80:83], v[144:159]
  v_exp_f32 v102, v102
  v_exp_f32 v103, v103
  v_cvt_pk_bf16_f32 v80, v96, v97
  v_exp_f32 v104, v104
  v_exp_f32 v105, v105
  v_cvt_pk_bf16_f32 v81, v98, v99
  v_exp_f32 v106, v106
  v_exp_f32 v107, v107
  v_mfma_f32_32x32x16_bf16 v[144:159], v[92:95], v[84:87], v[144:159]
  s_mov_b64 exec, s[58:59]
  ds_read_b128 v[88:91], v193 offset:15360
  ds_read_b128 v[92:95], v193 offset:15872
  s_mov_b64 exec, -1
  v_cvt_pk_bf16_f32 v82, v100, v101
  v_cvt_pk_bf16_f32 v83, v102, v103
  v_exp_f32 v108, v108
  v_exp_f32 v109, v109
  v_cvt_pk_bf16_f32 v84, v104, v105
  v_exp_f32 v110, v110
  v_exp_f32 v111, v111
  v_cvt_pk_bf16_f32 v85, v106, v107
  v_cvt_pk_bf16_f32 v86, v108, v109
  v_cvt_pk_bf16_f32 v87, v110, v111
  s_waitcnt lgkmcnt(0)
  v_exp_f32 v112, v112
  v_exp_f32 v113, v113
  v_exp_f32 v114, v114
  v_exp_f32 v115, v115
  v_exp_f32 v116, v116
  v_exp_f32 v117, v117
  v_mfma_f32_32x32x16_bf16 v[144:159], v[88:91], v[80:83], v[144:159]
  v_exp_f32 v118, v118
  v_exp_f32 v119, v119
  v_cvt_pk_bf16_f32 v80, v112, v113
  v_exp_f32 v120, v120
  v_exp_f32 v121, v121
  v_cvt_pk_bf16_f32 v81, v114, v115
  v_exp_f32 v122, v122
  v_exp_f32 v123, v123
  v_mfma_f32_32x32x16_bf16 v[144:159], v[92:95], v[84:87], v[144:159]
  s_mov_b64 exec, s[58:59]
  ds_read_b128 v[88:91], v193 offset:14336
  ds_read_b128 v[92:95], v193 offset:14848
  s_mov_b64 exec, -1
  v_cvt_pk_bf16_f32 v82, v116, v117
  v_cvt_pk_bf16_f32 v83, v118, v119
  v_exp_f32 v124, v124
  v_exp_f32 v125, v125
  v_cvt_pk_bf16_f32 v84, v120, v121
  v_exp_f32 v126, v126
  v_exp_f32 v127, v127
  v_cvt_pk_bf16_f32 v85, v122, v123
  v_cvt_pk_bf16_f32 v86, v124, v125
  v_cvt_pk_bf16_f32 v87, v126, v127
  s_branch H_FIN
PE10:
.p2align 12
PG11:
W2:
  s_branch W8
V2:
  ds_read_b128 v[72:75], v192 offset:10240
  ds_read_b128 v[76:79], v192 offset:21504
  s_nop 5
  v_pk_mul_f32 v[16:17], v[16:17], s[8:9]
  v_pk_mul_f32 v[18:19], v[18:19], s[8:9]
  v_pk_mul_f32 v[20:21], v[20:21], s[8:9]
  v_pk_mul_f32 v[22:23], v[22:23], s[8:9]
  v_cvt_pk_bf16_f32 v16, v16, v17
  v_cvt_pk_bf16_f32 v17, v18, v19
  v_cvt_pk_bf16_f32 v18, v20, v21
  v_cvt_pk_bf16_f32 v19, v22, v23
  ds_write_b128 v194, v[16:19] offset:0
  v_pk_mul_f32 v[40:41], v[40:41], s[8:9]
  v_pk_mul_f32 v[42:43], v[42:43], s[8:9]
  v_pk_mul_f32 v[44:45], v[44:45], s[8:9]
  v_pk_mul_f32 v[46:47], v[46:47], s[8:9]
  v_cvt_pk_bf16_f32 v40, v40, v41
  v_cvt_pk_bf16_f32 v41, v42, v43
  v_cvt_pk_bf16_f32 v42, v44, v45
  v_cvt_pk_bf16_f32 v43, v46, v47
  ds_write_b128 v194, v[40:43] offset:4096
  ds_write_b32 v171, v170
  v_pk_mul_f32 v[32:33], v[32:33], s[8:9]
  v_pk_mul_f32 v[34:35], v[34:35], s[8:9]
  v_pk_mul_f32 v[36:37], v[36:37], s[8:9]
  v_pk_mul_f32 v[38:39], v[38:39], s[8:9]
  v_pk_mul_f32 v[24:25], v[24:25], s[8:9]
  v_pk_mul_f32 v[26:27], v[26:27], s[8:9]
  v_pk_mul_f32 v[28:29], v[28:29], s[8:9]
  v_pk_mul_f32 v[30:31], v[30:31], s[8:9]
  v_cvt_pk_bf16_f32 v64, v32, v33
  v_cvt_pk_bf16_f32 v65, v34, v35
  v_cvt_pk_bf16_f32 v66, v36, v37
  v_cvt_pk_bf16_f32 v67, v38, v39
  v_cvt_pk_bf16_f32 v68, v24, v25
  v_cvt_pk_bf16_f32 v69, v26, v27
  s_waitcnt lgkmcnt(4)
  v_mfma_f32_32x32x16_bf16 v[96:111], v[72:75], v[64:67], v[220:235]
  v_cvt_pk_bf16_f32 v70, v28, v29
  v_cvt_pk_bf16_f32 v71, v30, v31
  s_nop 1
  s_waitcnt lgkmcnt(3)
  v_mfma_f32_32x32x16_bf16 v[112:127], v[76:79], v[68:71], v[220:235]
  ds_read_b128 v[72:75], v192 offset:9216
  s_nop 7
  v_exp_f32 v96, v96
  v_exp_f32 v97, v97
  v_exp_f32 v98, v98
  v_exp_f32 v99, v99
  v_exp_f32 v100, v100
  v_exp_f32 v101, v101
  v_exp_f32 v102, v102
  v_exp_f32 v103, v103
  v_cvt_pk_bf16_f32 v80, v96, v97
  v_exp_f32 v104, v104
  v_exp_f32 v105, v105
  v_cvt_pk_bf16_f32 v81, v98, v99
  v_exp_f32 v106, v106
  v_exp_f32 v107, v107
  s_mov_b64 exec, s[58:59]
  ds_read_b128 v[88:91], v193 offset:10240
  ds_read_b128 v[92:95], v193 offset:10752
  s_mov_b64 exec, -1
  v_cvt_pk_bf16_f32 v82, v100, v101
  v_cvt_pk_bf16_f32 v83, v102, v103
  v_exp_f32 v108, v108
  v_exp_f32 v109, v109
  v_cvt_pk_bf16_f32 v84, v104, v105
  v_exp_f32 v110, v110
  v_exp_f32 v111, v111
  v_cvt_pk_bf16_f32 v85, v106, v107
  v_cvt_pk_bf16_f32 v86, v108, v109
  v_cvt_pk_bf16_f32 v87, v110, v111
  s_waitcnt lgkmcnt(0)
  v_mfma_f32_32x32x16_bf16 v[96:111], v[72:75], v[64:67], 0
  ds_read_b128 v[76:79], v192 offset:8192
  v_exp_f32 v112, v112
  v_exp_f32 v113, v113
  v_exp_f32 v114, v114
  v_exp_f32 v115, v115
  v_exp_f32 v116, v116
  v_exp_f32 v117, v117
  v_mfma_f32_32x32x16_bf16 v[128:143], v[88:91], v[80:83], 0
  v_exp_f32 v118, v118
  v_exp_f32 v119, v119
  v_cvt_pk_bf16_f32 v80, v112, v113
  v_exp_f32 v120, v120
  v_exp_f32 v121, v121
  v_cvt_pk_bf16_f32 v81, v114, v115
  v_exp_f32 v122, v122
  v_exp_f32 v123, v123
  v_mfma_f32_32x32x16_bf16 v[128:143], v[92:95], v[84:87], v[128:143]
  s_mov_b64 exec, s[58:59]
  ds_read_b128 v[88:91], v193 offset:21504
  ds_read_b128 v[92:95], v193 offset:22016
  s_mov_b64 exec, -1
  v_cvt_pk_bf16_f32 v82, v116, v117
  v_cvt_pk_bf16_f32 v83, v118, v119
  v_exp_f32 v124, v124
  v_exp_f32 v125, v125
  v_cvt_pk_bf16_f32 v84, v120, v121
  v_exp_f32 v126, v126
  v_exp_f32 v127, v127
  v_cvt_pk_bf16_f32 v85, v122, v123
  v_cvt_pk_bf16_f32 v86, v124, v125
  v_cvt_pk_bf16_f32 v87, v126, v127
  s_waitcnt lgkmcnt(0)
  v_mfma_f32_32x32x16_bf16 v[112:127], v[76:79], v[64:67], 0
  ds_read_b128 v[72:75], v192 offset:20480
  v_exp_f32 v96, v96
  v_exp_f32 v97, v97
  v_exp_f32 v98, v98
  v_exp_f32 v99, v99
  v_exp_f32 v100, v100
  v_exp_f32 v101, v101
  v_mfma_f32_32x32x16_bf16 v[144:159], v[88:91], v[80:83], 0
  v_exp_f32 v102, v102
  v_exp_f32 v103, v103
  v_cvt_pk_bf16_f32 v80, v96, v97
  v_exp_f32 v104, v104
  v_exp_f32 v105, v105
  v_cvt_pk_bf16_f32 v81, v98, v99
  v_exp_f32 v106, v106
  v_exp_f32 v107, v107
  v_mfma_f32_32x32x16_bf16 v[144:159], v[92:95], v[84:87], v[144:159]
  s_mov_b64 exec, s[58:59]
  ds_read_b128 v[88:91], v193 offset:9216
  ds_read_b128 v[92:95], v193 offset:9728
  s_mov_b64 exec, -1
  v_cvt_pk_bf16_f32 v82, v100, v101
  v_cvt_pk_bf16_f32 v83, v102, v103
  v_exp_f32 v108, v108
  v_exp_f32 v109, v109
  v_cvt_pk_bf16_f32 v84, v104, v105
  v_exp_f32 v110, v110
  v_exp_f32 v111, v111
  v_cvt_pk_bf16_f32 v85, v106, v107
  v_cvt_pk_bf16_f32 v86, v108, v109
  v_cvt_pk_bf16_f32 v87, v110, v111
  s_waitcnt lgkmcnt(0)
  v_mfma_f32_32x32x16_bf16 v[96:111], v[72:75], v[68:71], 0
  v_exp_f32 v112, v112
  v_exp_f32 v113, v113
  v_exp_f32 v114, v114
  v_exp_f32 v115, v115
  v_exp_f32 v116, v116
  v_exp_f32 v117, v117
  v_mfma_f32_32x32x16_bf16 v[128:143], v[88:91], v[80:83], v[128:143]
  v_exp_f32 v118, v118
  v_exp_f32 v119, v119
  v_cvt_pk_bf16_f32 v80, v112, v113
  v_exp_f32 v120, v120
  v_exp_f32 v121, v121
  v_cvt_pk_bf16_f32 v81, v114, v115
  v_exp_f32 v122, v122
  v_exp_f32 v123, v123
  v_mfma_f32_32x32x16_bf16 v[128:143], v[92:95], v[84:87], v[128:143]
  s_mov_b64 exec, s[58:59]
  ds_read_b128 v[88:91], v193 offset:8192
  ds_read_b128 v[92:95], v193 offset:8704
  s_mov_b64 exec, -1
  v_cvt_pk_bf16_f32 v82, v116, v117
  v_cvt_pk_bf16_f32 v83, v118, v119
  v_exp_f32 v124, v124
  v_exp_f32 v125, v125
  v_cvt_pk_bf16_f32 v84, v120, v121
  v_exp_f32 v126, v126
  v_exp_f32 v127, v127
  v_cvt_pk_bf16_f32 v85, v122, v123
  v_cvt_pk_bf16_f32 v86, v124, v125
  v_cvt_pk_bf16_f32 v87, v126, v127
  s_waitcnt lgkmcnt(0)
  v_exp_f32 v96, v96
  v_exp_f32 v97, v97
  v_exp_f32 v98, v98
  v_exp_f32 v99, v99
  v_exp_f32 v100, v100
  v_exp_f32 v101, v101
  v_mfma_f32_32x32x16_bf16 v[128:143], v[88:91], v[80:83], v[128:143]
  v_exp_f32 v102, v102
  v_exp_f32 v103, v103
  v_cvt_pk_bf16_f32 v80, v96, v97
  v_exp_f32 v104, v104
  v_exp_f32 v105, v105
  v_cvt_pk_bf16_f32 v81, v98, v99
  v_exp_f32 v106, v106
  v_exp_f32 v107, v107
  v_mfma_f32_32x32x16_bf16 v[128:143], v[92:95], v[84:87], v[128:143]
  s_mov_b64 exec, s[58:59]
  ds_read_b128 v[88:91], v193 offset:20480
  ds_read_b128 v[92:95], v193 offset:20992
  s_mov_b64 exec, -1
  v_cvt_pk_bf16_f32 v82, v100, v101
  v_cvt_pk_bf16_f32 v83, v102, v103
  v_exp_f32 v108, v108
  v_exp_f32 v109, v109
  v_cvt_pk_bf16_f32 v84, v104, v105
  v_exp_f32 v110, v110
  v_exp_f32 v111, v111
  v_cvt_pk_bf16_f32 v85, v106, v107
  v_cvt_pk_bf16_f32 v86, v108, v109
  v_cvt_pk_bf16_f32 v87, v110, v111
  s_barrier
  buffer_load_dword v252, v196, s[32:35], 0 offen
  ds_read_b128 v[76:79], v192 offset:7168
  ds_read_b128 v[72:75], v192 offset:6144
  s_waitcnt lgkmcnt(3)
  v_mfma_f32_32x32x16_bf16 v[144:159], v[88:91], v[80:83], v[144:159]
  s_waitcnt lgkmcnt(2)
  v_mfma_f32_32x32x16_bf16 v[144:159], v[92:95], v[84:87], v[144:159]
  s_waitcnt lgkmcnt(1)
  v_mfma_f32_32x32x16_bf16 v[112:127], v[76:79], v[64:67], v[172:187]
  s_waitcnt lgkmcnt(0)
  v_mfma_f32_32x32x16_bf16 v[96:111], v[72:75], v[64:67], v[172:187]
  ds_read_b128 v[76:79], v192 offset:5120
  s_nop 8
  v_exp_f32 v112, v112
  v_exp_f32 v113, v113
  v_exp_f32 v114, v114
  v_exp_f32 v115, v115
  v_exp_f32 v116, v116
  v_exp_f32 v117, v117
  v_exp_f32 v118, v118
  v_exp_f32 v119, v119
  v_cvt_pk_bf16_f32 v80, v112, v113
  v_exp_f32 v120, v120
  v_exp_f32 v121, v121
  v_cvt_pk_bf16_f32 v81, v114, v115
  v_exp_f32 v122, v122
  v_exp_f32 v123, v123
  s_mov_b64 exec, s[58:59]
  ds_read_b128 v[88:91], v193 offset:7168
  ds_read_b128 v[92:95], v193 offset:7680
  s_mov_b64 exec, -1
  v_cvt_pk_bf16_f32 v82, v116, v117
  v_cvt_pk_bf16_f32 v83, v118, v119
  v_exp_f32 v124, v124
  v_exp_f32 v125, v125
  v_cvt_pk_bf16_f32 v84, v120, v121
  v_exp_f32 v126, v126
  v_exp_f32 v127, v127
  v_cvt_pk_bf16_f32 v85, v122, v123
  v_cvt_pk_bf16_f32 v86, v124, v125
  v_cvt_pk_bf16_f32 v87, v126, v127
  s_waitcnt lgkmcnt(0)
  v_mfma_f32_32x32x16_bf16 v[112:127], v[76:79], v[64:67], v[172:187]
  ds_read_b128 v[72:75], v192 offset:4096
  v_exp_f32 v96, v96
  v_exp_f32 v97, v97
  v_exp_f32 v98, v98
  v_exp_f32 v99, v99
  v_exp_f32 v100, v100
  v_exp_f32 v101, v101
  v_mfma_f32_32x32x16_bf16 v[128:143], v[88:91], v[80:83], v[128:143]
  v_exp_f32 v102, v102
  v_exp_f32 v103, v103
  v_cvt_pk_bf16_f32 v80, v96, v97
  v_exp_f32 v104, v104
  v_exp_f32 v105, v105
  v_cvt_pk_bf16_f32 v81, v98, v99
  v_exp_f32 v106, v106
  v_exp_f32 v107, v107
  v_mfma_f32_32x32x16_bf16 v[128:143], v[92:95], v[84:87], v[128:143]
  s_mov_b64 exec, s[58:59]
  ds_read_b128 v[88:91], v193 offset:6144
  ds_read_b128 v[92:95], v193 offset:6656
  s_mov_b64 exec, -1
  v_cvt_pk_bf16_f32 v82, v100, v101
  v_cvt_pk_bf16_f32 v83, v102, v103
  v_exp_f32 v108, v108
  v_exp_f32 v109, v109
  v_cvt_pk_bf16_f32 v84, v104, v105
  v_exp_f32 v110, v110
  v_exp_f32 v111, v111
  v_cvt_pk_bf16_f32 v85, v106, v107
  v_cvt_pk_bf16_f32 v86, v108, v109
  v_cvt_pk_bf16_f32 v87, v110, v111
  s_waitcnt lgkmcnt(0)
  v_mfma_f32_32x32x16_bf16 v[96:111], v[72:75], v[64:67], v[172:187]
  ds_read_b128 v[76:79], v192 offset:3072
  v_exp_f32 v112, v112
  v_exp_f32 v113, v113
  v_exp_f32 v114, v114
  v_exp_f32 v115, v115
  v_exp_f32 v116, v116
  v_exp_f32 v117, v117
  v_mfma_f32_32x32x16_bf16 v[128:143], v[88:91], v[80:83], v[128:143]
  v_exp_f32 v118, v118
  v_exp_f32 v119, v119
  v_cvt_pk_bf16_f32 v80, v112, v113
  v_exp_f32 v120, v120
  v_exp_f32 v121, v121
  v_cvt_pk_bf16_f32 v81, v114, v115
  v_exp_f32 v122, v122
  v_exp_f32 v123, v123
  v_mfma_f32_32x32x16_bf16 v[128:143], v[92:95], v[84:87], v[128:143]
  s_mov_b64 exec, s[58:59]
  ds_read_b128 v[88:91], v193 offset:5120
  ds_read_b128 v[92:95], v193 offset:5632
  s_mov_b64 exec, -1
  v_cvt_pk_bf16_f32 v82, v116, v117
  v_cvt_pk_bf16_f32 v83, v118, v119
  v_exp_f32 v124, v124
  v_exp_f32 v125, v125
  v_cvt_pk_bf16_f32 v84, v120, v121
  v_exp_f32 v126, v126
  v_exp_f32 v127, v127
  v_cvt_pk_bf16_f32 v85, v122, v123
  v_cvt_pk_bf16_f32 v86, v124, v125
  v_cvt_pk_bf16_f32 v87, v126, v127
  s_waitcnt lgkmcnt(0)
  v_mfma_f32_32x32x16_bf16 v[112:127], v[76:79], v[64:67], v[202:217]
  ds_read_b128 v[72:75], v192 offset:2048
  v_exp_f32 v96, v96
  v_exp_f32 v97, v97
  v_exp_f32 v98, v98
  v_exp_f32 v99, v99
  v_exp_f32 v100, v100
  v_exp_f32 v101, v101
  v_mfma_f32_32x32x16_bf16 v[128:143], v[88:91], v[80:83], v[128:143]
  v_exp_f32 v102, v102
  v_exp_f32 v103, v103
  v_cvt_pk_bf16_f32 v80, v96, v97
  v_exp_f32 v104, v104
  v_exp_f32 v105, v105
  v_cvt_pk_bf16_f32 v81, v98, v99
  v_exp_f32 v106, v106
  v_exp_f32 v107, v107
  v_mfma_f32_32x32x16_bf16 v[128:143], v[92:95], v[84:87], v[128:143]
  s_mov_b64 exec, s[58:59]
  ds_read_b128 v[88:91], v193 offset:4096
  ds_read_b128 v[92:95], v193 offset:4608
  s_mov_b64 exec, -1
  v_cvt_pk_bf16_f32 v82, v100, v101
  v_cvt_pk_bf16_f32 v83, v102, v103
  v_exp_f32 v108, v108
  v_exp_f32 v109, v109
  v_cvt_pk_bf16_f32 v84, v104, v105
  v_exp_f32 v110, v110
  v_exp_f32 v111, v111
  v_cvt_pk_bf16_f32 v85, v106, v107
  v_cvt_pk_bf16_f32 v86, v108, v109
  v_cvt_pk_bf16_f32 v87, v110, v111
  s_waitcnt lgkmcnt(0)
  v_mfma_f32_32x32x16_bf16 v[96:111], v[72:75], v[64:67], v[236:251]
  ds_read_b128 v[76:79], v192 offset:19456
  v_exp_f32 v112, v112
  v_exp_f32 v113, v113
  v_exp_f32 v114, v114
  v_exp_f32 v115, v115
  v_exp_f32 v116, v116
  v_exp_f32 v117, v117
  v_mfma_f32_32x32x16_bf16 v[128:143], v[88:91], v[80:83], v[128:143]
  v_exp_f32 v118, v118
  v_exp_f32 v119, v119
  v_cvt_pk_bf16_f32 v80, v112, v113
  v_exp_f32 v120, v120
  v_exp_f32 v121, v121
  v_cvt_pk_bf16_f32 v81, v114, v115
  v_exp_f32 v122, v122
  v_exp_f32 v123, v123
  v_mfma_f32_32x32x16_bf16 v[128:143], v[92:95], v[84:87], v[128:143]
  s_mov_b64 exec, s[58:59]
  ds_read_b128 v[88:91], v193 offset:3072
  ds_read_b128 v[92:95], v193 offset:3584
  s_mov_b64 exec, -1
  v_cvt_pk_bf16_f32 v82, v116, v117
  v_cvt_pk_bf16_f32 v83, v118, v119
  v_exp_f32 v124, v124
  v_exp_f32 v125, v125
  v_cvt_pk_bf16_f32 v84, v120, v121
  v_exp_f32 v126, v126
  v_exp_f32 v127, v127
  v_cvt_pk_bf16_f32 v85, v122, v123
  v_cvt_pk_bf16_f32 v86, v124, v125
  v_cvt_pk_bf16_f32 v87, v126, v127
  s_waitcnt lgkmcnt(0)
  v_mfma_f32_32x32x16_bf16 v[112:127], v[76:79], v[68:71], v[172:187]
  ds_read_b128 v[72:75], v192 offset:18432
  v_exp_f32 v96, v96
  v_exp_f32 v97, v97
  v_exp_f32 v98, v98
  v_exp_f32 v99, v99
  v_exp_f32 v100, v100
  v_exp_f32 v101, v101
  v_mfma_f32_32x32x16_bf16 v[128:143], v[88:91], v[80:83], v[128:143]
  v_exp_f32 v102, v102
  v_exp_f32 v103, v103
  v_cvt_pk_bf16_f32 v80, v96, v97
  v_exp_f32 v104, v104
  v_exp_f32 v105, v105
  v_cvt_pk_bf16_f32 v81, v98, v99
  v_exp_f32 v106, v106
  v_exp_f32 v107, v107
  v_mfma_f32_32x32x16_bf16 v[128:143], v[92:95], v[84:87], v[128:143]
  s_mov_b64 exec, s[58:59]
  ds_read_b128 v[88:91], v193 offset:2048
  ds_read_b128 v[92:95], v193 offset:2560
  s_mov_b64 exec, -1
  v_cvt_pk_bf16_f32 v82, v100, v101
  v_cvt_pk_bf16_f32 v83, v102, v103
  v_exp_f32 v108, v108
  v_exp_f32 v109, v109
  v_cvt_pk_bf16_f32 v84, v104, v105
  v_exp_f32 v110, v110
  v_exp_f32 v111, v111
  v_cvt_pk_bf16_f32 v85, v106, v107
  v_cvt_pk_bf16_f32 v86, v108, v109
  v_cvt_pk_bf16_f32 v87, v110, v111
  s_waitcnt lgkmcnt(0)
  v_mfma_f32_32x32x16_bf16 v[96:111], v[72:75], v[68:71], v[172:187]
  ds_read_b128 v[76:79], v192 offset:17408
  v_exp_f32 v112, v112
  v_exp_f32 v113, v113
  v_exp_f32 v114, v114
  v_exp_f32 v115, v115
  v_exp_f32 v116, v116
  v_exp_f32 v117, v117
  v_mfma_f32_32x32x16_bf16 v[128:143], v[88:91], v[80:83], v[128:143]
  v_exp_f32 v118, v118
  v_exp_f32 v119, v119
  v_cvt_pk_bf16_f32 v80, v112, v113
  v_exp_f32 v120, v120
  v_exp_f32 v121, v121
  v_cvt_pk_bf16_f32 v81, v114, v115
  v_exp_f32 v122, v122
  v_exp_f32 v123, v123
  v_mfma_f32_32x32x16_bf16 v[128:143], v[92:95], v[84:87], v[128:143]
  s_mov_b64 exec, s[58:59]
  ds_read_b128 v[88:91], v193 offset:19456
  ds_read_b128 v[92:95], v193 offset:19968
  s_mov_b64 exec, -1
  v_cvt_pk_bf16_f32 v82, v116, v117
  v_cvt_pk_bf16_f32 v83, v118, v119
  v_exp_f32 v124, v124
  v_exp_f32 v125, v125
  v_cvt_pk_bf16_f32 v84, v120, v121
  v_exp_f32 v126, v126
  v_exp_f32 v127, v127
  v_cvt_pk_bf16_f32 v85, v122, v123
  v_cvt_pk_bf16_f32 v86, v124, v125
  v_cvt_pk_bf16_f32 v87, v126, v127
  v_med3_f32 v14, v136, s56, v197
  v_cmp_neq_f32 vcc, v14, v136
  s_cbranch_vccnz FB0
FBDa2:
  v_rcp_f32 v14, v136
  s_nop 0
  v_mul_f32 v128, v128, v14
  v_mul_f32 v129, v129, v14
  v_mul_f32 v130, v130, v14
  v_mul_f32 v131, v131, v14
  v_mul_f32 v132, v132, v14
  v_mul_f32 v133, v133, v14
  v_mul_f32 v134, v134, v14
  v_mul_f32 v135, v135, v14
  v_cvt_pk_bf16_f32 v56, v128, v129
  v_cvt_pk_bf16_f32 v57, v130, v131
  v_cvt_pk_bf16_f32 v58, v132, v133
  v_cvt_pk_bf16_f32 v59, v134, v135
  s_cmp_eq_u32 s19, 0
  s_cbranch_scc1 DU_A10
  buffer_store_dwordx4 v[56:59], v1, s[32:35], s12 offen
DU_B10:
  s_waitcnt lgkmcnt(0)
  v_mfma_f32_32x32x16_bf16 v[112:127], v[76:79], v[68:71], v[172:187]
  ds_read_b128 v[72:75], v192 offset:16384
  v_exp_f32 v96, v96
  v_exp_f32 v97, v97
  v_exp_f32 v98, v98
  v_exp_f32 v99, v99
  v_exp_f32 v100, v100
  v_exp_f32 v101, v101
  v_mfma_f32_32x32x16_bf16 v[144:159], v[88:91], v[80:83], v[144:159]
  v_exp_f32 v102, v102
  v_exp_f32 v103, v103
  v_cvt_pk_bf16_f32 v80, v96, v97
  v_exp_f32 v104, v104
  v_exp_f32 v105, v105
  v_cvt_pk_bf16_f32 v81, v98, v99
  v_exp_f32 v106, v106
  v_exp_f32 v107, v107
  v_mfma_f32_32x32x16_bf16 v[144:159], v[92:95], v[84:87], v[144:159]
  s_mov_b64 exec, s[58:59]
  ds_read_b128 v[88:91], v193 offset:18432
  ds_read_b128 v[92:95], v193 offset:18944
  s_mov_b64 exec, -1
  v_cvt_pk_bf16_f32 v82, v100, v101
  v_cvt_pk_bf16_f32 v83, v102, v103
  v_exp_f32 v108, v108
  v_exp_f32 v109, v109
  v_cvt_pk_bf16_f32 v84, v104, v105
  v_exp_f32 v110, v110
  v_exp_f32 v111, v111
  v_cvt_pk_bf16_f32 v85, v106, v107
  v_cvt_pk_bf16_f32 v86, v108, v109
  v_cvt_pk_bf16_f32 v87, v110, v111
  s_waitcnt lgkmcnt(0)
  v_mfma_f32_32x32x16_bf16 v[96:111], v[72:75], v[68:71], v[172:187]
  ds_read_b128 v[76:79], v192 offset:15360
  v_exp_f32 v112, v112
  v_exp_f32 v113, v113
  v_exp_f32 v114, v114
  v_exp_f32 v115, v115
  v_exp_f32 v116, v116
  v_exp_f32 v117, v117
  v_mfma_f32_32x32x16_bf16 v[144:159], v[88:91], v[80:83], v[144:159]
  v_exp_f32 v118, v118
  v_exp_f32 v119, v119
  v_cvt_pk_bf16_f32 v80, v112, v113
  v_exp_f32 v120, v120
  v_exp_f32 v121, v121
  v_cvt_pk_bf16_f32 v81, v114, v115
  v_exp_f32 v122, v122
  v_exp_f32 v123, v123
  v_mfma_f32_32x32x16_bf16 v[144:159], v[92:95], v[84:87], v[144:159]
  s_mov_b64 exec, s[58:59]
  ds_read_b128 v[88:91], v193 offset:17408
  ds_read_b128 v[92:95], v193 offset:17920
  s_mov_b64 exec, -1
  v_cvt_pk_bf16_f32 v82, v116, v117
  v_cvt_pk_bf16_f32 v83, v118, v119
  v_exp_f32 v124, v124
  v_exp_f32 v125, v125
  v_cvt_pk_bf16_f32 v84, v120, v121
  v_exp_f32 v126, v126
  v_exp_f32 v127, v127
  v_cvt_pk_bf16_f32 v85, v122, v123
  v_cvt_pk_bf16_f32 v86, v124, v125
  v_cvt_pk_bf16_f32 v87, v126, v127
  buffer_load_dword v12, v198, s[32:35], 0 offen sc1
  s_waitcnt lgkmcnt(0)
  v_mfma_f32_32x32x16_bf16 v[112:127], v[76:79], v[68:71], v[202:217]
  ds_read_b128 v[72:75], v192 offset:14336
  v_exp_f32 v96, v96
  v_exp_f32 v97, v97
  v_exp_f32 v98, v98
  v_exp_f32 v99, v99
  v_exp_f32 v100, v100
  v_exp_f32 v101, v101
  v_mfma_f32_32x32x16_bf16 v[144:159], v[88:91], v[80:83], v[144:159]
  v_exp_f32 v102, v102
  v_exp_f32 v103, v103
  v_cvt_pk_bf16_f32 v80, v96, v97
  v_exp_f32 v104, v104
  v_exp_f32 v105, v105
  v_cvt_pk_bf16_f32 v81, v98, v99
  v_exp_f32 v106, v106
  v_exp_f32 v107, v107
  v_mfma_f32_32x32x16_bf16 v[144:159], v[92:95], v[84:87], v[144:159]
  s_mov_b64 exec, s[58:59]
  ds_read_b128 v[88:91], v193 offset:16384
  ds_read_b128 v[92:95], v193 offset:16896
  s_mov_b64 exec, -1
  v_cvt_pk_bf16_f32 v82, v100, v101
  v_cvt_pk_bf16_f32 v83, v102, v103
  v_exp_f32 v108, v108
  v_exp_f32 v109, v109
  v_cvt_pk_bf16_f32 v84, v104, v105
  v_exp_f32 v110, v110
  v_exp_f32 v111, v111
  v_cvt_pk_bf16_f32 v85, v106, v107
  v_cvt_pk_bf16_f32 v86, v108, v109
  v_cvt_pk_bf16_f32 v87, v110, v111
  s_waitcnt lgkmcnt(0)
  v_mfma_f32_32x32x16_bf16 v[96:111], v[72:75], v[68:71], v[202:217]
  ds_read_b128 v[76:79], v192 offset:13312
  v_exp_f32 v112, v112
  v_exp_f32 v113, v113
  v_exp_f32 v114, v114
  v_exp_f32 v115, v115
  v_exp_f32 v116, v116
  v_exp_f32 v117, v117
  v_mfma_f32_32x32x16_bf16 v[144:159], v[88:91], v[80:83], v[144:159]
  v_exp_f32 v118, v118
  v_exp_f32 v119, v119
  v_cvt_pk_bf16_f32 v80, v112, v113
  v_exp_f32 v120, v120
  v_exp_f32 v121, v121
  v_cvt_pk_bf16_f32 v81, v114, v115
  v_exp_f32 v122, v122
  v_exp_f32 v123, v123
  v_mfma_f32_32x32x16_bf16 v[144:159], v[92:95], v[84:87], v[144:159]
  s_mov_b64 exec, s[58:59]
  ds_read_b128 v[88:91], v193 offset:15360
  ds_read_b128 v[92:95], v193 offset:15872
  s_mov_b64 exec, -1
  v_cvt_pk_bf16_f32 v82, v116, v117
  v_cvt_pk_bf16_f32 v83, v118, v119
  v_exp_f32 v124, v124
  v_exp_f32 v125, v125
  v_cvt_pk_bf16_f32 v84, v120, v121
  v_exp_f32 v126, v126
  v_exp_f32 v127, v127
  v_cvt_pk_bf16_f32 v85, v122, v123
  v_cvt_pk_bf16_f32 v86, v124, v125
  v_cvt_pk_bf16_f32 v87, v126, v127
  s_waitcnt vmcnt(0)
  v_cmp_ne_u32 vcc, s52, v12
  s_and_b64 vcc, vcc, s[16:17]
  s_mov_b32 s7, 4000
  s_cbranch_vccnz POLL_L11
POLL_D11:
  buffer_load_dword v12, v198, s[32:35], 0 offen sc1
  buffer_load_dwordx4 v[16:19], v1, s[32:35], s80 offen offset:0 sc1
  buffer_load_dwordx4 v[20:23], v1, s[32:35], s81 offen offset:0 sc1
  buffer_load_dwordx4 v[24:27], v1, s[32:35], s82 offen offset:0 sc1
  buffer_load_dwordx4 v[28:31], v1, s[32:35], s83 offen offset:0 sc1
  buffer_load_dwordx4 v[32:35], v1, s[32:35], s84 offen offset:0 sc1
  buffer_load_dwordx4 v[36:39], v1, s[32:35], s85 offen offset:0 sc1
  buffer_load_dwordx4 v[40:43], v1, s[32:35], s86 offen offset:0 sc1
  buffer_load_dwordx4 v[44:47], v1, s[32:35], s87 offen offset:0 sc1
  s_waitcnt lgkmcnt(0)
  v_mfma_f32_32x32x16_bf16 v[112:127], v[76:79], v[68:71], v[236:251]
  v_exp_f32 v96, v96
  v_exp_f32 v97, v97
  v_exp_f32 v98, v98
  v_exp_f32 v99, v99
  v_exp_f32 v100, v100
  v_exp_f32 v101, v101
  v_mfma_f32_32x32x16_bf16 v[144:159], v[88:91], v[80:83], v[144:159]
  v_exp_f32 v102, v102
  v_exp_f32 v103, v103
  v_cvt_pk_bf16_f32 v80, v96, v97
  v_exp_f32 v104, v104
  v_exp_f32 v105, v105
  v_cvt_pk_bf16_f32 v81, v98, v99
  v_exp_f32 v106, v106
  v_exp_f32 v107, v107
  v_mfma_f32_32x32x16_bf16 v[144:159], v[92:95], v[84:87], v[144:159]
  s_mov_b64 exec, s[58:59]
  ds_read_b128 v[88:91], v193 offset:14336
  ds_read_b128 v[92:95], v193 offset:14848
  s_mov_b64 exec, -1
  v_cvt_pk_bf16_f32 v82, v100, v101
  v_cvt_pk_bf16_f32 v83, v102, v103
  v_exp_f32 v108, v108
  v_exp_f32 v109, v109
  v_cvt_pk_bf16_f32 v84, v104, v105
  v_exp_f32 v110, v110
  v_exp_f32 v111, v111
  v_cvt_pk_bf16_f32 v85, v106, v107
  v_cvt_pk_bf16_f32 v86, v108, v109
  v_cvt_pk_bf16_f32 v87, v110, v111
  s_waitcnt lgkmcnt(0)
  v_exp_f32 v112, v112
  v_exp_f32 v113, v113
  v_exp_f32 v114, v114
  v_exp_f32 v115, v115
  v_exp_f32 v116, v116
  v_exp_f32 v117, v117
  v_mfma_f32_32x32x16_bf16 v[144:159], v[88:91], v[80:83], v[144:159]
  v_exp_f32 v118, v118
  v_exp_f32 v119, v119
  v_cvt_pk_bf16_f32 v80, v112, v113
  v_exp_f32 v120, v120
  v_exp_f32 v121, v121
  v_cvt_pk_bf16_f32 v81, v114, v115
  v_exp_f32 v122, v122
  v_exp_f32 v123, v123
  v_mfma_f32_32x32x16_bf16 v[144:159], v[92:95], v[84:87], v[144:159]
  s_mov_b64 exec, s[58:59]
  ds_read_b128 v[88:91], v193 offset:13312
  ds_read_b128 v[92:95], v193 offset:13824
  s_mov_b64 exec, -1
  v_cvt_pk_bf16_f32 v82, v116, v117
  v_cvt_pk_bf16_f32 v83, v118, v119
  v_exp_f32 v124, v124
  v_exp_f32 v125, v125
  v_cvt_pk_bf16_f32 v84, v120, v121
  v_exp_f32 v126, v126
  v_exp_f32 v127, v127
  v_cvt_pk_bf16_f32 v85, v122, v123
  v_cvt_pk_bf16_f32 v86, v124, v125
  v_cvt_pk_bf16_f32 v87, v126, v127
  s_branch H_FIN
PE11:
.p2align 12
PG12:
W3:
  s_branch W8
V3:
  ds_read_b128 v[72:75], v192 offset:11264
  ds_read_b128 v[76:79], v192 offset:20480
  s_nop 5
  v_pk_mul_f32 v[16:17], v[16:17], s[8:9]
  v_pk_mul_f32 v[18:19], v[18:19], s[8:9]
  v_pk_mul_f32 v[20:21], v[20:21], s[8:9]
  v_pk_mul_f32 v[22:23], v[22:23], s[8:9]
  v_cvt_pk_bf16_f32 v16, v16, v17
  v_cvt_pk_bf16_f32 v17, v18, v19
  v_cvt_pk_bf16_f32 v18, v20, v21
  v_cvt_pk_bf16_f32 v19, v22, v23
  ds_write_b128 v194, v[16:19] offset:0
  v_pk_mul_f32 v[40:41], v[40:41], s[8:9]
  v_pk_mul_f32 v[42:43], v[42:43], s[8:9]
  v_pk_mul_f32 v[44:45], v[44:45], s[8:9]
  v_pk_mul_f32 v[46:47], v[46:47], s[8:9]
  v_cvt_pk_bf16_f32 v40, v40, v41
  v_cvt_pk_bf16_f32 v41, v42, v43
  v_cvt_pk_bf16_f32 v42, v44, v45
  v_cvt_pk_bf16_f32 v43, v46, v47
  ds_write_b128 v194, v[40:43] offset:4096
  ds_write_b32 v171, v170
  v_pk_mul_f32 v[32:33], v[32:33], s[8:9]
  v_pk_mul_f32 v[34:35], v[34:35], s[8:9]
  v_pk_mul_f32 v[36:37], v[36:37], s[8:9]
  v_pk_mul_f32 v[38:39], v[38:39], s[8:9]
  v_pk_mul_f32 v[24:25], v[24:25], s[8:9]
  v_pk_mul_f32 v[26:27], v[26:27], s[8:9]
  v_pk_mul_f32 v[28:29], v[28:29], s[8:9]
  v_pk_mul_f32 v[30:31], v[30:31], s[8:9]
  v_cvt_pk_bf16_f32 v64, v32, v33
  v_cvt_pk_bf16_f32 v65, v34, v35
  v_cvt_pk_bf16_f32 v66, v36, v37
  v_cvt_pk_bf16_f32 v67, v38, v39
  v_cvt_pk_bf16_f32 v68, v24, v25
  v_cvt_pk_bf16_f32 v69, v26, v27
  s_waitcnt lgkmcnt(4)
  v_mfma_f32_32x32x16_bf16 v[96:111], v[72:75], v[64:67], v[220:235]
  v_cvt_pk_bf16_f32 v70, v28, v29
  v_cvt_pk_bf16_f32 v71, v30, v31
  s_nop 1
  s_waitcnt lgkmcnt(3)
  v_mfma_f32_32x32x16_bf16 v[112:127], v[76:79], v[68:71], v[220:235]
  ds_read_b128 v[72:75], v192 offset:10240
  s_nop 7
  v_exp_f32 v96, v96
  v_exp_f32 v97, v97
  v_exp_f32 v98, v98
  v_exp_f32 v99, v99
  v_exp_f32 v100, v100
  v_exp_f32 v101, v101
  v_exp_f32 v102, v102
  v_exp_f32 v103, v103
  v_cvt_pk_bf16_f32 v80, v96, v97
  v_exp_f32 v104, v104
  v_exp_f32 v105, v105
  v_cvt_pk_bf16_f32 v81, v98, v99
  v_exp_f32 v106, v106
  v_exp_f32 v107, v107
  s_mov_b64 exec, s[58:59]
  ds_read_b128 v[88:91], v193 offset:11264
  ds_read_b128 v[92:95], v193 offset:11776
  s_mov_b64 exec, -1
  v_cvt_pk_bf16_f32 v82, v100, v101
  v_cvt_pk_bf16_f32 v83, v102, v103
  v_exp_f32 v108, v108
  v_exp_f32 v109, v109
  v_cvt_pk_bf16_f32 v84, v104, v105
  v_exp_f32 v110, v110
  v_exp_f32 v111, v111
  v_cvt_pk_bf16_f32 v85, v106, v107
  v_cvt_pk_bf16_f32 v86, v108, v109
  v_cvt_pk_bf16_f32 v87, v110, v111
  s_waitcnt lgkmcnt(0)
  v_mfma_f32_32x32x16_bf16 v[96:111], v[72:75], v[64:67], 0
  ds_read_b128 v[76:79], v192 offset:9216
  v_exp_f32 v112, v112
  v_exp_f32 v113, v113
  v_exp_f32 v114, v114
  v_exp_f32 v115, v115
  v_exp_f32 v116, v116
  v_exp_f32 v117, v117
  v_mfma_f32_32x32x16_bf16 v[128:143], v[88:91], v[80:83], 0
  v_exp_f32 v118, v118
  v_exp_f32 v119, v119
  v_cvt_pk_bf16_f32 v80, v112, v113
  v_exp_f32 v120, v120
  v_exp_f32 v121, v121
  v_cvt_pk_bf16_f32 v81, v114, v115
  v_exp_f32 v122, v122
  v_exp_f32 v123, v123
  v_mfma_f32_32x32x16_bf16 v[128:143], v[92:95], v[84:87], v[128:143]
  s_mov_b64 exec, s[58:59]
  ds_read_b128 v[88:91], v193 offset:20480
  ds_read_b128 v[92:95], v193 offset:20992
  s_mov_b64 exec, -1
  v_cvt_pk_bf16_f32 v82, v116, v117
  v_cvt_pk_bf16_f32 v83, v118, v119
  v_exp_f32 v124, v124
  v_exp_f32 v125, v125
  v_cvt_pk_bf16_f32 v84, v120, v121
  v_exp_f32 v126, v126
  v_exp_f32 v127, v127
  v_cvt_pk_bf16_f32 v85, v122, v123
  v_cvt_pk_bf16_f32 v86, v124, v125
  v_cvt_pk_bf16_f32 v87, v126, v127
  s_waitcnt lgkmcnt(0)
  v_mfma_f32_32x32x16_bf16 v[112:127], v[76:79], v[64:67], 0
  ds_read_b128 v[72:75], v192 offset:8192
  v_exp_f32 v96, v96
  v_exp_f32 v97, v97
  v_exp_f32 v98, v98
  v_exp_f32 v99, v99
  v_exp_f32 v100, v100
  v_exp_f32 v101, v101
  v_mfma_f32_32x32x16_bf16 v[144:159], v[88:91], v[80:83], 0
  v_exp_f32 v102, v102
  v_exp_f32 v103, v103
  v_cvt_pk_bf16_f32 v80, v96, v97
  v_exp_f32 v104, v104
  v_exp_f32 v105, v105
  v_cvt_pk_bf16_f32 v81, v98, v99
  v_exp_f32 v106, v106
  v_exp_f32 v107, v107
  v_mfma_f32_32x32x16_bf16 v[144:159], v[92:95], v[84:87], v[144:159]
  s_mov_b64 exec, s[58:59]
  ds_read_b128 v[88:91], v193 offset:10240
  ds_read_b128 v[92:95], v193 offset:10752
  s_mov_b64 exec, -1
  v_cvt_pk_bf16_f32 v82, v100, v101
  v_cvt_pk_bf16_f32 v83, v102, v103
  v_exp_f32 v108, v108
  v_exp_f32 v109, v109
  v_cvt_pk_bf16_f32 v84, v104, v105
  v_exp_f32 v110, v110
  v_exp_f32 v111, v111
  v_cvt_pk_bf16_f32 v85, v106, v107
  v_cvt_pk_bf16_f32 v86, v108, v109
  v_cvt_pk_bf16_f32 v87, v110, v111
  s_waitcnt lgkmcnt(0)
  v_mfma_f32_32x32x16_bf16 v[96:111], v[72:75], v[64:67], 0
  v_exp_f32 v112, v112
  v_exp_f32 v113, v113
  v_exp_f32 v114, v114
  v_exp_f32 v115, v115
  v_exp_f32 v116, v116
  v_exp_f32 v117, v117
  v_mfma_f32_32x32x16_bf16 v[128:143], v[88:91], v[80:83], v[128:143]
  v_exp_f32 v118, v118
  v_exp_f32 v119, v119
  v_cvt_pk_bf16_f32 v80, v112, v113
  v_exp_f32 v120, v120
  v_exp_f32 v121, v121
  v_cvt_pk_bf16_f32 v81, v114, v115
  v_exp_f32 v122, v122
  v_exp_f32 v123, v123
  v_mfma_f32_32x32x16_bf16 v[128:143], v[92:95], v[84:87], v[128:143]
  s_mov_b64 exec, s[58:59]
  ds_read_b128 v[88:91], v193 offset:9216
  ds_read_b128 v[92:95], v193 offset:9728
  s_mov_b64 exec, -1
  v_cvt_pk_bf16_f32 v82, v116, v117
  v_cvt_pk_bf16_f32 v83, v118, v119
  v_exp_f32 v124, v124
  v_exp_f32 v125, v125
  v_cvt_pk_bf16_f32 v84, v120, v121
  v_exp_f32 v126, v126
  v_exp_f32 v127, v127
  v_cvt_pk_bf16_f32 v85, v122, v123
  v_cvt_pk_bf16_f32 v86, v124, v125
  v_cvt_pk_bf16_f32 v87, v126, v127
  s_waitcnt lgkmcnt(0)
  v_exp_f32 v96, v96
  v_exp_f32 v97, v97
  v_exp_f32 v98, v98
  v_exp_f32 v99, v99
  v_exp_f32 v100, v100
  v_exp_f32 v101, v101
  v_mfma_f32_32x32x16_bf16 v[128:143], v[88:91], v[80:83], v[128:143]
  v_exp_f32 v102, v102
  v_exp_f32 v103, v103
  v_cvt_pk_bf16_f32 v80, v96, v97
  v_exp_f32 v104, v104
  v_exp_f32 v105, v105
  v_cvt_pk_bf16_f32 v81, v98, v99
  v_exp_f32 v106, v106
  v_exp_f32 v107, v107
  v_mfma_f32_32x32x16_bf16 v[128:143], v[92:95], v[84:87], v[128:143]
  s_mov_b64 exec, s[58:59]
  ds_read_b128 v[88:91], v193 offset:8192
  ds_read_b128 v[92:95], v193 offset:8704
  s_mov_b64 exec, -1
  v_cvt_pk_bf16_f32 v82, v100, v101
  v_cvt_pk_bf16_f32 v83, v102, v103
  v_exp_f32 v108, v108
  v_exp_f32 v109, v109
  v_cvt_pk_bf16_f32 v84, v104, v105
  v_exp_f32 v110, v110
  v_exp_f32 v111, v111
  v_cvt_pk_bf16_f32 v85, v106, v107
  v_cvt_pk_bf16_f32 v86, v108, v109
  v_cvt_pk_bf16_f32 v87, v110, v111
  s_barrier
  buffer_load_dword v252, v196, s[32:35], 0 offen
  ds_read_b128 v[76:79], v192 offset:7168
  ds_read_b128 v[72:75], v192 offset:6144
  s_waitcnt lgkmcnt(3)
  v_mfma_f32_32x32x16_bf16 v[128:143], v[88:91], v[80:83], v[128:143]
  s_waitcnt lgkmcnt(2)
  v_mfma_f32_32x32x16_bf16 v[128:143], v[92:95], v[84:87], v[128:143]
  s_waitcnt lgkmcnt(1)
  v_mfma_f32_32x32x16_bf16 v[112:127], v[76:79], v[64:67], v[172:187]
  s_waitcnt lgkmcnt(0)
  v_mfma_f32_32x32x16_bf16 v[96:111], v[72:75], v[64:67], v[172:187]
  ds_read_b128 v[76:79], v192 offset:5120
  s_nop 8
  v_exp_f32 v112, v112
  v_exp_f32 v113, v113
  v_exp_f32 v114, v114
  v_exp_f32 v115, v115
  v_exp_f32 v116, v116
  v_exp_f32 v117, v117
  v_exp_f32 v118, v118
  v_exp_f32 v119, v119
  v_cvt_pk_bf16_f32 v80, v112, v113
  v_exp_f32 v120, v120
  v_exp_f32 v121, v121
  v_cvt_pk_bf16_f32 v81, v114, v115
  v_exp_f32 v122, v122
  v_exp_f32 v123, v123
  s_mov_b64 exec, s[58:59]
  ds_read_b128 v[88:91], v193 offset:7168
  ds_read_b128 v[92:95], v193 offset:7680
  s_mov_b64 exec, -1
  v_cvt_pk_bf16_f32 v82, v116, v117
  v_cvt_pk_bf16_f32 v83, v118, v119
  v_exp_f32 v124, v124
  v_exp_f32 v125, v125
  v_cvt_pk_bf16_f32 v84, v120, v121
  v_exp_f32 v126, v126
  v_exp_f32 v127, v127
  v_cvt_pk_bf16_f32 v85, v122, v123
  v_cvt_pk_bf16_f32 v86, v124, v125
  v_cvt_pk_bf16_f32 v87, v126, v127
  s_waitcnt lgkmcnt(0)
  v_mfma_f32_32x32x16_bf16 v[112:127], v[76:79], v[64:67], v[172:187]
  ds_read_b128 v[72:75], v192 offset:4096
  v_exp_f32 v96, v96
  v_exp_f32 v97, v97
  v_exp_f32 v98, v98
  v_exp_f32 v99, v99
  v_exp_f32 v100, v100
  v_exp_f32 v101, v101
  v_mfma_f32_32x32x16_bf16 v[128:143], v[88:91], v[80:83], v[128:143]
  v_exp_f32 v102, v102
  v_exp_f32 v103, v103
  v_cvt_pk_bf16_f32 v80, v96, v97
  v_exp_f32 v104, v104
  v_exp_f32 v105, v105
  v_cvt_pk_bf16_f32 v81, v98, v99
  v_exp_f32 v106, v106
  v_exp_f32 v107, v107
  v_mfma_f32_32x32x16_bf16 v[128:143], v[92:95], v[84:87], v[128:143]
  s_mov_b64 exec, s[58:59]
  ds_read_b128 v[88:91], v193 offset:6144
  ds_read_b128 v[92:95], v193 offset:6656
  s_mov_b64 exec, -1
  v_cvt_pk_bf16_f32 v82, v100, v101
  v_cvt_pk_bf16_f32 v83, v102, v103
  v_exp_f32 v108, v108
  v_exp_f32 v109, v109
  v_cvt_pk_bf16_f32 v84, v104, v105
  v_exp_f32 v110, v110
  v_exp_f32 v111, v111
  v_cvt_pk_bf16_f32 v85, v106, v107
  v_cvt_pk_bf16_f32 v86, v108, v109
  v_cvt_pk_bf16_f32 v87, v110, v111
  s_waitcnt lgkmcnt(0)
  v_mfma_f32_32x32x16_bf16 v[96:111], v[72:75], v[64:67], v[172:187]
  ds_read_b128 v[76:79], v192 offset:3072
  v_exp_f32 v112, v112
  v_exp_f32 v113, v113
  v_exp_f32 v114, v114
  v_exp_f32 v115, v115
  v_exp_f32 v116, v116
  v_exp_f32 v117, v117
  v_mfma_f32_32x32x16_bf16 v[128:143], v[88:91], v[80:83], v[128:143]
  v_exp_f32 v118, v118
  v_exp_f32 v119, v119
  v_cvt_pk_bf16_f32 v80, v112, v113
  v_exp_f32 v120, v120
  v_exp_f32 v121, v121
  v_cvt_pk_bf16_f32 v81, v114, v115
  v_exp_f32 v122, v122
  v_exp_f32 v123, v123
  v_mfma_f32_32x32x16_bf16 v[128:143], v[92:95], v[84:87], v[128:143]
  s_mov_b64 exec, s[58:59]
  ds_read_b128 v[88:91], v193 offset:5120
  ds_read_b128 v[92:95], v193 offset:5632
  s_mov_b64 exec, -1
  v_cvt_pk_bf16_f32 v82, v116, v117
  v_cvt_pk_bf16_f32 v83, v118, v119
  v_exp_f32 v124, v124
  v_exp_f32 v125, v125
  v_cvt_pk_bf16_f32 v84, v120, v121
  v_exp_f32 v126, v126
  v_exp_f32 v127, v127
  v_cvt_pk_bf16_f32 v85, v122, v123
  v_cvt_pk_bf16_f32 v86, v124, v125
  v_cvt_pk_bf16_f32 v87, v126, v127
  s_waitcnt lgkmcnt(0)
  v_mfma_f32_32x32x16_bf16 v[112:127], v[76:79], v[64:67], v[236:251]
  ds_read_b128 v[72:75], v192 offset:19456
  v_exp_f32 v96, v96
  v_exp_f32 v97, v97
  v_exp_f32 v98, v98
  v_exp_f32 v99, v99
  v_exp_f32 v100, v100
  v_exp_f32 v101, v101
  v_mfma_f32_32x32x16_bf16 v[128:143], v[88:91], v[80:83], v[128:143]
  v_exp_f32 v102, v102
  v_exp_f32 v103, v103
  v_cvt_pk_bf16_f32 v80, v96, v97
  v_exp_f32 v104, v104
  v_exp_f32 v105, v105
  v_cvt_pk_bf16_f32 v81, v98, v99
  v_exp_f32 v106, v106
  v_exp_f32 v107, v107
  v_mfma_f32_32x32x16_bf16 v[128:143], v[92:95], v[84:87], v[128:143]
  s_mov_b64 exec, s[58:59]
  ds_read_b128 v[88:91], v193 offset:4096
  ds_read_b128 v[92:95], v193 offset:4608
  s_mov_b64 exec, -1
  v_cvt_pk_bf16_f32 v82, v100, v101
  v_cvt_pk_bf16_f32 v83, v102, v103
  v_exp_f32 v108, v108
  v_exp_f32 v109, v109
  v_cvt_pk_bf16_f32 v84, v104, v105
  v_exp_f32 v110, v110
  v_exp_f32 v111, v111
  v_cvt_pk_bf16_f32 v85, v106, v107
  v_cvt_pk_bf16_f32 v86, v108, v109
  v_cvt_pk_bf16_f32 v87, v110, v111
  s_waitcnt lgkmcnt(0)
  v_mfma_f32_32x32x16_bf16 v[96:111], v[72:75], v[68:71], v[172:187]
  ds_read_b128 v[76:79], v192 offset:18432
  v_exp_f32 v112, v112
  v_exp_f32 v113, v113
  v_exp_f32 v114, v114
  v_exp_f32 v115, v115
  v_exp_f32 v116, v116
  v_exp_f32 v117, v117
  v_mfma_f32_32x32x16_bf16 v[128:143], v[88:91], v[80:83], v[128:143]
  v_exp_f32 v118, v118
  v_exp_f32 v119, v119
  v_cvt_pk_bf16_f32 v80, v112, v113
  v_exp_f32 v120, v120
  v_exp_f32 v121, v121
  v_cvt_pk_bf16_f32 v81, v114, v115
  v_exp_f32 v122, v122
  v_exp_f32 v123, v123
  v_mfma_f32_32x32x16_bf16 v[128:143], v[92:95], v[84:87], v[128:143]
  s_mov_b64 exec, s[58:59]
  ds_read_b128 v[88:91], v193 offset:3072
  ds_read_b128 v[92:95], v193 offset:3584
  s_mov_b64 exec, -1
  v_cvt_pk_bf16_f32 v82, v116, v117
  v_cvt_pk_bf16_f32 v83, v118, v119
  v_exp_f32 v124, v124
  v_exp_f32 v125, v125
  v_cvt_pk_bf16_f32 v84, v120, v121
  v_exp_f32 v126, v126
  v_exp_f32 v127, v127
  v_cvt_pk_bf16_f32 v85, v122, v123
  v_cvt_pk_bf16_f32 v86, v124, v125
  v_cvt_pk_bf16_f32 v87, v126, v127
  s_waitcnt lgkmcnt(0)
  v_mfma_f32_32x32x16_bf16 v[112:127], v[76:79], v[68:71], v[172:187]
  ds_read_b128 v[72:75], v192 offset:17408
  v_exp_f32 v96, v96
  v_exp_f32 v97, v97
  v_exp_f32 v98, v98
  v_exp_f32 v99, v99
  v_exp_f32 v100, v100
  v_exp_f32 v101, v101
  v_mfma_f32_32x32x16_bf16 v[128:143], v[88:91], v[80:83], v[128:143]
  v_exp_f32 v102, v102
  v_exp_f32 v103, v103
  v_cvt_pk_bf16_f32 v80, v96, v97
  v_exp_f32 v104, v104
  v_exp_f32 v105, v105
  v_cvt_pk_bf16_f32 v81, v98, v99
  v_exp_f32 v106, v106
  v_exp_f32 v107, v107
  v_mfma_f32_32x32x16_bf16 v[128:143], v[92:95], v[84:87], v[128:143]
  s_mov_b64 exec, s[58:59]
  ds_read_b128 v[88:91], v193 offset:19456
  ds_read_b128 v[92:95], v193 offset:19968
  s_mov_b64 exec, -1
  v_cvt_pk_bf16_f32 v82, v100, v101
  v_cvt_pk_bf16_f32 v83, v102, v103
  v_exp_f32 v108, v108
  v_exp_f32 v109, v109
  v_cvt_pk_bf16_f32 v84, v104, v105
  v_exp_f32 v110, v110
  v_exp_f32 v111, v111
  v_cvt_pk_bf16_f32 v85, v106, v107
  v_cvt_pk_bf16_f32 v86, v108, v109
  v_cvt_pk_bf16_f32 v87, v110, v111
  v_med3_f32 v14, v136, s56, v197
  v_cmp_neq_f32 vcc, v14, v136
  s_cbranch_vccnz FB0
FBDa3:
  v_rcp_f32 v14, v136
  s_nop 0
  v_mul_f32 v128, v128, v14
  v_mul_f32 v129, v129, v14
  v_mul_f32 v130, v130, v14
  v_mul_f32 v131, v131, v14
  v_mul_f32 v132, v132, v14
  v_mul_f32 v133, v133, v14
  v_mul_f32 v134, v134, v14
  v_mul_f32 v135, v135, v14
  v_cvt_pk_bf16_f32 v56, v128, v129
  v_cvt_pk_bf16_f32 v57, v130, v131
  v_cvt_pk_bf16_f32 v58, v132, v133
  v_cvt_pk_bf16_f32 v59, v134, v135
  s_cmp_eq_u32 s19, 0
  s_cbranch_scc1 DU_A12
  buffer_store_dwordx4 v[56:59], v1, s[32:35], s12 offen
DU_B12:
  s_waitcnt lgkmcnt(0)
  v_mfma_f32_32x32x16_bf16 v[96:111], v[72:75], v[68:71], v[172:187]
  ds_read_b128 v[76:79], v192 offset:16384
  v_exp_f32 v112, v112
  v_exp_f32 v113, v113
  v_exp_f32 v114, v114
  v_exp_f32 v115, v115
  v_exp_f32 v116, v116
  v_exp_f32 v117, v117
  v_mfma_f32_32x32x16_bf16 v[144:159], v[88:91], v[80:83], v[144:159]
  v_exp_f32 v118, v118
  v_exp_f32 v119, v119
  v_cvt_pk_bf16_f32 v80, v112, v113
  v_exp_f32 v120, v120
  v_exp_f32 v121, v121
  v_cvt_pk_bf16_f32 v81, v114, v115
  v_exp_f32 v122, v122
  v_exp_f32 v123, v123
  v_mfma_f32_32x32x16_bf16 v[144:159], v[92:95], v[84:87], v[144:159]
  s_mov_b64 exec, s[58:59]
  ds_read_b128 v[88:91], v193 offset:18432
  ds_read_b128 v[92:95], v193 offset:18944
  s_mov_b64 exec, -1
  v_cvt_pk_bf16_f32 v82, v116, v117
  v_cvt_pk_bf16_f32 v83, v118, v119
  v_exp_f32 v124, v124
  v_exp_f32 v125, v125
  v_cvt_pk_bf16_f32 v84, v120, v121
  v_exp_f32 v126, v126
  v_exp_f32 v127, v127
  v_cvt_pk_bf16_f32 v85, v122, v123
  v_cvt_pk_bf16_f32 v86, v124, v125
  v_cvt_pk_bf16_f32 v87, v126, v127
  s_waitcnt lgkmcnt(0)
  v_mfma_f32_32x32x16_bf16 v[112:127], v[76:79], v[68:71], v[172:187]
  ds_read_b128 v[72:75], v192 offset:15360
  v_exp_f32 v96, v96
  v_exp_f32 v97, v97
  v_exp_f32 v98, v98
  v_exp_f32 v99, v99
  v_exp_f32 v100, v100
  v_exp_f32 v101, v101
  v_mfma_f32_32x32x16_bf16 v[144:159], v[88:91], v[80:83], v[144:159]
  v_exp_f32 v102, v102
  v_exp_f32 v103, v103
  v_cvt_pk_bf16_f32 v80, v96, v97
  v_exp_f32 v104, v104
  v_exp_f32 v105, v105
  v_cvt_pk_bf16_f32 v81, v98, v99
  v_exp_f32 v106, v106
  v_exp_f32 v107, v107
  v_mfma_f32_32x32x16_bf16 v[144:159], v[92:95], v[84:87], v[144:159]
  s_mov_b64 exec, s[58:59]
  ds_read_b128 v[88:91], v193 offset:17408
  ds_read_b128 v[92:95], v193 offset:17920
  s_mov_b64 exec, -1
  v_cvt_pk_bf16_f32 v82, v100, v101
  v_cvt_pk_bf16_f32 v83, v102, v103
  v_exp_f32 v108, v108
  v_exp_f32 v109, v109
  v_cvt_pk_bf16_f32 v84, v104, v105
  v_exp_f32 v110, v110
  v_exp_f32 v111, v111
  v_cvt_pk_bf16_f32 v85, v106, v107
  v_cvt_pk_bf16_f32 v86, v108, v109
  v_cvt_pk_bf16_f32 v87, v110, v111
  s_waitcnt lgkmcnt(0)
  v_mfma_f32_32x32x16_bf16 v[96:111], v[72:75], v[68:71], v[202:217]
  ds_read_b128 v[76:79], v192 offset:14336
  v_exp_f32 v112, v112
  v_exp_f32 v113, v113
  v_exp_f32 v114, v114
  v_exp_f32 v115, v115
  v_exp_f32 v116, v116
  v_exp_f32 v117, v117
  v_mfma_f32_32x32x16_bf16 v[144:159], v[88:91], v[80:83], v[144:159]
  v_exp_f32 v118, v118
  v_exp_f32 v119, v119
  v_cvt_pk_bf16_f32 v80, v112, v113
  v_exp_f32 v120, v120
  v_exp_f32 v121, v121
  v_cvt_pk_bf16_f32 v81, v114, v115
  v_exp_f32 v122, v122
  v_exp_f32 v123, v123
  v_mfma_f32_32x32x16_bf16 v[144:159], v[92:95], v[84:87], v[144:159]
  s_mov_b64 exec, s[58:59]
  ds_read_b128 v[88:91], v193 offset:16384
  ds_read_b128 v[92:95], v193 offset:16896
  s_mov_b64 exec, -1
  v_cvt_pk_bf16_f32 v82, v116, v117
  v_cvt_pk_bf16_f32 v83, v118, v119
  v_exp_f32 v124, v124
  v_exp_f32 v125, v125
  v_cvt_pk_bf16_f32 v84, v120, v121
  v_exp_f32 v126, v126
  v_exp_f32 v127, v127
  v_cvt_pk_bf16_f32 v85, v122, v123
  v_cvt_pk_bf16_f32 v86, v124, v125
  v_cvt_pk_bf16_f32 v87, v126, v127
  buffer_load_dword v12, v198, s[32:35], 0 offen sc1
  s_waitcnt lgkmcnt(0)
  v_mfma_f32_32x32x16_bf16 v[112:127], v[76:79], v[68:71], v[202:217]
  ds_read_b128 v[72:75], v192 offset:13312
  v_exp_f32 v96, v96
  v_exp_f32 v97, v97
  v_exp_f32 v98, v98
  v_exp_f32 v99, v99
  v_exp_f32 v100, v100
  v_exp_f32 v101, v101
  v_mfma_f32_32x32x16_bf16 v[144:159], v[88:91], v[80:83], v[144:159]
  v_exp_f32 v102, v102
  v_exp_f32 v103, v103
  v_cvt_pk_bf16_f32 v80, v96, v97
  v_exp_f32 v104, v104
  v_exp_f32 v105, v105
  v_cvt_pk_bf16_f32 v81, v98, v99
  v_exp_f32 v106, v106
  v_exp_f32 v107, v107
  v_mfma_f32_32x32x16_bf16 v[144:159], v[92:95], v[84:87], v[144:159]
  s_mov_b64 exec, s[58:59]
  ds_read_b128 v[88:91], v193 offset:15360
  ds_read_b128 v[92:95], v193 offset:15872
  s_mov_b64 exec, -1
  v_cvt_pk_bf16_f32 v82, v100, v101
  v_cvt_pk_bf16_f32 v83, v102, v103
  v_exp_f32 v108, v108
  v_exp_f32 v109, v109
  v_cvt_pk_bf16_f32 v84, v104, v105
  v_exp_f32 v110, v110
  v_exp_f32 v111, v111
  v_cvt_pk_bf16_f32 v85, v106, v107
  v_cvt_pk_bf16_f32 v86, v108, v109
  v_cvt_pk_bf16_f32 v87, v110, v111
  s_waitcnt lgkmcnt(0)
  v_mfma_f32_32x32x16_bf16 v[96:111], v[72:75], v[68:71], v[202:217]
  ds_read_b128 v[76:79], v192 offset:12288
  v_exp_f32 v112, v112
  v_exp_f32 v113, v113
  v_exp_f32 v114, v114
  v_exp_f32 v115, v115
  v_exp_f32 v116, v116
  v_exp_f32 v117, v117
  v_mfma_f32_32x32x16_bf16 v[144:159], v[88:91], v[80:83], v[144:159]
  v_exp_f32 v118, v118
  v_exp_f32 v119, v119
  v_cvt_pk_bf16_f32 v80, v112, v113
  v_exp_f32 v120, v120
  v_exp_f32 v121, v121
  v_cvt_pk_bf16_f32 v81, v114, v115
  v_exp_f32 v122, v122
  v_exp_f32 v123, v123
  v_mfma_f32_32x32x16_bf16 v[144:159], v[92:95], v[84:87], v[144:159]
  s_mov_b64 exec, s[58:59]
  ds_read_b128 v[88:91], v193 offset:14336
  ds_read_b128 v[92:95], v193 offset:14848
  s_mov_b64 exec, -1
  v_cvt_pk_bf16_f32 v82, v116, v117
  v_cvt_pk_bf16_f32 v83, v118, v119
  v_exp_f32 v124, v124
  v_exp_f32 v125, v125
  v_cvt_pk_bf16_f32 v84, v120, v121
  v_exp_f32 v126, v126
  v_exp_f32 v127, v127
  v_cvt_pk_bf16_f32 v85, v122, v123
  v_cvt_pk_bf16_f32 v86, v124, v125
  v_cvt_pk_bf16_f32 v87, v126, v127
  s_waitcnt vmcnt(0)
  v_cmp_ne_u32 vcc, s52, v12
  s_and_b64 vcc, vcc, s[16:17]
  s_mov_b32 s7, 4000
  s_cbranch_vccnz POLL_L13
POLL_D13:
  buffer_load_dword v12, v198, s[32:35], 0 offen sc1
  buffer_load_dwordx4 v[16:19], v1, s[32:35], s80 offen offset:0 sc1
  buffer_load_dwordx4 v[20:23], v1, s[32:35], s81 offen offset:0 sc1
  buffer_load_dwordx4 v[24:27], v1, s[32:35], s82 offen offset:0 sc1
  buffer_load_dwordx4 v[28:31], v1, s[32:35], s83 offen offset:0 sc1
  buffer_load_dwordx4 v[32:35], v1, s[32:35], s84 offen offset:0 sc1
  buffer_load_dwordx4 v[36:39], v1, s[32:35], s85 offen offset:0 sc1
  buffer_load_dwordx4 v[40:43], v1, s[32:35], s86 offen offset:0 sc1
  buffer_load_dwordx4 v[44:47], v1, s[32:35], s87 offen offset:0 sc1
  s_waitcnt lgkmcnt(0)
  v_mfma_f32_32x32x16_bf16 v[112:127], v[76:79], v[68:71], v[236:251]
  v_exp_f32 v96, v96
  v_exp_f32 v97, v97
  v_exp_f32 v98, v98
  v_exp_f32 v99, v99
  v_exp_f32 v100, v100
  v_exp_f32 v101, v101
  v_mfma_f32_32x32x16_bf16 v[144:159], v[88:91], v[80:83], v[144:159]
  v_exp_f32 v102, v102
  v_exp_f32 v103, v103
  v_cvt_pk_bf16_f32 v80, v96, v97
  v_exp_f32 v104, v104
  v_exp_f32 v105, v105
  v_cvt_pk_bf16_f32 v81, v98, v99
  v_exp_f32 v106, v106
  v_exp_f32 v107, v107
  v_mfma_f32_32x32x16_bf16 v[144:159], v[92:95], v[84:87], v[144:159]
  s_mov_b64 exec, s[58:59]
  ds_read_b128 v[88:91], v193 offset:13312
  ds_read_b128 v[92:95], v193 offset:13824
  s_mov_b64 exec, -1
  v_cvt_pk_bf16_f32 v82, v100, v101
  v_cvt_pk_bf16_f32 v83, v102, v103
  v_exp_f32 v108, v108
  v_exp_f32 v109, v109
  v_cvt_pk_bf16_f32 v84, v104, v105
  v_exp_f32 v110, v110
  v_exp_f32 v111, v111
  v_cvt_pk_bf16_f32 v85, v106, v107
  v_cvt_pk_bf16_f32 v86, v108, v109
  v_cvt_pk_bf16_f32 v87, v110, v111
  s_waitcnt lgkmcnt(0)
  v_exp_f32 v112, v112
  v_exp_f32 v113, v113
  v_exp_f32 v114, v114
  v_exp_f32 v115, v115
  v_exp_f32 v116, v116
  v_exp_f32 v117, v117
  v_mfma_f32_32x32x16_bf16 v[144:159], v[88:91], v[80:83], v[144:159]
  v_exp_f32 v118, v118
  v_exp_f32 v119, v119
  v_cvt_pk_bf16_f32 v80, v112, v113
  v_exp_f32 v120, v120
  v_exp_f32 v121, v121
  v_cvt_pk_bf16_f32 v81, v114, v115
  v_exp_f32 v122, v122
  v_exp_f32 v123, v123
  v_mfma_f32_32x32x16_bf16 v[144:159], v[92:95], v[84:87], v[144:159]
  s_mov_b64 exec, s[58:59]
  ds_read_b128 v[88:91], v193 offset:12288
  ds_read_b128 v[92:95], v193 offset:12800
  s_mov_b64 exec, -1
  v_cvt_pk_bf16_f32 v82, v116, v117
  v_cvt_pk_bf16_f32 v83, v118, v119
  v_exp_f32 v124, v124
  v_exp_f32 v125, v125
  v_cvt_pk_bf16_f32 v84, v120, v121
  v_exp_f32 v126, v126
  v_exp_f32 v127, v127
  v_cvt_pk_bf16_f32 v85, v122, v123
  v_cvt_pk_bf16_f32 v86, v124, v125
  v_cvt_pk_bf16_f32 v87, v126, v127
  s_branch H_FIN
PE12:
.p2align 12
PG13:
W4:
  s_branch W3
VH0:
  v_mfma_f32_32x32x16_bf16 v[112:127], v[76:79], v[68:71], v[220:235]
  ds_read_b128 v[72:75], v192 offset:22528
  s_nop 7
  v_exp_f32 v96, v96
  v_exp_f32 v97, v97
  v_exp_f32 v98, v98
  v_exp_f32 v99, v99
  v_exp_f32 v100, v100
  v_exp_f32 v101, v101
  v_exp_f32 v102, v102
  v_exp_f32 v103, v103
  v_cvt_pk_bf16_f32 v80, v96, v97
  v_exp_f32 v104, v104
  v_exp_f32 v105, v105
  v_cvt_pk_bf16_f32 v81, v98, v99
  v_exp_f32 v106, v106
  v_exp_f32 v107, v107
  s_mov_b64 exec, s[58:59]
  ds_read_b128 v[88:91], v193 offset:8192
  ds_read_b128 v[92:95], v193 offset:8704
  s_mov_b64 exec, -1
  v_cvt_pk_bf16_f32 v82, v100, v101
  v_cvt_pk_bf16_f32 v83, v102, v103
  v_exp_f32 v108, v108
  v_exp_f32 v109, v109
  v_cvt_pk_bf16_f32 v84, v104, v105
  v_exp_f32 v110, v110
  v_exp_f32 v111, v111
  v_cvt_pk_bf16_f32 v85, v106, v107
  v_cvt_pk_bf16_f32 v86, v108, v109
  v_cvt_pk_bf16_f32 v87, v110, v111
  s_waitcnt lgkmcnt(0)
  v_mfma_f32_32x32x16_bf16 v[96:111], v[72:75], v[68:71], 0
  ds_read_b128 v[76:79], v192 offset:21504
  v_exp_f32 v112, v112
  v_exp_f32 v113, v113
  v_exp_f32 v114, v114
  v_exp_f32 v115, v115
  v_exp_f32 v116, v116
  v_exp_f32 v117, v117
  v_mfma_f32_32x32x16_bf16 v[128:143], v[88:91], v[80:83], 0
  v_exp_f32 v118, v118
  v_exp_f32 v119, v119
  v_cvt_pk_bf16_f32 v80, v112, v113
  v_exp_f32 v120, v120
  v_exp_f32 v121, v121
  v_cvt_pk_bf16_f32 v81, v114, v115
  v_exp_f32 v122, v122
  v_exp_f32 v123, v123
  v_mfma_f32_32x32x16_bf16 v[128:143], v[92:95], v[84:87], v[128:143]
  s_mov_b64 exec, s[58:59]
  ds_read_b128 v[88:91], v193 offset:23552
  ds_read_b128 v[92:95], v193 offset:24064
  s_mov_b64 exec, -1
  v_cvt_pk_bf16_f32 v82, v116, v117
  v_cvt_pk_bf16_f32 v83, v118, v119
  v_exp_f32 v124, v124
  v_exp_f32 v125, v125
  v_cvt_pk_bf16_f32 v84, v120, v121
  v_exp_f32 v126, v126
  v_exp_f32 v127, v127
  v_cvt_pk_bf16_f32 v85, v122, v123
  v_cvt_pk_bf16_f32 v86, v124, v125
  v_cvt_pk_bf16_f32 v87, v126, v127
  s_cmp_eq_u32 s81, 0
  s_cbranch_scc1 CK2
CR2_0:
  s_waitcnt lgkmcnt(0)
  v_mfma_f32_32x32x16_bf16 v[112:127], v[76:79], v[68:71], 0
  ds_read_b128 v[72:75], v192 offset:20480
  v_exp_f32 v96, v96
  v_exp_f32 v97, v97
  v_exp_f32 v98, v98
  v_exp_f32 v99, v99
  v_exp_f32 v100, v100
  v_exp_f32 v101, v101
  v_mfma_f32_32x32x16_bf16 v[144:159], v[88:91], v[80:83], 0
  v_exp_f32 v102, v102
  v_exp_f32 v103, v103
  v_cvt_pk_bf16_f32 v80, v96, v97
  v_exp_f32 v104, v104
  v_exp_f32 v105, v105
  v_cvt_pk_bf16_f32 v81, v98, v99
  v_exp_f32 v106, v106
  v_exp_f32 v107, v107
  v_mfma_f32_32x32x16_bf16 v[144:159], v[92:95], v[84:87], v[144:159]
  s_mov_b64 exec, s[58:59]
  ds_read_b128 v[88:91], v193 offset:22528
  ds_read_b128 v[92:95], v193 offset:23040
  s_mov_b64 exec, -1
  v_cvt_pk_bf16_f32 v82, v100, v101
  v_cvt_pk_bf16_f32 v83, v102, v103
  v_exp_f32 v108, v108
  v_exp_f32 v109, v109
  v_cvt_pk_bf16_f32 v84, v104, v105
  v_exp_f32 v110, v110
  v_exp_f32 v111, v111
  v_cvt_pk_bf16_f32 v85, v106, v107
  v_cvt_pk_bf16_f32 v86, v108, v109
  v_cvt_pk_bf16_f32 v87, v110, v111
  s_waitcnt lgkmcnt(0)
  v_mfma_f32_32x32x16_bf16 v[96:111], v[72:75], v[68:71], 0
  v_exp_f32 v112, v112
  v_exp_f32 v113, v113
  v_exp_f32 v114, v114
  v_exp_f32 v115, v115
  v_exp_f32 v116, v116
  v_exp_f32 v117, v117
  v_mfma_f32_32x32x16_bf16 v[144:159], v[88:91], v[80:83], v[144:159]
  v_exp_f32 v118, v118
  v_exp_f32 v119, v119
  v_cvt_pk_bf16_f32 v80, v112, v113
  v_exp_f32 v120, v120
  v_exp_f32 v121, v121
  v_cvt_pk_bf16_f32 v81, v114, v115
  v_exp_f32 v122, v122
  v_exp_f32 v123, v123
  v_mfma_f32_32x32x16_bf16 v[144:159], v[92:95], v[84:87], v[144:159]
  s_mov_b64 exec, s[58:59]
  ds_read_b128 v[88:91], v193 offset:21504
  ds_read_b128 v[92:95], v193 offset:22016
  s_mov_b64 exec, -1
  v_cvt_pk_bf16_f32 v82, v116, v117
  v_cvt_pk_bf16_f32 v83, v118, v119
  v_exp_f32 v124, v124
  v_exp_f32 v125, v125
  v_cvt_pk_bf16_f32 v84, v120, v121
  v_exp_f32 v126, v126
  v_exp_f32 v127, v127
  v_cvt_pk_bf16_f32 v85, v122, v123
  v_cvt_pk_bf16_f32 v86, v124, v125
  v_cvt_pk_bf16_f32 v87, v126, v127
  s_cmp_eq_u32 s81, 0
  s_cbranch_scc1 CK4
CR4_0:
  s_waitcnt lgkmcnt(0)
  v_exp_f32 v96, v96
  v_exp_f32 v97, v97
  v_exp_f32 v98, v98
  v_exp_f32 v99, v99
  v_exp_f32 v100, v100
  v_exp_f32 v101, v101
  v_mfma_f32_32x32x16_bf16 v[144:159], v[88:91], v[80:83], v[144:159]
  v_exp_f32 v102, v102
  v_exp_f32 v103, v103
  v_cvt_pk_bf16_f32 v80, v96, v97
  v_exp_f32 v104, v104
  v_exp_f32 v105, v105
  v_cvt_pk_bf16_f32 v81, v98, v99
  v_exp_f32 v106, v106
  v_exp_f32 v107, v107
  v_mfma_f32_32x32x16_bf16 v[144:159], v[92:95], v[84:87], v[144:159]
  s_mov_b64 exec, s[58:59]
  ds_read_b128 v[88:91], v193 offset:20480
  ds_read_b128 v[92:95], v193 offset:20992
  s_mov_b64 exec, -1
  v_cvt_pk_bf16_f32 v82, v100, v101
  v_cvt_pk_bf16_f32 v83, v102, v103
  v_exp_f32 v108, v108
  v_exp_f32 v109, v109
  v_cvt_pk_bf16_f32 v84, v104, v105
  v_exp_f32 v110, v110
  v_exp_f32 v111, v111
  v_cvt_pk_bf16_f32 v85, v106, v107
  v_cvt_pk_bf16_f32 v86, v108, v109
  v_cvt_pk_bf16_f32 v87, v110, v111
  s_waitcnt vmcnt(0)
  s_barrier
  s_lshl_b32 s5, s22, 2
  s_lshl_b64 exec, 15, s5
  s_cmp_eq_u32 s19, 0
  s_cbranch_scc1 DU_A14
  buffer_store_dword v253, v198, s[32:35], 0 offen
DU_B14:
  s_mov_b64 exec, -1
  buffer_load_dword v252, v196, s[32:35], 0 offen
  buffer_load_dword v219, v19, s[40:43], s80 offen offset:384
  ds_read_b128 v[76:79], v192 offset:7168
  ds_read_b128 v[72:75], v192 offset:6144
  s_waitcnt lgkmcnt(3)
  v_mfma_f32_32x32x16_bf16 v[144:159], v[88:91], v[80:83], v[144:159]
  s_waitcnt lgkmcnt(2)
  v_mfma_f32_32x32x16_bf16 v[144:159], v[92:95], v[84:87], v[144:159]
  s_waitcnt lgkmcnt(1)
  v_mfma_f32_32x32x16_bf16 v[112:127], v[76:79], v[64:67], v[172:187]
  s_add_u32 m0, s99, s8
  s_add_u32 s78, s78, s9
  buffer_load_dwordx4 v195, s[40:43], s78 offen lds
  s_add_u32 m0, m0, s8
  s_add_u32 s78, s78, s9
  buffer_load_dwordx4 v195, s[40:43], s78 offen lds
  s_add_u32 m0, m0, s8
  s_add_u32 s78, s78, s9
  buffer_load_dwordx4 v195, s[40:43], s78 offen lds
  s_add_u32 m0, m0, s8
  s_add_u32 s78, s78, s9
  buffer_load_dwordx4 v195, s[40:43], s78 offen lds
  s_add_u32 m0, m0, s8
  s_add_u32 s78, s78, s9
  buffer_load_dwordx4 v195, s[40:43], s78 offen lds
  s_add_u32 m0, m0, s8
  s_add_u32 s78, s78, s9
  buffer_load_dwordx4 v195, s[40:43], s78 offen lds
  s_add_u32 m0, m0, s8
  s_add_u32 s78, s78, s9
  buffer_load_dwordx4 v195, s[40:43], s78 offen lds
  s_add_u32 m0, m0, s8
  s_add_u32 s78, s78, s9
  buffer_load_dwordx4 v195, s[40:43], s78 offen lds
  s_add_u32 m0, m0, s8
  s_add_u32 s78, s78, s9
  buffer_load_dwordx4 v195, s[40:43], s78 offen lds
  s_add_u32 m0, m0, s8
  s_add_u32 s78, s78, s9
  buffer_load_dwordx4 v195, s[40:43], s78 offen lds
  s_add_u32 m0, m0, s8
  s_add_u32 s78, s78, s9
  buffer_load_dwordx4 v195, s[40:43], s78 offen lds
  s_add_u32 m0, m0, s8
  s_add_u32 s78, s78, s9
  buffer_load_dwordx4 v195, s[40:43], s78 offen lds
  s_add_u32 m0, m0, s8
  s_add_u32 s78, s78, s9
  buffer_load_dwordx4 v195, s[40:43], s78 offen lds
  s_add_u32 m0, m0, s8
  s_add_u32 s78, s78, s9
  buffer_load_dwordx4 v195, s[40:43], s78 offen lds
  s_add_u32 m0, m0, s8
  s_add_u32 s78, s78, s9
  buffer_load_dwordx4 v195, s[40:43], s78 offen lds
  s_add_u32 m0, m0, s8
  s_add_u32 s78, s78, s9
  buffer_load_dwordx4 v195, s[40:43], s78 offen lds
  s_waitcnt lgkmcnt(0)
  v_mfma_f32_32x32x16_bf16 v[96:111], v[72:75], v[64:67], v[172:187]
  ds_read_b128 v[76:79], v192 offset:5120
  s_nop 8
  v_exp_f32 v112, v112
  v_exp_f32 v113, v113
  v_exp_f32 v114, v114
  v_exp_f32 v115, v115
  v_exp_f32 v116, v116
  v_exp_f32 v117, v117
  v_exp_f32 v118, v118
  v_exp_f32 v119, v119
  v_cvt_pk_bf16_f32 v80, v112, v113
  v_exp_f32 v120, v120
  v_exp_f32 v121, v121
  v_cvt_pk_bf16_f32 v81, v114, v115
  v_exp_f32 v122, v122
  v_exp_f32 v123, v123
  s_mov_b64 exec, s[58:59]
  ds_read_b128 v[88:91], v193 offset:7168
  ds_read_b128 v[92:95], v193 offset:7680
  s_mov_b64 exec, -1
  v_cvt_pk_bf16_f32 v82, v116, v117
  v_cvt_pk_bf16_f32 v83, v118, v119
  v_exp_f32 v124, v124
  v_exp_f32 v125, v125
  v_cvt_pk_bf16_f32 v84, v120, v121
  v_exp_f32 v126, v126
  v_exp_f32 v127, v127
  v_cvt_pk_bf16_f32 v85, v122, v123
  v_cvt_pk_bf16_f32 v86, v124, v125
  v_cvt_pk_bf16_f32 v87, v126, v127
  s_waitcnt lgkmcnt(0)
  v_mfma_f32_32x32x16_bf16 v[112:127], v[76:79], v[64:67], v[172:187]
  ds_read_b128 v[72:75], v192 offset:4096
  v_exp_f32 v96, v96
  v_exp_f32 v97, v97
  v_exp_f32 v98, v98
  v_exp_f32 v99, v99
  v_exp_f32 v100, v100
  v_exp_f32 v101, v101
  v_mfma_f32_32x32x16_bf16 v[128:143], v[88:91], v[80:83], v[128:143]
  v_exp_f32 v102, v102
  v_exp_f32 v103, v103
  v_cvt_pk_bf16_f32 v80, v96, v97
  v_exp_f32 v104, v104
  v_exp_f32 v105, v105
  v_cvt_pk_bf16_f32 v81, v98, v99
  v_exp_f32 v106, v106
  v_exp_f32 v107, v107
  v_mfma_f32_32x32x16_bf16 v[128:143], v[92:95], v[84:87], v[128:143]
  s_mov_b64 exec, s[58:59]
  ds_read_b128 v[88:91], v193 offset:6144
  ds_read_b128 v[92:95], v193 offset:6656
  s_mov_b64 exec, -1
  v_cvt_pk_bf16_f32 v82, v100, v101
  v_cvt_pk_bf16_f32 v83, v102, v103
  v_exp_f32 v108, v108
  v_exp_f32 v109, v109
  v_cvt_pk_bf16_f32 v84, v104, v105
  v_exp_f32 v110, v110
  v_exp_f32 v111, v111
  v_cvt_pk_bf16_f32 v85, v106, v107
  v_cvt_pk_bf16_f32 v86, v108, v109
  v_cvt_pk_bf16_f32 v87, v110, v111
  s_waitcnt vmcnt(0)
  s_lshl_b32 s6, s2, 7
  s_add_u32 s6, s6, 10110976
  buffer_store_dword v253, v218, s[32:35], s6 offen sc1
  s_mov_b64 exec, 3
  s_cmp_eq_u32 s19, 0
  s_cbranch_scc1 DU_A15
  buffer_store_dword v253, v218, s[32:35], s79 offen
DU_B15:
  s_mov_b64 exec, -1
  s_setprio 1
  s_waitcnt lgkmcnt(0)
  v_mfma_f32_32x32x16_bf16 v[96:111], v[72:75], v[64:67], v[172:187]
  ds_read_b128 v[76:79], v192 offset:3072
  v_exp_f32 v112, v112
  v_exp_f32 v113, v113
  v_exp_f32 v114, v114
  v_exp_f32 v115, v115
  v_exp_f32 v116, v116
  v_exp_f32 v117, v117
  v_mfma_f32_32x32x16_bf16 v[128:143], v[88:91], v[80:83], v[128:143]
  v_exp_f32 v118, v118
  v_exp_f32 v119, v119
  v_cvt_pk_bf16_f32 v80, v112, v113
  v_exp_f32 v120, v120
  v_exp_f32 v121, v121
  v_cvt_pk_bf16_f32 v81, v114, v115
  v_exp_f32 v122, v122
  v_exp_f32 v123, v123
  v_mfma_f32_32x32x16_bf16 v[128:143], v[92:95], v[84:87], v[128:143]
  s_mov_b64 exec, s[58:59]
  ds_read_b128 v[88:91], v193 offset:5120
  ds_read_b128 v[92:95], v193 offset:5632
  s_mov_b64 exec, -1
  v_cvt_pk_bf16_f32 v82, v116, v117
  v_cvt_pk_bf16_f32 v83, v118, v119
  v_exp_f32 v124, v124
  v_exp_f32 v125, v125
  v_cvt_pk_bf16_f32 v84, v120, v121
  v_exp_f32 v126, v126
  v_exp_f32 v127, v127
  v_cvt_pk_bf16_f32 v85, v122, v123
  v_cvt_pk_bf16_f32 v86, v124, v125
  v_cvt_pk_bf16_f32 v87, v126, v127
  s_waitcnt lgkmcnt(0)
  v_mfma_f32_32x32x16_bf16 v[112:127], v[76:79], v[64:67], v[202:217]
  ds_read_b128 v[72:75], v192 offset:2048
  v_exp_f32 v96, v96
  v_exp_f32 v97, v97
  v_exp_f32 v98, v98
  v_exp_f32 v99, v99
  v_exp_f32 v100, v100
  v_exp_f32 v101, v101
  v_mfma_f32_32x32x16_bf16 v[128:143], v[88:91], v[80:83], v[128:143]
  v_exp_f32 v102, v102
  v_exp_f32 v103, v103
  v_cvt_pk_bf16_f32 v80, v96, v97
  v_exp_f32 v104, v104
  v_exp_f32 v105, v105
  v_cvt_pk_bf16_f32 v81, v98, v99
  v_exp_f32 v106, v106
  v_exp_f32 v107, v107
  v_mfma_f32_32x32x16_bf16 v[128:143], v[92:95], v[84:87], v[128:143]
  s_mov_b64 exec, s[58:59]
  ds_read_b128 v[88:91], v193 offset:4096
  ds_read_b128 v[92:95], v193 offset:4608
  s_mov_b64 exec, -1
  v_cvt_pk_bf16_f32 v82, v100, v101
  v_cvt_pk_bf16_f32 v83, v102, v103
  v_exp_f32 v108, v108
  v_exp_f32 v109, v109
  v_cvt_pk_bf16_f32 v84, v104, v105
  v_exp_f32 v110, v110
  v_exp_f32 v111, v111
  v_cvt_pk_bf16_f32 v85, v106, v107
  v_cvt_pk_bf16_f32 v86, v108, v109
  v_cvt_pk_bf16_f32 v87, v110, v111
  s_waitcnt lgkmcnt(0)
  v_mfma_f32_32x32x16_bf16 v[96:111], v[72:75], v[64:67], v[202:217]
  ds_read_b128 v[76:79], v192 offset:1024
  v_exp_f32 v112, v112
  v_exp_f32 v113, v113
  v_exp_f32 v114, v114
  v_exp_f32 v115, v115
  v_exp_f32 v116, v116
  v_exp_f32 v117, v117
  v_mfma_f32_32x32x16_bf16 v[128:143], v[88:91], v[80:83], v[128:143]
  v_exp_f32 v118, v118
  v_exp_f32 v119, v119
  v_cvt_pk_bf16_f32 v80, v112, v113
  v_exp_f32 v120, v120
  v_exp_f32 v121, v121
  v_cvt_pk_bf16_f32 v81, v114, v115
  v_exp_f32 v122, v122
  v_exp_f32 v123, v123
  v_mfma_f32_32x32x16_bf16 v[128:143], v[92:95], v[84:87], v[128:143]
  s_mov_b64 exec, s[58:59]
  ds_read_b128 v[88:91], v193 offset:3072
  ds_read_b128 v[92:95], v193 offset:3584
  s_mov_b64 exec, -1
  v_cvt_pk_bf16_f32 v82, v116, v117
  v_cvt_pk_bf16_f32 v83, v118, v119
  v_exp_f32 v124, v124
  v_exp_f32 v125, v125
  v_cvt_pk_bf16_f32 v84, v120, v121
  v_exp_f32 v126, v126
  v_exp_f32 v127, v127
  v_cvt_pk_bf16_f32 v85, v122, v123
  v_cvt_pk_bf16_f32 v86, v124, v125
  v_cvt_pk_bf16_f32 v87, v126, v127
  s_waitcnt lgkmcnt(0)
  v_mfma_f32_32x32x16_bf16 v[112:127], v[76:79], v[64:67], v[202:217]
  ds_read_b128 v[72:75], v192 offset:0
  v_exp_f32 v96, v96
  v_exp_f32 v97, v97
  v_exp_f32 v98, v98
  v_exp_f32 v99, v99
  v_exp_f32 v100, v100
  v_exp_f32 v101, v101
  v_mfma_f32_32x32x16_bf16 v[128:143], v[88:91], v[80:83], v[128:143]
  v_exp_f32 v102, v102
  v_exp_f32 v103, v103
  v_cvt_pk_bf16_f32 v80, v96, v97
  v_exp_f32 v104, v104
  v_exp_f32 v105, v105
  v_cvt_pk_bf16_f32 v81, v98, v99
  v_exp_f32 v106, v106
  v_exp_f32 v107, v107
  v_mfma_f32_32x32x16_bf16 v[128:143], v[92:95], v[84:87], v[128:143]
  s_mov_b64 exec, s[58:59]
  ds_read_b128 v[88:91], v193 offset:2048
  ds_read_b128 v[92:95], v193 offset:2560
  s_mov_b64 exec, -1
  v_cvt_pk_bf16_f32 v82, v100, v101
  v_cvt_pk_bf16_f32 v83, v102, v103
  v_exp_f32 v108, v108
  v_exp_f32 v109, v109
  v_cvt_pk_bf16_f32 v84, v104, v105
  v_exp_f32 v110, v110
  v_exp_f32 v111, v111
  v_cvt_pk_bf16_f32 v85, v106, v107
  v_cvt_pk_bf16_f32 v86, v108, v109
  v_cvt_pk_bf16_f32 v87, v110, v111
  s_waitcnt lgkmcnt(0)
  v_mfma_f32_32x32x16_bf16 v[96:111], v[72:75], v[64:67], v[236:251]
  ds_read_b128 v[76:79], v192 offset:19456
  v_exp_f32 v112, v112
  v_exp_f32 v113, v113
  v_exp_f32 v114, v114
  v_exp_f32 v115, v115
  v_exp_f32 v116, v116
  v_exp_f32 v117, v117
  v_mfma_f32_32x32x16_bf16 v[128:143], v[88:91], v[80:83], v[128:143]
  v_exp_f32 v118, v118
  v_exp_f32 v119, v119
  v_cvt_pk_bf16_f32 v80, v112, v113
  v_exp_f32 v120, v120
  v_exp_f32 v121, v121
  v_cvt_pk_bf16_f32 v81, v114, v115
  v_exp_f32 v122, v122
  v_exp_f32 v123, v123
  v_mfma_f32_32x32x16_bf16 v[128:143], v[92:95], v[84:87], v[128:143]
  s_mov_b64 exec, s[58:59]
  ds_read_b128 v[88:91], v193 offset:1024
  ds_read_b128 v[92:95], v193 offset:1536
  s_mov_b64 exec, -1
  v_cvt_pk_bf16_f32 v82, v116, v117
  v_cvt_pk_bf16_f32 v83, v118, v119
  v_exp_f32 v124, v124
  v_exp_f32 v125, v125
  v_cvt_pk_bf16_f32 v84, v120, v121
  v_exp_f32 v126, v126
  v_exp_f32 v127, v127
  v_cvt_pk_bf16_f32 v85, v122, v123
  v_cvt_pk_bf16_f32 v86, v124, v125
  v_cvt_pk_bf16_f32 v87, v126, v127
  s_waitcnt lgkmcnt(0)
  v_mfma_f32_32x32x16_bf16 v[112:127], v[76:79], v[68:71], v[172:187]
  ds_read_b128 v[72:75], v192 offset:18432
  v_exp_f32 v96, v96
  v_exp_f32 v97, v97
  v_exp_f32 v98, v98
  v_exp_f32 v99, v99
  v_exp_f32 v100, v100
  v_exp_f32 v101, v101
  v_mfma_f32_32x32x16_bf16 v[128:143], v[88:91], v[80:83], v[128:143]
  v_exp_f32 v102, v102
  v_exp_f32 v103, v103
  v_cvt_pk_bf16_f32 v80, v96, v97
  v_exp_f32 v104, v104
  v_exp_f32 v105, v105
  v_cvt_pk_bf16_f32 v81, v98, v99
  v_exp_f32 v106, v106
  v_exp_f32 v107, v107
  v_mfma_f32_32x32x16_bf16 v[128:143], v[92:95], v[84:87], v[128:143]
  s_mov_b64 exec, s[58:59]
  ds_read_b128 v[88:91], v193 offset:0
  ds_read_b128 v[92:95], v193 offset:512
  s_mov_b64 exec, -1
  v_cvt_pk_bf16_f32 v82, v100, v101
  v_cvt_pk_bf16_f32 v83, v102, v103
  v_exp_f32 v108, v108
  v_exp_f32 v109, v109
  v_cvt_pk_bf16_f32 v84, v104, v105
  v_exp_f32 v110, v110
  v_exp_f32 v111, v111
  v_cvt_pk_bf16_f32 v85, v106, v107
  v_cvt_pk_bf16_f32 v86, v108, v109
  v_cvt_pk_bf16_f32 v87, v110, v111
  s_waitcnt lgkmcnt(0)
  v_mfma_f32_32x32x16_bf16 v[96:111], v[72:75], v[68:71], v[172:187]
  ds_read_b128 v[76:79], v192 offset:17408
  v_exp_f32 v112, v112
  v_exp_f32 v113, v113
  v_exp_f32 v114, v114
  v_exp_f32 v115, v115
  v_exp_f32 v116, v116
  v_exp_f32 v117, v117
  v_mfma_f32_32x32x16_bf16 v[128:143], v[88:91], v[80:83], v[128:143]
  v_exp_f32 v118, v118
  v_exp_f32 v119, v119
  v_cvt_pk_bf16_f32 v80, v112, v113
  v_exp_f32 v120, v120
  v_exp_f32 v121, v121
  v_cvt_pk_bf16_f32 v81, v114, v115
  v_exp_f32 v122, v122
  v_exp_f32 v123, v123
  v_mfma_f32_32x32x16_bf16 v[128:143], v[92:95], v[84:87], v[128:143]
  s_mov_b64 exec, s[58:59]
  ds_read_b128 v[88:91], v193 offset:19456
  ds_read_b128 v[92:95], v193 offset:19968
  s_mov_b64 exec, -1
  v_cvt_pk_bf16_f32 v82, v116, v117
  v_cvt_pk_bf16_f32 v83, v118, v119
  v_exp_f32 v124, v124
  v_exp_f32 v125, v125
  v_cvt_pk_bf16_f32 v84, v120, v121
  v_exp_f32 v126, v126
  v_exp_f32 v127, v127
  v_cvt_pk_bf16_f32 v85, v122, v123
  v_cvt_pk_bf16_f32 v86, v124, v125
  v_cvt_pk_bf16_f32 v87, v126, v127
  v_med3_f32 v14, v136, s56, v197
  v_cmp_neq_f32 vcc, v14, v136
  s_cbranch_vccnz FB0
FBDa4:
  v_rcp_f32 v14, v136
  s_nop 0
  v_mul_f32 v128, v128, v14
  v_mul_f32 v129, v129, v14
  v_mul_f32 v130, v130, v14
  v_mul_f32 v131, v131, v14
  v_mul_f32 v132, v132, v14
  v_mul_f32 v133, v133, v14
  v_mul_f32 v134, v134, v14
  v_mul_f32 v135, v135, v14
  v_cvt_pk_bf16_f32 v56, v128, v129
  v_cvt_pk_bf16_f32 v57, v130, v131
  v_cvt_pk_bf16_f32 v58, v132, v133
  v_cvt_pk_bf16_f32 v59, v134, v135
  s_cmp_eq_u32 s19, 0
  s_cbranch_scc1 DU_A16
  buffer_store_dwordx4 v[56:59], v1, s[32:35], s12 offen
DU_B16:
  s_waitcnt lgkmcnt(0)
  v_mfma_f32_32x32x16_bf16 v[112:127], v[76:79], v[68:71], v[172:187]
  ds_read_b128 v[72:75], v192 offset:16384
  v_exp_f32 v96, v96
  v_exp_f32 v97, v97
  v_exp_f32 v98, v98
  v_exp_f32 v99, v99
  v_exp_f32 v100, v100
  v_exp_f32 v101, v101
  v_mfma_f32_32x32x16_bf16 v[144:159], v[88:91], v[80:83], v[144:159]
  v_exp_f32 v102, v102
  v_exp_f32 v103, v103
  v_cvt_pk_bf16_f32 v80, v96, v97
  v_exp_f32 v104, v104
  v_exp_f32 v105, v105
  v_cvt_pk_bf16_f32 v81, v98, v99
  v_exp_f32 v106, v106
  v_exp_f32 v107, v107
  v_mfma_f32_32x32x16_bf16 v[144:159], v[92:95], v[84:87], v[144:159]
  s_mov_b64 exec, s[58:59]
  ds_read_b128 v[88:91], v193 offset:18432
  ds_read_b128 v[92:95], v193 offset:18944
  s_mov_b64 exec, -1
  v_cvt_pk_bf16_f32 v82, v100, v101
  v_cvt_pk_bf16_f32 v83, v102, v103
  v_exp_f32 v108, v108
  v_exp_f32 v109, v109
  v_cvt_pk_bf16_f32 v84, v104, v105
  v_exp_f32 v110, v110
  v_exp_f32 v111, v111
  v_cvt_pk_bf16_f32 v85, v106, v107
  v_cvt_pk_bf16_f32 v86, v108, v109
  v_cvt_pk_bf16_f32 v87, v110, v111
  s_waitcnt lgkmcnt(0)
  v_mfma_f32_32x32x16_bf16 v[96:111], v[72:75], v[68:71], v[172:187]
  ds_read_b128 v[76:79], v192 offset:15360
  v_exp_f32 v112, v112
  v_exp_f32 v113, v113
  v_exp_f32 v114, v114
  v_exp_f32 v115, v115
  v_exp_f32 v116, v116
  v_exp_f32 v117, v117
  v_mfma_f32_32x32x16_bf16 v[144:159], v[88:91], v[80:83], v[144:159]
  v_exp_f32 v118, v118
  v_exp_f32 v119, v119
  v_cvt_pk_bf16_f32 v80, v112, v113
  v_exp_f32 v120, v120
  v_exp_f32 v121, v121
  v_cvt_pk_bf16_f32 v81, v114, v115
  v_exp_f32 v122, v122
  v_exp_f32 v123, v123
  v_mfma_f32_32x32x16_bf16 v[144:159], v[92:95], v[84:87], v[144:159]
  s_mov_b64 exec, s[58:59]
  ds_read_b128 v[88:91], v193 offset:17408
  ds_read_b128 v[92:95], v193 offset:17920
  s_mov_b64 exec, -1
  v_cvt_pk_bf16_f32 v82, v116, v117
  v_cvt_pk_bf16_f32 v83, v118, v119
  v_exp_f32 v124, v124
  v_exp_f32 v125, v125
  v_cvt_pk_bf16_f32 v84, v120, v121
  v_exp_f32 v126, v126
  v_exp_f32 v127, v127
  v_cvt_pk_bf16_f32 v85, v122, v123
  v_cvt_pk_bf16_f32 v86, v124, v125
  v_cvt_pk_bf16_f32 v87, v126, v127
  s_waitcnt lgkmcnt(0)
  v_mfma_f32_32x32x16_bf16 v[112:127], v[76:79], v[68:71], v[236:251]
  v_exp_f32 v96, v96
  v_exp_f32 v97, v97
  v_exp_f32 v98, v98
  v_exp_f32 v99, v99
  v_exp_f32 v100, v100
  v_exp_f32 v101, v101
  v_mfma_f32_32x32x16_bf16 v[144:159], v[88:91], v[80:83], v[144:159]
  v_exp_f32 v102, v102
  v_exp_f32 v103, v103
  v_cvt_pk_bf16_f32 v80, v96, v97
  v_exp_f32 v104, v104
  v_exp_f32 v105, v105
  v_cvt_pk_bf16_f32 v81, v98, v99
  v_exp_f32 v106, v106
  v_exp_f32 v107, v107
  v_mfma_f32_32x32x16_bf16 v[144:159], v[92:95], v[84:87], v[144:159]
  s_mov_b64 exec, s[58:59]
  ds_read_b128 v[88:91], v193 offset:16384
  ds_read_b128 v[92:95], v193 offset:16896
  s_mov_b64 exec, -1
  v_cvt_pk_bf16_f32 v82, v100, v101
  v_cvt_pk_bf16_f32 v83, v102, v103
  v_exp_f32 v108, v108
  v_exp_f32 v109, v109
  v_cvt_pk_bf16_f32 v84, v104, v105
  v_exp_f32 v110, v110
  v_exp_f32 v111, v111
  v_cvt_pk_bf16_f32 v85, v106, v107
  v_cvt_pk_bf16_f32 v86, v108, v109
  v_cvt_pk_bf16_f32 v87, v110, v111
  s_waitcnt lgkmcnt(0)
  v_exp_f32 v112, v112
  v_exp_f32 v113, v113
  v_exp_f32 v114, v114
  v_exp_f32 v115, v115
  v_exp_f32 v116, v116
  v_exp_f32 v117, v117
  v_mfma_f32_32x32x16_bf16 v[144:159], v[88:91], v[80:83], v[144:159]
  v_exp_f32 v118, v118
  v_exp_f32 v119, v119
  v_cvt_pk_bf16_f32 v80, v112, v113
  v_exp_f32 v120, v120
  v_exp_f32 v121, v121
  v_cvt_pk_bf16_f32 v81, v114, v115
  v_exp_f32 v122, v122
  v_exp_f32 v123, v123
  v_mfma_f32_32x32x16_bf16 v[144:159], v[92:95], v[84:87], v[144:159]
  s_mov_b64 exec, s[58:59]
  ds_read_b128 v[88:91], v193 offset:15360
  ds_read_b128 v[92:95], v193 offset:15872
  s_mov_b64 exec, -1
  v_cvt_pk_bf16_f32 v82, v116, v117
  v_cvt_pk_bf16_f32 v83, v118, v119
  v_exp_f32 v124, v124
  v_exp_f32 v125, v125
  v_cvt_pk_bf16_f32 v84, v120, v121
  v_exp_f32 v126, v126
  v_exp_f32 v127, v127
  v_cvt_pk_bf16_f32 v85, v122, v123
  v_cvt_pk_bf16_f32 v86, v124, v125
  v_cvt_pk_bf16_f32 v87, v126, v127
  s_branch H_FIN
PE13:
.p2align 12
PG14:
W5:
  s_branch W2
VH1:
  v_mfma_f32_32x32x16_bf16 v[112:127], v[76:79], v[68:71], v[220:235]
  ds_read_b128 v[72:75], v192 offset:8192
  s_nop 7
  v_exp_f32 v96, v96
  v_exp_f32 v97, v97
  v_exp_f32 v98, v98
  v_exp_f32 v99, v99
  v_exp_f32 v100, v100
  v_exp_f32 v101, v101
  v_exp_f32 v102, v102
  v_exp_f32 v103, v103
  v_cvt_pk_bf16_f32 v80, v96, v97
  v_exp_f32 v104, v104
  v_exp_f32 v105, v105
  v_cvt_pk_bf16_f32 v81, v98, v99
  v_exp_f32 v106, v106
  v_exp_f32 v107, v107
  s_mov_b64 exec, s[58:59]
  ds_read_b128 v[88:91], v193 offset:9216
  ds_read_b128 v[92:95], v193 offset:9728
  s_mov_b64 exec, -1
  v_cvt_pk_bf16_f32 v82, v100, v101
  v_cvt_pk_bf16_f32 v83, v102, v103
  v_exp_f32 v108, v108
  v_exp_f32 v109, v109
  v_cvt_pk_bf16_f32 v84, v104, v105
  v_exp_f32 v110, v110
  v_exp_f32 v111, v111
  v_cvt_pk_bf16_f32 v85, v106, v107
  v_cvt_pk_bf16_f32 v86, v108, v109
  v_cvt_pk_bf16_f32 v87, v110, v111
  s_waitcnt lgkmcnt(0)
  v_mfma_f32_32x32x16_bf16 v[96:111], v[72:75], v[64:67], 0
  ds_read_b128 v[76:79], v192 offset:21504
  v_exp_f32 v112, v112
  v_exp_f32 v113, v113
  v_exp_f32 v114, v114
  v_exp_f32 v115, v115
  v_exp_f32 v116, v116
  v_exp_f32 v117, v117
  v_mfma_f32_32x32x16_bf16 v[128:143], v[88:91], v[80:83], 0
  v_exp_f32 v118, v118
  v_exp_f32 v119, v119
  v_cvt_pk_bf16_f32 v80, v112, v113
  v_exp_f32 v120, v120
  v_exp_f32 v121, v121
  v_cvt_pk_bf16_f32 v81, v114, v115
  v_exp_f32 v122, v122
  v_exp_f32 v123, v123
  v_mfma_f32_32x32x16_bf16 v[128:143], v[92:95], v[84:87], v[128:143]
  s_mov_b64 exec, s[58:59]
  ds_read_b128 v[88:91], v193 offset:22528
  ds_read_b128 v[92:95], v193 offset:23040
  s_mov_b64 exec, -1
  v_cvt_pk_bf16_f32 v82, v116, v117
  v_cvt_pk_bf16_f32 v83, v118, v119
  v_exp_f32 v124, v124
  v_exp_f32 v125, v125
  v_cvt_pk_bf16_f32 v84, v120, v121
  v_exp_f32 v126, v126
  v_exp_f32 v127, v127
  v_cvt_pk_bf16_f32 v85, v122, v123
  v_cvt_pk_bf16_f32 v86, v124, v125
  v_cvt_pk_bf16_f32 v87, v126, v127
  s_cmp_eq_u32 s81, 0
  s_cbranch_scc1 CK2
CR2_1:
  s_waitcnt lgkmcnt(0)
  v_mfma_f32_32x32x16_bf16 v[112:127], v[76:79], v[68:71], 0
  ds_read_b128 v[72:75], v192 offset:20480
  v_exp_f32 v96, v96
  v_exp_f32 v97, v97
  v_exp_f32 v98, v98
  v_exp_f32 v99, v99
  v_exp_f32 v100, v100
  v_exp_f32 v101, v101
  v_mfma_f32_32x32x16_bf16 v[144:159], v[88:91], v[80:83], 0
  v_exp_f32 v102, v102
  v_exp_f32 v103, v103
  v_cvt_pk_bf16_f32 v80, v96, v97
  v_exp_f32 v104, v104
  v_exp_f32 v105, v105
  v_cvt_pk_bf16_f32 v81, v98, v99
  v_exp_f32 v106, v106
  v_exp_f32 v107, v107
  v_mfma_f32_32x32x16_bf16 v[144:159], v[92:95], v[84:87], v[144:159]
  s_mov_b64 exec, s[58:59]
  ds_read_b128 v[88:91], v193 offset:8192
  ds_read_b128 v[92:95], v193 offset:8704
  s_mov_b64 exec, -1
  v_cvt_pk_bf16_f32 v82, v100, v101
  v_cvt_pk_bf16_f32 v83, v102, v103
  v_exp_f32 v108, v108
  v_exp_f32 v109, v109
  v_cvt_pk_bf16_f32 v84, v104, v105
  v_exp_f32 v110, v110
  v_exp_f32 v111, v111
  v_cvt_pk_bf16_f32 v85, v106, v107
  v_cvt_pk_bf16_f32 v86, v108, v109
  v_cvt_pk_bf16_f32 v87, v110, v111
  s_waitcnt lgkmcnt(0)
  v_mfma_f32_32x32x16_bf16 v[96:111], v[72:75], v[68:71], 0
  v_exp_f32 v112, v112
  v_exp_f32 v113, v113
  v_exp_f32 v114, v114
  v_exp_f32 v115, v115
  v_exp_f32 v116, v116
  v_exp_f32 v117, v117
  v_mfma_f32_32x32x16_bf16 v[128:143], v[88:91], v[80:83], v[128:143]
  v_exp_f32 v118, v118
  v_exp_f32 v119, v119
  v_cvt_pk_bf16_f32 v80, v112, v113
  v_exp_f32 v120, v120
  v_exp_f32 v121, v121
  v_cvt_pk_bf16_f32 v81, v114, v115
  v_exp_f32 v122, v122
  v_exp_f32 v123, v123
  v_mfma_f32_32x32x16_bf16 v[128:143], v[92:95], v[84:87], v[128:143]
  s_mov_b64 exec, s[58:59]
  ds_read_b128 v[88:91], v193 offset:21504
  ds_read_b128 v[92:95], v193 offset:22016
  s_mov_b64 exec, -1
  v_cvt_pk_bf16_f32 v82, v116, v117
  v_cvt_pk_bf16_f32 v83, v118, v119
  v_exp_f32 v124, v124
  v_exp_f32 v125, v125
  v_cvt_pk_bf16_f32 v84, v120, v121
  v_exp_f32 v126, v126
  v_exp_f32 v127, v127
  v_cvt_pk_bf16_f32 v85, v122, v123
  v_cvt_pk_bf16_f32 v86, v124, v125
  v_cvt_pk_bf16_f32 v87, v126, v127
  s_cmp_eq_u32 s81, 0
  s_cbranch_scc1 CK4
CR4_1:
  s_waitcnt lgkmcnt(0)
  v_exp_f32 v96, v96
  v_exp_f32 v97, v97
  v_exp_f32 v98, v98
  v_exp_f32 v99, v99
  v_exp_f32 v100, v100
  v_exp_f32 v101, v101
  v_mfma_f32_32x32x16_bf16 v[144:159], v[88:91], v[80:83], v[144:159]
  v_exp_f32 v102, v102
  v_exp_f32 v103, v103
  v_cvt_pk_bf16_f32 v80, v96, v97
  v_exp_f32 v104, v104
  v_exp_f32 v105, v105
  v_cvt_pk_bf16_f32 v81, v98, v99
  v_exp_f32 v106, v106
  v_exp_f32 v107, v107
  v_mfma_f32_32x32x16_bf16 v[144:159], v[92:95], v[84:87], v[144:159]
  s_mov_b64 exec, s[58:59]
  ds_read_b128 v[88:91], v193 offset:20480
  ds_read_b128 v[92:95], v193 offset:20992
  s_mov_b64 exec, -1
  v_cvt_pk_bf16_f32 v82, v100, v101
  v_cvt_pk_bf16_f32 v83, v102, v103
  v_exp_f32 v108, v108
  v_exp_f32 v109, v109
  v_cvt_pk_bf16_f32 v84, v104, v105
  v_exp_f32 v110, v110
  v_exp_f32 v111, v111
  v_cvt_pk_bf16_f32 v85, v106, v107
  v_cvt_pk_bf16_f32 v86, v108, v109
  v_cvt_pk_bf16_f32 v87, v110, v111
  s_waitcnt vmcnt(0)
  s_barrier
  s_lshl_b32 s5, s22, 2
  s_lshl_b64 exec, 15, s5
  s_cmp_eq_u32 s19, 0
  s_cbranch_scc1 DU_A17
  buffer_store_dword v253, v198, s[32:35], 0 offen
DU_B17:
  s_mov_b64 exec, -1
  buffer_load_dword v252, v196, s[32:35], 0 offen
  buffer_load_dword v219, v19, s[40:43], s80 offen offset:384
  ds_read_b128 v[76:79], v192 offset:7168
  ds_read_b128 v[72:75], v192 offset:6144
  s_waitcnt lgkmcnt(3)
  v_mfma_f32_32x32x16_bf16 v[144:159], v[88:91], v[80:83], v[144:159]
  s_waitcnt lgkmcnt(2)
  v_mfma_f32_32x32x16_bf16 v[144:159], v[92:95], v[84:87], v[144:159]
  s_waitcnt lgkmcnt(1)
  v_mfma_f32_32x32x16_bf16 v[112:127], v[76:79], v[64:67], v[172:187]
  s_add_u32 m0, s99, s8
  s_add_u32 s78, s78, s9
  buffer_load_dwordx4 v195, s[40:43], s78 offen lds
  s_add_u32 m0, m0, s8
  s_add_u32 s78, s78, s9
  buffer_load_dwordx4 v195, s[40:43], s78 offen lds
  s_add_u32 m0, m0, s8
  s_add_u32 s78, s78, s9
  buffer_load_dwordx4 v195, s[40:43], s78 offen lds
  s_add_u32 m0, m0, s8
  s_add_u32 s78, s78, s9
  buffer_load_dwordx4 v195, s[40:43], s78 offen lds
  s_add_u32 m0, m0, s8
  s_add_u32 s78, s78, s9
  buffer_load_dwordx4 v195, s[40:43], s78 offen lds
  s_add_u32 m0, m0, s8
  s_add_u32 s78, s78, s9
  buffer_load_dwordx4 v195, s[40:43], s78 offen lds
  s_add_u32 m0, m0, s8
  s_add_u32 s78, s78, s9
  buffer_load_dwordx4 v195, s[40:43], s78 offen lds
  s_add_u32 m0, m0, s8
  s_add_u32 s78, s78, s9
  buffer_load_dwordx4 v195, s[40:43], s78 offen lds
  s_add_u32 m0, m0, s8
  s_add_u32 s78, s78, s9
  buffer_load_dwordx4 v195, s[40:43], s78 offen lds
  s_add_u32 m0, m0, s8
  s_add_u32 s78, s78, s9
  buffer_load_dwordx4 v195, s[40:43], s78 offen lds
  s_add_u32 m0, m0, s8
  s_add_u32 s78, s78, s9
  buffer_load_dwordx4 v195, s[40:43], s78 offen lds
  s_add_u32 m0, m0, s8
  s_add_u32 s78, s78, s9
  buffer_load_dwordx4 v195, s[40:43], s78 offen lds
  s_add_u32 m0, m0, s8
  s_add_u32 s78, s78, s9
  buffer_load_dwordx4 v195, s[40:43], s78 offen lds
  s_add_u32 m0, m0, s8
  s_add_u32 s78, s78, s9
  buffer_load_dwordx4 v195, s[40:43], s78 offen lds
  s_add_u32 m0, m0, s8
  s_add_u32 s78, s78, s9
  buffer_load_dwordx4 v195, s[40:43], s78 offen lds
  s_add_u32 m0, m0, s8
  s_add_u32 s78, s78, s9
  buffer_load_dwordx4 v195, s[40:43], s78 offen lds
  s_waitcnt lgkmcnt(0)
  v_mfma_f32_32x32x16_bf16 v[96:111], v[72:75], v[64:67], v[172:187]
  ds_read_b128 v[76:79], v192 offset:5120
  s_nop 8
  v_exp_f32 v112, v112
  v_exp_f32 v113, v113
  v_exp_f32 v114, v114
  v_exp_f32 v115, v115
  v_exp_f32 v116, v116
  v_exp_f32 v117, v117
  v_exp_f32 v118, v118
  v_exp_f32 v119, v119
  v_cvt_pk_bf16_f32 v80, v112, v113
  v_exp_f32 v120, v120
  v_exp_f32 v121, v121
  v_cvt_pk_bf16_f32 v81, v114, v115
  v_exp_f32 v122, v122
  v_exp_f32 v123, v123
  s_mov_b64 exec, s[58:59]
  ds_read_b128 v[88:91], v193 offset:7168
  ds_read_b128 v[92:95], v193 offset:7680
  s_mov_b64 exec, -1
  v_cvt_pk_bf16_f32 v82, v116, v117
  v_cvt_pk_bf16_f32 v83, v118, v119
  v_exp_f32 v124, v124
  v_exp_f32 v125, v125
  v_cvt_pk_bf16_f32 v84, v120, v121
  v_exp_f32 v126, v126
  v_exp_f32 v127, v127
  v_cvt_pk_bf16_f32 v85, v122, v123
  v_cvt_pk_bf16_f32 v86, v124, v125
  v_cvt_pk_bf16_f32 v87, v126, v127
  s_waitcnt lgkmcnt(0)
  v_mfma_f32_32x32x16_bf16 v[112:127], v[76:79], v[64:67], v[172:187]
  ds_read_b128 v[72:75], v192 offset:4096
  v_exp_f32 v96, v96
  v_exp_f32 v97, v97
  v_exp_f32 v98, v98
  v_exp_f32 v99, v99
  v_exp_f32 v100, v100
  v_exp_f32 v101, v101
  v_mfma_f32_32x32x16_bf16 v[128:143], v[88:91], v[80:83], v[128:143]
  v_exp_f32 v102, v102
  v_exp_f32 v103, v103
  v_cvt_pk_bf16_f32 v80, v96, v97
  v_exp_f32 v104, v104
  v_exp_f32 v105, v105
  v_cvt_pk_bf16_f32 v81, v98, v99
  v_exp_f32 v106, v106
  v_exp_f32 v107, v107
  v_mfma_f32_32x32x16_bf16 v[128:143], v[92:95], v[84:87], v[128:143]
  s_mov_b64 exec, s[58:59]
  ds_read_b128 v[88:91], v193 offset:6144
  ds_read_b128 v[92:95], v193 offset:6656
  s_mov_b64 exec, -1
  v_cvt_pk_bf16_f32 v82, v100, v101
  v_cvt_pk_bf16_f32 v83, v102, v103
  v_exp_f32 v108, v108
  v_exp_f32 v109, v109
  v_cvt_pk_bf16_f32 v84, v104, v105
  v_exp_f32 v110, v110
  v_exp_f32 v111, v111
  v_cvt_pk_bf16_f32 v85, v106, v107
  v_cvt_pk_bf16_f32 v86, v108, v109
  v_cvt_pk_bf16_f32 v87, v110, v111
  s_waitcnt vmcnt(0)
  s_mov_b64 exec, 3
  s_cmp_eq_u32 s19, 0
  s_cbranch_scc1 DU_A18
  buffer_store_dword v253, v218, s[32:35], s79 offen
DU_B18:
  s_mov_b64 exec, -1
  s_setprio 1
  s_waitcnt lgkmcnt(0)
  v_mfma_f32_32x32x16_bf16 v[96:111], v[72:75], v[64:67], v[172:187]
  ds_read_b128 v[76:79], v192 offset:3072
  v_exp_f32 v112, v112
  v_exp_f32 v113, v113
  v_exp_f32 v114, v114
  v_exp_f32 v115, v115
  v_exp_f32 v116, v116
  v_exp_f32 v117, v117
  v_mfma_f32_32x32x16_bf16 v[128:143], v[88:91], v[80:83], v[128:143]
  v_exp_f32 v118, v118
  v_exp_f32 v119, v119
  v_cvt_pk_bf16_f32 v80, v112, v113
  v_exp_f32 v120, v120
  v_exp_f32 v121, v121
  v_cvt_pk_bf16_f32 v81, v114, v115
  v_exp_f32 v122, v122
  v_exp_f32 v123, v123
  v_mfma_f32_32x32x16_bf16 v[128:143], v[92:95], v[84:87], v[128:143]
  s_mov_b64 exec, s[58:59]
  ds_read_b128 v[88:91], v193 offset:5120
  ds_read_b128 v[92:95], v193 offset:5632
  s_mov_b64 exec, -1
  v_cvt_pk_bf16_f32 v82, v116, v117
  v_cvt_pk_bf16_f32 v83, v118, v119
  v_exp_f32 v124, v124
  v_exp_f32 v125, v125
  v_cvt_pk_bf16_f32 v84, v120, v121
  v_exp_f32 v126, v126
  v_exp_f32 v127, v127
  v_cvt_pk_bf16_f32 v85, v122, v123
  v_cvt_pk_bf16_f32 v86, v124, v125
  v_cvt_pk_bf16_f32 v87, v126, v127
  s_waitcnt lgkmcnt(0)
  v_mfma_f32_32x32x16_bf16 v[112:127], v[76:79], v[64:67], v[202:217]
  ds_read_b128 v[72:75], v192 offset:2048
  v_exp_f32 v96, v96
  v_exp_f32 v97, v97
  v_exp_f32 v98, v98
  v_exp_f32 v99, v99
  v_exp_f32 v100, v100
  v_exp_f32 v101, v101
  v_mfma_f32_32x32x16_bf16 v[128:143], v[88:91], v[80:83], v[128:143]
  v_exp_f32 v102, v102
  v_exp_f32 v103, v103
  v_cvt_pk_bf16_f32 v80, v96, v97
  v_exp_f32 v104, v104
  v_exp_f32 v105, v105
  v_cvt_pk_bf16_f32 v81, v98, v99
  v_exp_f32 v106, v106
  v_exp_f32 v107, v107
  v_mfma_f32_32x32x16_bf16 v[128:143], v[92:95], v[84:87], v[128:143]
  s_mov_b64 exec, s[58:59]
  ds_read_b128 v[88:91], v193 offset:4096
  ds_read_b128 v[92:95], v193 offset:4608
  s_mov_b64 exec, -1
  v_cvt_pk_bf16_f32 v82, v100, v101
  v_cvt_pk_bf16_f32 v83, v102, v103
  v_exp_f32 v108, v108
  v_exp_f32 v109, v109
  v_cvt_pk_bf16_f32 v84, v104, v105
  v_exp_f32 v110, v110
  v_exp_f32 v111, v111
  v_cvt_pk_bf16_f32 v85, v106, v107
  v_cvt_pk_bf16_f32 v86, v108, v109
  v_cvt_pk_bf16_f32 v87, v110, v111
  s_waitcnt lgkmcnt(0)
  v_mfma_f32_32x32x16_bf16 v[96:111], v[72:75], v[64:67], v[202:217]
  ds_read_b128 v[76:79], v192 offset:1024
  v_exp_f32 v112, v112
  v_exp_f32 v113, v113
  v_exp_f32 v114, v114
  v_exp_f32 v115, v115
  v_exp_f32 v116, v116
  v_exp_f32 v117, v117
  v_mfma_f32_32x32x16_bf16 v[128:143], v[88:91], v[80:83], v[128:143]
  v_exp_f32 v118, v118
  v_exp_f32 v119, v119
  v_cvt_pk_bf16_f32 v80, v112, v113
  v_exp_f32 v120, v120
  v_exp_f32 v121, v121
  v_cvt_pk_bf16_f32 v81, v114, v115
  v_exp_f32 v122, v122
  v_exp_f32 v123, v123
  v_mfma_f32_32x32x16_bf16 v[128:143], v[92:95], v[84:87], v[128:143]
  s_mov_b64 exec, s[58:59]
  ds_read_b128 v[88:91], v193 offset:3072
  ds_read_b128 v[92:95], v193 offset:3584
  s_mov_b64 exec, -1
  v_cvt_pk_bf16_f32 v82, v116, v117
  v_cvt_pk_bf16_f32 v83, v118, v119
  v_exp_f32 v124, v124
  v_exp_f32 v125, v125
  v_cvt_pk_bf16_f32 v84, v120, v121
  v_exp_f32 v126, v126
  v_exp_f32 v127, v127
  v_cvt_pk_bf16_f32 v85, v122, v123
  v_cvt_pk_bf16_f32 v86, v124, v125
  v_cvt_pk_bf16_f32 v87, v126, v127
  s_waitcnt lgkmcnt(0)
  v_mfma_f32_32x32x16_bf16 v[112:127], v[76:79], v[64:67], v[236:251]
  ds_read_b128 v[72:75], v192 offset:19456
  v_exp_f32 v96, v96
  v_exp_f32 v97, v97
  v_exp_f32 v98, v98
  v_exp_f32 v99, v99
  v_exp_f32 v100, v100
  v_exp_f32 v101, v101
  v_mfma_f32_32x32x16_bf16 v[128:143], v[88:91], v[80:83], v[128:143]
  v_exp_f32 v102, v102
  v_exp_f32 v103, v103
  v_cvt_pk_bf16_f32 v80, v96, v97
  v_exp_f32 v104, v104
  v_exp_f32 v105, v105
  v_cvt_pk_bf16_f32 v81, v98, v99
  v_exp_f32 v106, v106
  v_exp_f32 v107, v107
  v_mfma_f32_32x32x16_bf16 v[128:143], v[92:95], v[84:87], v[128:143]
  s_mov_b64 exec, s[58:59]
  ds_read_b128 v[88:91], v193 offset:2048
  ds_read_b128 v[92:95], v193 offset:2560
  s_mov_b64 exec, -1
  v_cvt_pk_bf16_f32 v82, v100, v101
  v_cvt_pk_bf16_f32 v83, v102, v103
  v_exp_f32 v108, v108
  v_exp_f32 v109, v109
  v_cvt_pk_bf16_f32 v84, v104, v105
  v_exp_f32 v110, v110
  v_exp_f32 v111, v111
  v_cvt_pk_bf16_f32 v85, v106, v107
  v_cvt_pk_bf16_f32 v86, v108, v109
  v_cvt_pk_bf16_f32 v87, v110, v111
  s_waitcnt lgkmcnt(0)
  v_mfma_f32_32x32x16_bf16 v[96:111], v[72:75], v[68:71], v[172:187]
  ds_read_b128 v[76:79], v192 offset:18432
  v_exp_f32 v112, v112
  v_exp_f32 v113, v113
  v_exp_f32 v114, v114
  v_exp_f32 v115, v115
  v_exp_f32 v116, v116
  v_exp_f32 v117, v117
  v_mfma_f32_32x32x16_bf16 v[128:143], v[88:91], v[80:83], v[128:143]
  v_exp_f32 v118, v118
  v_exp_f32 v119, v119
  v_cvt_pk_bf16_f32 v80, v112, v113
  v_exp_f32 v120, v120
  v_exp_f32 v121, v121
  v_cvt_pk_bf16_f32 v81, v114, v115
  v_exp_f32 v122, v122
  v_exp_f32 v123, v123
  v_mfma_f32_32x32x16_bf16 v[128:143], v[92:95], v[84:87], v[128:143]
  s_mov_b64 exec, s[58:59]
  ds_read_b128 v[88:91], v193 offset:1024
  ds_read_b128 v[92:95], v193 offset:1536
  s_mov_b64 exec, -1
  v_cvt_pk_bf16_f32 v82, v116, v117
  v_cvt_pk_bf16_f32 v83, v118, v119
  v_exp_f32 v124, v124
  v_exp_f32 v125, v125
  v_cvt_pk_bf16_f32 v84, v120, v121
  v_exp_f32 v126, v126
  v_exp_f32 v127, v127
  v_cvt_pk_bf16_f32 v85, v122, v123
  v_cvt_pk_bf16_f32 v86, v124, v125
  v_cvt_pk_bf16_f32 v87, v126, v127
  s_waitcnt lgkmcnt(0)
  v_mfma_f32_32x32x16_bf16 v[112:127], v[76:79], v[68:71], v[172:187]
  ds_read_b128 v[72:75], v192 offset:17408
  v_exp_f32 v96, v96
  v_exp_f32 v97, v97
  v_exp_f32 v98, v98
  v_exp_f32 v99, v99
  v_exp_f32 v100, v100
  v_exp_f32 v101, v101
  v_mfma_f32_32x32x16_bf16 v[128:143], v[88:91], v[80:83], v[128:143]
  v_exp_f32 v102, v102
  v_exp_f32 v103, v103
  v_cvt_pk_bf16_f32 v80, v96, v97
  v_exp_f32 v104, v104
  v_exp_f32 v105, v105
  v_cvt_pk_bf16_f32 v81, v98, v99
  v_exp_f32 v106, v106
  v_exp_f32 v107, v107
  v_mfma_f32_32x32x16_bf16 v[128:143], v[92:95], v[84:87], v[128:143]
  s_mov_b64 exec, s[58:59]
  ds_read_b128 v[88:91], v193 offset:19456
  ds_read_b128 v[92:95], v193 offset:19968
  s_mov_b64 exec, -1
  v_cvt_pk_bf16_f32 v82, v100, v101
  v_cvt_pk_bf16_f32 v83, v102, v103
  v_exp_f32 v108, v108
  v_exp_f32 v109, v109
  v_cvt_pk_bf16_f32 v84, v104, v105
  v_exp_f32 v110, v110
  v_exp_f32 v111, v111
  v_cvt_pk_bf16_f32 v85, v106, v107
  v_cvt_pk_bf16_f32 v86, v108, v109
  v_cvt_pk_bf16_f32 v87, v110, v111
  v_med3_f32 v14, v136, s56, v197
  v_cmp_neq_f32 vcc, v14, v136
  s_cbranch_vccnz FB0
FBDa5:
  v_rcp_f32 v14, v136
  s_nop 0
  v_mul_f32 v128, v128, v14
  v_mul_f32 v129, v129, v14
  v_mul_f32 v130, v130, v14
  v_mul_f32 v131, v131, v14
  v_mul_f32 v132, v132, v14
  v_mul_f32 v133, v133, v14
  v_mul_f32 v134, v134, v14
  v_mul_f32 v135, v135, v14
  v_cvt_pk_bf16_f32 v56, v128, v129
  v_cvt_pk_bf16_f32 v57, v130, v131
  v_cvt_pk_bf16_f32 v58, v132, v133
  v_cvt_pk_bf16_f32 v59, v134, v135
  s_cmp_eq_u32 s19, 0
  s_cbranch_scc1 DU_A19
  buffer_store_dwordx4 v[56:59], v1, s[32:35], s12 offen
DU_B19:
  s_waitcnt lgkmcnt(0)
  v_mfma_f32_32x32x16_bf16 v[96:111], v[72:75], v[68:71], v[172:187]
  ds_read_b128 v[76:79], v192 offset:16384
  v_exp_f32 v112, v112
  v_exp_f32 v113, v113
  v_exp_f32 v114, v114
  v_exp_f32 v115, v115
  v_exp_f32 v116, v116
  v_exp_f32 v117, v117
  v_mfma_f32_32x32x16_bf16 v[144:159], v[88:91], v[80:83], v[144:159]
  v_exp_f32 v118, v118
  v_exp_f32 v119, v119
  v_cvt_pk_bf16_f32 v80, v112, v113
  v_exp_f32 v120, v120
  v_exp_f32 v121, v121
  v_cvt_pk_bf16_f32 v81, v114, v115
  v_exp_f32 v122, v122
  v_exp_f32 v123, v123
  v_mfma_f32_32x32x16_bf16 v[144:159], v[92:95], v[84:87], v[144:159]
  s_mov_b64 exec, s[58:59]
  ds_read_b128 v[88:91], v193 offset:18432
  ds_read_b128 v[92:95], v193 offset:18944
  s_mov_b64 exec, -1
  v_cvt_pk_bf16_f32 v82, v116, v117
  v_cvt_pk_bf16_f32 v83, v118, v119
  v_exp_f32 v124, v124
  v_exp_f32 v125, v125
  v_cvt_pk_bf16_f32 v84, v120, v121
  v_exp_f32 v126, v126
  v_exp_f32 v127, v127
  v_cvt_pk_bf16_f32 v85, v122, v123
  v_cvt_pk_bf16_f32 v86, v124, v125
  v_cvt_pk_bf16_f32 v87, v126, v127
  s_waitcnt lgkmcnt(0)
  v_mfma_f32_32x32x16_bf16 v[112:127], v[76:79], v[68:71], v[172:187]
  ds_read_b128 v[72:75], v192 offset:15360
  v_exp_f32 v96, v96
  v_exp_f32 v97, v97
  v_exp_f32 v98, v98
  v_exp_f32 v99, v99
  v_exp_f32 v100, v100
  v_exp_f32 v101, v101
  v_mfma_f32_32x32x16_bf16 v[144:159], v[88:91], v[80:83], v[144:159]
  v_exp_f32 v102, v102
  v_exp_f32 v103, v103
  v_cvt_pk_bf16_f32 v80, v96, v97
  v_exp_f32 v104, v104
  v_exp_f32 v105, v105
  v_cvt_pk_bf16_f32 v81, v98, v99
  v_exp_f32 v106, v106
  v_exp_f32 v107, v107
  v_mfma_f32_32x32x16_bf16 v[144:159], v[92:95], v[84:87], v[144:159]
  s_mov_b64 exec, s[58:59]
  ds_read_b128 v[88:91], v193 offset:17408
  ds_read_b128 v[92:95], v193 offset:17920
  s_mov_b64 exec, -1
  v_cvt_pk_bf16_f32 v82, v100, v101
  v_cvt_pk_bf16_f32 v83, v102, v103
  v_exp_f32 v108, v108
  v_exp_f32 v109, v109
  v_cvt_pk_bf16_f32 v84, v104, v105
  v_exp_f32 v110, v110
  v_exp_f32 v111, v111
  v_cvt_pk_bf16_f32 v85, v106, v107
  v_cvt_pk_bf16_f32 v86, v108, v109
  v_cvt_pk_bf16_f32 v87, v110, v111
  s_waitcnt lgkmcnt(0)
  v_mfma_f32_32x32x16_bf16 v[96:111], v[72:75], v[68:71], v[202:217]
  ds_read_b128 v[76:79], v192 offset:14336
  v_exp_f32 v112, v112
  v_exp_f32 v113, v113
  v_exp_f32 v114, v114
  v_exp_f32 v115, v115
  v_exp_f32 v116, v116
  v_exp_f32 v117, v117
  v_mfma_f32_32x32x16_bf16 v[144:159], v[88:91], v[80:83], v[144:159]
  v_exp_f32 v118, v118
  v_exp_f32 v119, v119
  v_cvt_pk_bf16_f32 v80, v112, v113
  v_exp_f32 v120, v120
  v_exp_f32 v121, v121
  v_cvt_pk_bf16_f32 v81, v114, v115
  v_exp_f32 v122, v122
  v_exp_f32 v123, v123
  v_mfma_f32_32x32x16_bf16 v[144:159], v[92:95], v[84:87], v[144:159]
  s_mov_b64 exec, s[58:59]
  ds_read_b128 v[88:91], v193 offset:16384
  ds_read_b128 v[92:95], v193 offset:16896
  s_mov_b64 exec, -1
  v_cvt_pk_bf16_f32 v82, v116, v117
  v_cvt_pk_bf16_f32 v83, v118, v119
  v_exp_f32 v124, v124
  v_exp_f32 v125, v125
  v_cvt_pk_bf16_f32 v84, v120, v121
  v_exp_f32 v126, v126
  v_exp_f32 v127, v127
  v_cvt_pk_bf16_f32 v85, v122, v123
  v_cvt_pk_bf16_f32 v86, v124, v125
  v_cvt_pk_bf16_f32 v87, v126, v127
  s_waitcnt lgkmcnt(0)
  v_mfma_f32_32x32x16_bf16 v[112:127], v[76:79], v[68:71], v[236:251]
  v_exp_f32 v96, v96
  v_exp_f32 v97, v97
  v_exp_f32 v98, v98
  v_exp_f32 v99, v99
  v_exp_f32 v100, v100
  v_exp_f32 v101, v101
  v_mfma_f32_32x32x16_bf16 v[144:159], v[88:91], v[80:83], v[144:159]
  v_exp_f32 v102, v102
  v_exp_f32 v103, v103
  v_cvt_pk_bf16_f32 v80, v96, v97
  v_exp_f32 v104, v104
  v_exp_f32 v105, v105
  v_cvt_pk_bf16_f32 v81, v98, v99
  v_exp_f32 v106, v106
  v_exp_f32 v107, v107
  v_mfma_f32_32x32x16_bf16 v[144:159], v[92:95], v[84:87], v[144:159]
  s_mov_b64 exec, s[58:59]
  ds_read_b128 v[88:91], v193 offset:15360
  ds_read_b128 v[92:95], v193 offset:15872
  s_mov_b64 exec, -1
  v_cvt_pk_bf16_f32 v82, v100, v101
  v_cvt_pk_bf16_f32 v83, v102, v103
  v_exp_f32 v108, v108
  v_exp_f32 v109, v109
  v_cvt_pk_bf16_f32 v84, v104, v105
  v_exp_f32 v110, v110
  v_exp_f32 v111, v111
  v_cvt_pk_bf16_f32 v85, v106, v107
  v_cvt_pk_bf16_f32 v86, v108, v109
  v_cvt_pk_bf16_f32 v87, v110, v111
  s_waitcnt lgkmcnt(0)
  v_exp_f32 v112, v112
  v_exp_f32 v113, v113
  v_exp_f32 v114, v114
  v_exp_f32 v115, v115
  v_exp_f32 v116, v116
  v_exp_f32 v117, v117
  v_mfma_f32_32x32x16_bf16 v[144:159], v[88:91], v[80:83], v[144:159]
  v_exp_f32 v118, v118
  v_exp_f32 v119, v119
  v_cvt_pk_bf16_f32 v80, v112, v113
  v_exp_f32 v120, v120
  v_exp_f32 v121, v121
  v_cvt_pk_bf16_f32 v81, v114, v115
  v_exp_f32 v122, v122
  v_exp_f32 v123, v123
  v_mfma_f32_32x32x16_bf16 v[144:159], v[92:95], v[84:87], v[144:159]
  s_mov_b64 exec, s[58:59]
  ds_read_b128 v[88:91], v193 offset:14336
  ds_read_b128 v[92:95], v193 offset:14848
  s_mov_b64 exec, -1
  v_cvt_pk_bf16_f32 v82, v116, v117
  v_cvt_pk_bf16_f32 v83, v118, v119
  v_exp_f32 v124, v124
  v_exp_f32 v125, v125
  v_cvt_pk_bf16_f32 v84, v120, v121
  v_exp_f32 v126, v126
  v_exp_f32 v127, v127
  v_cvt_pk_bf16_f32 v85, v122, v123
  v_cvt_pk_bf16_f32 v86, v124, v125
  v_cvt_pk_bf16_f32 v87, v126, v127
  s_branch H_FIN
PE14:
.p2align 12
PG15:
W6:
  s_branch W1
VH2:
  v_mfma_f32_32x32x16_bf16 v[112:127], v[76:79], v[68:71], v[220:235]
  ds_read_b128 v[72:75], v192 offset:9216
  s_nop 7
  v_exp_f32 v96, v96
  v_exp_f32 v97, v97
  v_exp_f32 v98, v98
  v_exp_f32 v99, v99
  v_exp_f32 v100, v100
  v_exp_f32 v101, v101
  v_exp_f32 v102, v102
  v_exp_f32 v103, v103
  v_cvt_pk_bf16_f32 v80, v96, v97
  v_exp_f32 v104, v104
  v_exp_f32 v105, v105
  v_cvt_pk_bf16_f32 v81, v98, v99
  v_exp_f32 v106, v106
  v_exp_f32 v107, v107
  s_mov_b64 exec, s[58:59]
  ds_read_b128 v[88:91], v193 offset:10240
  ds_read_b128 v[92:95], v193 offset:10752
  s_mov_b64 exec, -1
  v_cvt_pk_bf16_f32 v82, v100, v101
  v_cvt_pk_bf16_f32 v83, v102, v103
  v_exp_f32 v108, v108
  v_exp_f32 v109, v109
  v_cvt_pk_bf16_f32 v84, v104, v105
  v_exp_f32 v110, v110
  v_exp_f32 v111, v111
  v_cvt_pk_bf16_f32 v85, v106, v107
  v_cvt_pk_bf16_f32 v86, v108, v109
  v_cvt_pk_bf16_f32 v87, v110, v111
  s_waitcnt lgkmcnt(0)
  v_mfma_f32_32x32x16_bf16 v[96:111], v[72:75], v[64:67], 0
  ds_read_b128 v[76:79], v192 offset:8192
  v_exp_f32 v112, v112
  v_exp_f32 v113, v113
  v_exp_f32 v114, v114
  v_exp_f32 v115, v115
  v_exp_f32 v116, v116
  v_exp_f32 v117, v117
  v_mfma_f32_32x32x16_bf16 v[128:143], v[88:91], v[80:83], 0
  v_exp_f32 v118, v118
  v_exp_f32 v119, v119
  v_cvt_pk_bf16_f32 v80, v112, v113
  v_exp_f32 v120, v120
  v_exp_f32 v121, v121
  v_cvt_pk_bf16_f32 v81, v114, v115
  v_exp_f32 v122, v122
  v_exp_f32 v123, v123
  v_mfma_f32_32x32x16_bf16 v[128:143], v[92:95], v[84:87], v[128:143]
  s_mov_b64 exec, s[58:59]
  ds_read_b128 v[88:91], v193 offset:21504
  ds_read_b128 v[92:95], v193 offset:22016
  s_mov_b64 exec, -1
  v_cvt_pk_bf16_f32 v82, v116, v117
  v_cvt_pk_bf16_f32 v83, v118, v119
  v_exp_f32 v124, v124
  v_exp_f32 v125, v125
  v_cvt_pk_bf16_f32 v84, v120, v121
  v_exp_f32 v126, v126
  v_exp_f32 v127, v127
  v_cvt_pk_bf16_f32 v85, v122, v123
  v_cvt_pk_bf16_f32 v86, v124, v125
  v_cvt_pk_bf16_f32 v87, v126, v127
  s_cmp_eq_u32 s81, 0
  s_cbranch_scc1 CK2
CR2_2:
  s_waitcnt lgkmcnt(0)
  v_mfma_f32_32x32x16_bf16 v[112:127], v[76:79], v[64:67], 0
  ds_read_b128 v[72:75], v192 offset:20480
  v_exp_f32 v96, v96
  v_exp_f32 v97, v97
  v_exp_f32 v98, v98
  v_exp_f32 v99, v99
  v_exp_f32 v100, v100
  v_exp_f32 v101, v101
  v_mfma_f32_32x32x16_bf16 v[144:159], v[88:91], v[80:83], 0
  v_exp_f32 v102, v102
  v_exp_f32 v103, v103
  v_cvt_pk_bf16_f32 v80, v96, v97
  v_exp_f32 v104, v104
  v_exp_f32 v105, v105
  v_cvt_pk_bf16_f32 v81, v98, v99
  v_exp_f32 v106, v106
  v_exp_f32 v107, v107
  v_mfma_f32_32x32x16_bf16 v[144:159], v[92:95], v[84:87], v[144:159]
  s_mov_b64 exec, s[58:59]
  ds_read_b128 v[88:91], v193 offset:9216
  ds_read_b128 v[92:95], v193 offset:9728
  s_mov_b64 exec, -1
  v_cvt_pk_bf16_f32 v82, v100, v101
  v_cvt_pk_bf16_f32 v83, v102, v103
  v_exp_f32 v108, v108
  v_exp_f32 v109, v109
  v_cvt_pk_bf16_f32 v84, v104, v105
  v_exp_f32 v110, v110
  v_exp_f32 v111, v111
  v_cvt_pk_bf16_f32 v85, v106, v107
  v_cvt_pk_bf16_f32 v86, v108, v109
  v_cvt_pk_bf16_f32 v87, v110, v111
  s_waitcnt lgkmcnt(0)
  v_mfma_f32_32x32x16_bf16 v[96:111], v[72:75], v[68:71], 0
  v_exp_f32 v112, v112
  v_exp_f32 v113, v113
  v_exp_f32 v114, v114
  v_exp_f32 v115, v115
  v_exp_f32 v116, v116
  v_exp_f32 v117, v117
  v_mfma_f32_32x32x16_bf16 v[128:143], v[88:91], v[80:83], v[128:143]
  v_exp_f32 v118, v118
  v_exp_f32 v119, v119
  v_cvt_pk_bf16_f32 v80, v112, v113
  v_exp_f32 v120, v120
  v_exp_f32 v121, v121
  v_cvt_pk_bf16_f32 v81, v114, v115
  v_exp_f32 v122, v122
  v_exp_f32 v123, v123
  v_mfma_f32_32x32x16_bf16 v[128:143], v[92:95], v[84:87], v[128:143]
  s_mov_b64 exec, s[58:59]
  ds_read_b128 v[88:91], v193 offset:8192
  ds_read_b128 v[92:95], v193 offset:8704
  s_mov_b64 exec, -1
  v_cvt_pk_bf16_f32 v82, v116, v117
  v_cvt_pk_bf16_f32 v83, v118, v119
  v_exp_f32 v124, v124
  v_exp_f32 v125, v125
  v_cvt_pk_bf16_f32 v84, v120, v121
  v_exp_f32 v126, v126
  v_exp_f32 v127, v127
  v_cvt_pk_bf16_f32 v85, v122, v123
  v_cvt_pk_bf16_f32 v86, v124, v125
  v_cvt_pk_bf16_f32 v87, v126, v127
  s_cmp_eq_u32 s81, 0
  s_cbranch_scc1 CK4
CR4_2:
  s_waitcnt lgkmcnt(0)
  v_exp_f32 v96, v96
  v_exp_f32 v97, v97
  v_exp_f32 v98, v98
  v_exp_f32 v99, v99
  v_exp_f32 v100, v100
  v_exp_f32 v101, v101
  v_mfma_f32_32x32x16_bf16 v[128:143], v[88:91], v[80:83], v[128:143]
  v_exp_f32 v102, v102
  v_exp_f32 v103, v103
  v_cvt_pk_bf16_f32 v80, v96, v97
  v_exp_f32 v104, v104
  v_exp_f32 v105, v105
  v_cvt_pk_bf16_f32 v81, v98, v99
  v_exp_f32 v106, v106
  v_exp_f32 v107, v107
  v_mfma_f32_32x32x16_bf16 v[128:143], v[92:95], v[84:87], v[128:143]
  s_mov_b64 exec, s[58:59]
  ds_read_b128 v[88:91], v193 offset:20480
  ds_read_b128 v[92:95], v193 offset:20992
  s_mov_b64 exec, -1
  v_cvt_pk_bf16_f32 v82, v100, v101
  v_cvt_pk_bf16_f32 v83, v102, v103
  v_exp_f32 v108, v108
  v_exp_f32 v109, v109
  v_cvt_pk_bf16_f32 v84, v104, v105
  v_exp_f32 v110, v110
  v_exp_f32 v111, v111
  v_cvt_pk_bf16_f32 v85, v106, v107
  v_cvt_pk_bf16_f32 v86, v108, v109
  v_cvt_pk_bf16_f32 v87, v110, v111
  s_waitcnt vmcnt(0)
  s_barrier
  s_lshl_b32 s5, s22, 2
  s_lshl_b64 exec, 15, s5
  s_cmp_eq_u32 s19, 0
  s_cbranch_scc1 DU_A20
  buffer_store_dword v253, v198, s[32:35], 0 offen
DU_B20:
  s_mov_b64 exec, -1
  buffer_load_dword v252, v196, s[32:35], 0 offen
  buffer_load_dword v219, v19, s[40:43], s80 offen offset:384
  ds_read_b128 v[76:79], v192 offset:7168
  ds_read_b128 v[72:75], v192 offset:6144
  s_waitcnt lgkmcnt(3)
  v_mfma_f32_32x32x16_bf16 v[144:159], v[88:91], v[80:83], v[144:159]
  s_waitcnt lgkmcnt(2)
  v_mfma_f32_32x32x16_bf16 v[144:159], v[92:95], v[84:87], v[144:159]
  s_waitcnt lgkmcnt(1)
  v_mfma_f32_32x32x16_bf16 v[112:127], v[76:79], v[64:67], v[172:187]
  s_add_u32 m0, s99, s8
  s_add_u32 s78, s78, s9
  buffer_load_dwordx4 v195, s[40:43], s78 offen lds
  s_add_u32 m0, m0, s8
  s_add_u32 s78, s78, s9
  buffer_load_dwordx4 v195, s[40:43], s78 offen lds
  s_add_u32 m0, m0, s8
  s_add_u32 s78, s78, s9
  buffer_load_dwordx4 v195, s[40:43], s78 offen lds
  s_add_u32 m0, m0, s8
  s_add_u32 s78, s78, s9
  buffer_load_dwordx4 v195, s[40:43], s78 offen lds
  s_add_u32 m0, m0, s8
  s_add_u32 s78, s78, s9
  buffer_load_dwordx4 v195, s[40:43], s78 offen lds
  s_add_u32 m0, m0, s8
  s_add_u32 s78, s78, s9
  buffer_load_dwordx4 v195, s[40:43], s78 offen lds
  s_add_u32 m0, m0, s8
  s_add_u32 s78, s78, s9
  buffer_load_dwordx4 v195, s[40:43], s78 offen lds
  s_add_u32 m0, m0, s8
  s_add_u32 s78, s78, s9
  buffer_load_dwordx4 v195, s[40:43], s78 offen lds
  s_add_u32 m0, m0, s8
  s_add_u32 s78, s78, s9
  buffer_load_dwordx4 v195, s[40:43], s78 offen lds
  s_add_u32 m0, m0, s8
  s_add_u32 s78, s78, s9
  buffer_load_dwordx4 v195, s[40:43], s78 offen lds
  s_add_u32 m0, m0, s8
  s_add_u32 s78, s78, s9
  buffer_load_dwordx4 v195, s[40:43], s78 offen lds
  s_add_u32 m0, m0, s8
  s_add_u32 s78, s78, s9
  buffer_load_dwordx4 v195, s[40:43], s78 offen lds
  s_add_u32 m0, m0, s8
  s_add_u32 s78, s78, s9
  buffer_load_dwordx4 v195, s[40:43], s78 offen lds
  s_add_u32 m0, m0, s8
  s_add_u32 s78, s78, s9
  buffer_load_dwordx4 v195, s[40:43], s78 offen lds
  s_add_u32 m0, m0, s8
  s_add_u32 s78, s78, s9
  buffer_load_dwordx4 v195, s[40:43], s78 offen lds
  s_add_u32 m0, m0, s8
  s_add_u32 s78, s78, s9
  buffer_load_dwordx4 v195, s[40:43], s78 offen lds
  s_waitcnt lgkmcnt(0)
  v_mfma_f32_32x32x16_bf16 v[96:111], v[72:75], v[64:67], v[172:187]
  ds_read_b128 v[76:79], v192 offset:5120
  s_nop 8
  v_exp_f32 v112, v112
  v_exp_f32 v113, v113
  v_exp_f32 v114, v114
  v_exp_f32 v115, v115
  v_exp_f32 v116, v116
  v_exp_f32 v117, v117
  v_exp_f32 v118, v118
  v_exp_f32 v119, v119
  v_cvt_pk_bf16_f32 v80, v112, v113
  v_exp_f32 v120, v120
  v_exp_f32 v121, v121
  v_cvt_pk_bf16_f32 v81, v114, v115
  v_exp_f32 v122, v122
  v_exp_f32 v123, v123
  s_mov_b64 exec, s[58:59]
  ds_read_b128 v[88:91], v193 offset:7168
  ds_read_b128 v[92:95], v193 offset:7680
  s_mov_b64 exec, -1
  v_cvt_pk_bf16_f32 v82, v116, v117
  v_cvt_pk_bf16_f32 v83, v118, v119
  v_exp_f32 v124, v124
  v_exp_f32 v125, v125
  v_cvt_pk_bf16_f32 v84, v120, v121
  v_exp_f32 v126, v126
  v_exp_f32 v127, v127
  v_cvt_pk_bf16_f32 v85, v122, v123
  v_cvt_pk_bf16_f32 v86, v124, v125
  v_cvt_pk_bf16_f32 v87, v126, v127
  s_waitcnt lgkmcnt(0)
  v_mfma_f32_32x32x16_bf16 v[112:127], v[76:79], v[64:67], v[172:187]
  ds_read_b128 v[72:75], v192 offset:4096
  v_exp_f32 v96, v96
  v_exp_f32 v97, v97
  v_exp_f32 v98, v98
  v_exp_f32 v99, v99
  v_exp_f32 v100, v100
  v_exp_f32 v101, v101
  v_mfma_f32_32x32x16_bf16 v[128:143], v[88:91], v[80:83], v[128:143]
  v_exp_f32 v102, v102
  v_exp_f32 v103, v103
  v_cvt_pk_bf16_f32 v80, v96, v97
  v_exp_f32 v104, v104
  v_exp_f32 v105, v105
  v_cvt_pk_bf16_f32 v81, v98, v99
  v_exp_f32 v106, v106
  v_exp_f32 v107, v107
  v_mfma_f32_32x32x16_bf16 v[128:143], v[92:95], v[84:87], v[128:143]
  s_mov_b64 exec, s[58:59]
  ds_read_b128 v[88:91], v193 offset:6144
  ds_read_b128 v[92:95], v193 offset:6656
  s_mov_b64 exec, -1
  v_cvt_pk_bf16_f32 v82, v100, v101
  v_cvt_pk_bf16_f32 v83, v102, v103
  v_exp_f32 v108, v108
  v_exp_f32 v109, v109
  v_cvt_pk_bf16_f32 v84, v104, v105
  v_exp_f32 v110, v110
  v_exp_f32 v111, v111
  v_cvt_pk_bf16_f32 v85, v106, v107
  v_cvt_pk_bf16_f32 v86, v108, v109
  v_cvt_pk_bf16_f32 v87, v110, v111
  s_waitcnt vmcnt(0)
  s_mov_b64 exec, 3
  s_cmp_eq_u32 s19, 0
  s_cbranch_scc1 DU_A21
  buffer_store_dword v253, v218, s[32:35], s79 offen
DU_B21:
  s_mov_b64 exec, -1
  s_setprio 1
  s_waitcnt lgkmcnt(0)
  v_mfma_f32_32x32x16_bf16 v[96:111], v[72:75], v[64:67], v[172:187]
  ds_read_b128 v[76:79], v192 offset:3072
  v_exp_f32 v112, v112
  v_exp_f32 v113, v113
  v_exp_f32 v114, v114
  v_exp_f32 v115, v115
  v_exp_f32 v116, v116
  v_exp_f32 v117, v117
  v_mfma_f32_32x32x16_bf16 v[128:143], v[88:91], v[80:83], v[128:143]
  v_exp_f32 v118, v118
  v_exp_f32 v119, v119
  v_cvt_pk_bf16_f32 v80, v112, v113
  v_exp_f32 v120, v120
  v_exp_f32 v121, v121
  v_cvt_pk_bf16_f32 v81, v114, v115
  v_exp_f32 v122, v122
  v_exp_f32 v123, v123
  v_mfma_f32_32x32x16_bf16 v[128:143], v[92:95], v[84:87], v[128:143]
  s_mov_b64 exec, s[58:59]
  ds_read_b128 v[88:91], v193 offset:5120
  ds_read_b128 v[92:95], v193 offset:5632
  s_mov_b64 exec, -1
  v_cvt_pk_bf16_f32 v82, v116, v117
  v_cvt_pk_bf16_f32 v83, v118, v119
  v_exp_f32 v124, v124
  v_exp_f32 v125, v125
  v_cvt_pk_bf16_f32 v84, v120, v121
  v_exp_f32 v126, v126
  v_exp_f32 v127, v127
  v_cvt_pk_bf16_f32 v85, v122, v123
  v_cvt_pk_bf16_f32 v86, v124, v125
  v_cvt_pk_bf16_f32 v87, v126, v127
  s_waitcnt lgkmcnt(0)
  v_mfma_f32_32x32x16_bf16 v[112:127], v[76:79], v[64:67], v[202:217]
  ds_read_b128 v[72:75], v192 offset:2048
  v_exp_f32 v96, v96
  v_exp_f32 v97, v97
  v_exp_f32 v98, v98
  v_exp_f32 v99, v99
  v_exp_f32 v100, v100
  v_exp_f32 v101, v101
  v_mfma_f32_32x32x16_bf16 v[128:143], v[88:91], v[80:83], v[128:143]
  v_exp_f32 v102, v102
  v_exp_f32 v103, v103
  v_cvt_pk_bf16_f32 v80, v96, v97
  v_exp_f32 v104, v104
  v_exp_f32 v105, v105
  v_cvt_pk_bf16_f32 v81, v98, v99
  v_exp_f32 v106, v106
  v_exp_f32 v107, v107
  v_mfma_f32_32x32x16_bf16 v[128:143], v[92:95], v[84:87], v[128:143]
  s_mov_b64 exec, s[58:59]
  ds_read_b128 v[88:91], v193 offset:4096
  ds_read_b128 v[92:95], v193 offset:4608
  s_mov_b64 exec, -1
  v_cvt_pk_bf16_f32 v82, v100, v101
  v_cvt_pk_bf16_f32 v83, v102, v103
  v_exp_f32 v108, v108
  v_exp_f32 v109, v109
  v_cvt_pk_bf16_f32 v84, v104, v105
  v_exp_f32 v110, v110
  v_exp_f32 v111, v111
  v_cvt_pk_bf16_f32 v85, v106, v107
  v_cvt_pk_bf16_f32 v86, v108, v109
  v_cvt_pk_bf16_f32 v87, v110, v111
  s_waitcnt lgkmcnt(0)
  v_mfma_f32_32x32x16_bf16 v[96:111], v[72:75], v[64:67], v[236:251]
  ds_read_b128 v[76:79], v192 offset:19456
  v_exp_f32 v112, v112
  v_exp_f32 v113, v113
  v_exp_f32 v114, v114
  v_exp_f32 v115, v115
  v_exp_f32 v116, v116
  v_exp_f32 v117, v117
  v_mfma_f32_32x32x16_bf16 v[128:143], v[88:91], v[80:83], v[128:143]
  v_exp_f32 v118, v118
  v_exp_f32 v119, v119
  v_cvt_pk_bf16_f32 v80, v112, v113
  v_exp_f32 v120, v120
  v_exp_f32 v121, v121
  v_cvt_pk_bf16_f32 v81, v114, v115
  v_exp_f32 v122, v122
  v_exp_f32 v123, v123
  v_mfma_f32_32x32x16_bf16 v[128:143], v[92:95], v[84:87], v[128:143]
  s_mov_b64 exec, s[58:59]
  ds_read_b128 v[88:91], v193 offset:3072
  ds_read_b128 v[92:95], v193 offset:3584
  s_mov_b64 exec, -1
  v_cvt_pk_bf16_f32 v82, v116, v117
  v_cvt_pk_bf16_f32 v83, v118, v119
  v_exp_f32 v124, v124
  v_exp_f32 v125, v125
  v_cvt_pk_bf16_f32 v84, v120, v121
  v_exp_f32 v126, v126
  v_exp_f32 v127, v127
  v_cvt_pk_bf16_f32 v85, v122, v123
  v_cvt_pk_bf16_f32 v86, v124, v125
  v_cvt_pk_bf16_f32 v87, v126, v127
  s_waitcnt lgkmcnt(0)
  v_mfma_f32_32x32x16_bf16 v[112:127], v[76:79], v[68:71], v[172:187]
  ds_read_b128 v[72:75], v192 offset:18432
  v_exp_f32 v96, v96
  v_exp_f32 v97, v97
  v_exp_f32 v98, v98
  v_exp_f32 v99, v99
  v_exp_f32 v100, v100
  v_exp_f32 v101, v101
  v_mfma_f32_32x32x16_bf16 v[128:143], v[88:91], v[80:83], v[128:143]
  v_exp_f32 v102, v102
  v_exp_f32 v103, v103
  v_cvt_pk_bf16_f32 v80, v96, v97
  v_exp_f32 v104, v104
  v_exp_f32 v105, v105
  v_cvt_pk_bf16_f32 v81, v98, v99
  v_exp_f32 v106, v106
  v_exp_f32 v107, v107
  v_mfma_f32_32x32x16_bf16 v[128:143], v[92:95], v[84:87], v[128:143]
  s_mov_b64 exec, s[58:59]
  ds_read_b128 v[88:91], v193 offset:2048
  ds_read_b128 v[92:95], v193 offset:2560
  s_mov_b64 exec, -1
  v_cvt_pk_bf16_f32 v82, v100, v101
  v_cvt_pk_bf16_f32 v83, v102, v103
  v_exp_f32 v108, v108
  v_exp_f32 v109, v109
  v_cvt_pk_bf16_f32 v84, v104, v105
  v_exp_f32 v110, v110
  v_exp_f32 v111, v111
  v_cvt_pk_bf16_f32 v85, v106, v107
  v_cvt_pk_bf16_f32 v86, v108, v109
  v_cvt_pk_bf16_f32 v87, v110, v111
  s_waitcnt lgkmcnt(0)
  v_mfma_f32_32x32x16_bf16 v[96:111], v[72:75], v[68:71], v[172:187]
  ds_read_b128 v[76:79], v192 offset:17408
  v_exp_f32 v112, v112
  v_exp_f32 v113, v113
  v_exp_f32 v114, v114
  v_exp_f32 v115, v115
  v_exp_f32 v116, v116
  v_exp_f32 v117, v117
  v_mfma_f32_32x32x16_bf16 v[128:143], v[88:91], v[80:83], v[128:143]
  v_exp_f32 v118, v118
  v_exp_f32 v119, v119
  v_cvt_pk_bf16_f32 v80, v112, v113
  v_exp_f32 v120, v120
  v_exp_f32 v121, v121
  v_cvt_pk_bf16_f32 v81, v114, v115
  v_exp_f32 v122, v122
  v_exp_f32 v123, v123
  v_mfma_f32_32x32x16_bf16 v[128:143], v[92:95], v[84:87], v[128:143]
  s_mov_b64 exec, s[58:59]
  ds_read_b128 v[88:91], v193 offset:19456
  ds_read_b128 v[92:95], v193 offset:19968
  s_mov_b64 exec, -1
  v_cvt_pk_bf16_f32 v82, v116, v117
  v_cvt_pk_bf16_f32 v83, v118, v119
  v_exp_f32 v124, v124
  v_exp_f32 v125, v125
  v_cvt_pk_bf16_f32 v84, v120, v121
  v_exp_f32 v126, v126
  v_exp_f32 v127, v127
  v_cvt_pk_bf16_f32 v85, v122, v123
  v_cvt_pk_bf16_f32 v86, v124, v125
  v_cvt_pk_bf16_f32 v87, v126, v127
  v_med3_f32 v14, v136, s56, v197
  v_cmp_neq_f32 vcc, v14, v136
  s_cbranch_vccnz FB0
FBDa6:
  v_rcp_f32 v14, v136
  s_nop 0
  v_mul_f32 v128, v128, v14
  v_mul_f32 v129, v129, v14
  v_mul_f32 v130, v130, v14
  v_mul_f32 v131, v131, v14
  v_mul_f32 v132, v132, v14
  v_mul_f32 v133, v133, v14
  v_mul_f32 v134, v134, v14
  v_mul_f32 v135, v135, v14
  v_cvt_pk_bf16_f32 v56, v128, v129
  v_cvt_pk_bf16_f32 v57, v130, v131
  v_cvt_pk_bf16_f32 v58, v132, v133
  v_cvt_pk_bf16_f32 v59, v134, v135
  s_cmp_eq_u32 s19, 0
  s_cbranch_scc1 DU_A22
  buffer_store_dwordx4 v[56:59], v1, s[32:35], s12 offen
DU_B22:
  s_waitcnt lgkmcnt(0)
  v_mfma_f32_32x32x16_bf16 v[112:127], v[76:79], v[68:71], v[172:187]
  ds_read_b128 v[72:75], v192 offset:16384
  v_exp_f32 v96, v96
  v_exp_f32 v97, v97
  v_exp_f32 v98, v98
  v_exp_f32 v99, v99
  v_exp_f32 v100, v100
  v_exp_f32 v101, v101
  v_mfma_f32_32x32x16_bf16 v[144:159], v[88:91], v[80:83], v[144:159]
  v_exp_f32 v102, v102
  v_exp_f32 v103, v103
  v_cvt_pk_bf16_f32 v80, v96, v97
  v_exp_f32 v104, v104
  v_exp_f32 v105, v105
  v_cvt_pk_bf16_f32 v81, v98, v99
  v_exp_f32 v106, v106
  v_exp_f32 v107, v107
  v_mfma_f32_32x32x16_bf16 v[144:159], v[92:95], v[84:87], v[144:159]
  s_mov_b64 exec, s[58:59]
  ds_read_b128 v[88:91], v193 offset:18432
  ds_read_b128 v[92:95], v193 offset:18944
  s_mov_b64 exec, -1
  v_cvt_pk_bf16_f32 v82, v100, v101
  v_cvt_pk_bf16_f32 v83, v102, v103
  v_exp_f32 v108, v108
  v_exp_f32 v109, v109
  v_cvt_pk_bf16_f32 v84, v104, v105
  v_exp_f32 v110, v110
  v_exp_f32 v111, v111
  v_cvt_pk_bf16_f32 v85, v106, v107
  v_cvt_pk_bf16_f32 v86, v108, v109
  v_cvt_pk_bf16_f32 v87, v110, v111
  s_waitcnt lgkmcnt(0)
  v_mfma_f32_32x32x16_bf16 v[96:111], v[72:75], v[68:71], v[172:187]
  ds_read_b128 v[76:79], v192 offset:15360
  v_exp_f32 v112, v112
  v_exp_f32 v113, v113
  v_exp_f32 v114, v114
  v_exp_f32 v115, v115
  v_exp_f32 v116, v116
  v_exp_f32 v117, v117
  v_mfma_f32_32x32x16_bf16 v[144:159], v[88:91], v[80:83], v[144:159]
  v_exp_f32 v118, v118
  v_exp_f32 v119, v119
  v_cvt_pk_bf16_f32 v80, v112, v113
  v_exp_f32 v120, v120
  v_exp_f32 v121, v121
  v_cvt_pk_bf16_f32 v81, v114, v115
  v_exp_f32 v122, v122
  v_exp_f32 v123, v123
  v_mfma_f32_32x32x16_bf16 v[144:159], v[92:95], v[84:87], v[144:159]
  s_mov_b64 exec, s[58:59]
  ds_read_b128 v[88:91], v193 offset:17408
  ds_read_b128 v[92:95], v193 offset:17920
  s_mov_b64 exec, -1
  v_cvt_pk_bf16_f32 v82, v116, v117
  v_cvt_pk_bf16_f32 v83, v118, v119
  v_exp_f32 v124, v124
  v_exp_f32 v125, v125
  v_cvt_pk_bf16_f32 v84, v120, v121
  v_exp_f32 v126, v126
  v_exp_f32 v127, v127
  v_cvt_pk_bf16_f32 v85, v122, v123
  v_cvt_pk_bf16_f32 v86, v124, v125
  v_cvt_pk_bf16_f32 v87, v126, v127
  s_waitcnt lgkmcnt(0)
  v_mfma_f32_32x32x16_bf16 v[112:127], v[76:79], v[68:71], v[202:217]
  ds_read_b128 v[72:75], v192 offset:14336
  v_exp_f32 v96, v96
  v_exp_f32 v97, v97
  v_exp_f32 v98, v98
  v_exp_f32 v99, v99
  v_exp_f32 v100, v100
  v_exp_f32 v101, v101
  v_mfma_f32_32x32x16_bf16 v[144:159], v[88:91], v[80:83], v[144:159]
  v_exp_f32 v102, v102
  v_exp_f32 v103, v103
  v_cvt_pk_bf16_f32 v80, v96, v97
  v_exp_f32 v104, v104
  v_exp_f32 v105, v105
  v_cvt_pk_bf16_f32 v81, v98, v99
  v_exp_f32 v106, v106
  v_exp_f32 v107, v107
  v_mfma_f32_32x32x16_bf16 v[144:159], v[92:95], v[84:87], v[144:159]
  s_mov_b64 exec, s[58:59]
  ds_read_b128 v[88:91], v193 offset:16384
  ds_read_b128 v[92:95], v193 offset:16896
  s_mov_b64 exec, -1
  v_cvt_pk_bf16_f32 v82, v100, v101
  v_cvt_pk_bf16_f32 v83, v102, v103
  v_exp_f32 v108, v108
  v_exp_f32 v109, v109
  v_cvt_pk_bf16_f32 v84, v104, v105
  v_exp_f32 v110, v110
  v_exp_f32 v111, v111
  v_cvt_pk_bf16_f32 v85, v106, v107
  v_cvt_pk_bf16_f32 v86, v108, v109
  v_cvt_pk_bf16_f32 v87, v110, v111
  s_waitcnt lgkmcnt(0)
  v_mfma_f32_32x32x16_bf16 v[96:111], v[72:75], v[68:71], v[202:217]
  ds_read_b128 v[76:79], v192 offset:13312
  v_exp_f32 v112, v112
  v_exp_f32 v113, v113
  v_exp_f32 v114, v114
  v_exp_f32 v115, v115
  v_exp_f32 v116, v116
  v_exp_f32 v117, v117
  v_mfma_f32_32x32x16_bf16 v[144:159], v[88:91], v[80:83], v[144:159]
  v_exp_f32 v118, v118
  v_exp_f32 v119, v119
  v_cvt_pk_bf16_f32 v80, v112, v113
  v_exp_f32 v120, v120
  v_exp_f32 v121, v121
  v_cvt_pk_bf16_f32 v81, v114, v115
  v_exp_f32 v122, v122
  v_exp_f32 v123, v123
  v_mfma_f32_32x32x16_bf16 v[144:159], v[92:95], v[84:87], v[144:159]
  s_mov_b64 exec, s[58:59]
  ds_read_b128 v[88:91], v193 offset:15360
  ds_read_b128 v[92:95], v193 offset:15872
  s_mov_b64 exec, -1
  v_cvt_pk_bf16_f32 v82, v116, v117
  v_cvt_pk_bf16_f32 v83, v118, v119
  v_exp_f32 v124, v124
  v_exp_f32 v125, v125
  v_cvt_pk_bf16_f32 v84, v120, v121
  v_exp_f32 v126, v126
  v_exp_f32 v127, v127
  v_cvt_pk_bf16_f32 v85, v122, v123
  v_cvt_pk_bf16_f32 v86, v124, v125
  v_cvt_pk_bf16_f32 v87, v126, v127
  s_waitcnt lgkmcnt(0)
  v_mfma_f32_32x32x16_bf16 v[112:127], v[76:79], v[68:71], v[236:251]
  v_exp_f32 v96, v96
  v_exp_f32 v97, v97
  v_exp_f32 v98, v98
  v_exp_f32 v99, v99
  v_exp_f32 v100, v100
  v_exp_f32 v101, v101
  v_mfma_f32_32x32x16_bf16 v[144:159], v[88:91], v[80:83], v[144:159]
  v_exp_f32 v102, v102
  v_exp_f32 v103, v103
  v_cvt_pk_bf16_f32 v80, v96, v97
  v_exp_f32 v104, v104
  v_exp_f32 v105, v105
  v_cvt_pk_bf16_f32 v81, v98, v99
  v_exp_f32 v106, v106
  v_exp_f32 v107, v107
  v_mfma_f32_32x32x16_bf16 v[144:159], v[92:95], v[84:87], v[144:159]
  s_mov_b64 exec, s[58:59]
  ds_read_b128 v[88:91], v193 offset:14336
  ds_read_b128 v[92:95], v193 offset:14848
  s_mov_b64 exec, -1
  v_cvt_pk_bf16_f32 v82, v100, v101
  v_cvt_pk_bf16_f32 v83, v102, v103
  v_exp_f32 v108, v108
  v_exp_f32 v109, v109
  v_cvt_pk_bf16_f32 v84, v104, v105
  v_exp_f32 v110, v110
  v_exp_f32 v111, v111
  v_cvt_pk_bf16_f32 v85, v106, v107
  v_cvt_pk_bf16_f32 v86, v108, v109
  v_cvt_pk_bf16_f32 v87, v110, v111
  s_waitcnt lgkmcnt(0)
  v_exp_f32 v112, v112
  v_exp_f32 v113, v113
  v_exp_f32 v114, v114
  v_exp_f32 v115, v115
  v_exp_f32 v116, v116
  v_exp_f32 v117, v117
  v_mfma_f32_32x32x16_bf16 v[144:159], v[88:91], v[80:83], v[144:159]
  v_exp_f32 v118, v118
  v_exp_f32 v119, v119
  v_cvt_pk_bf16_f32 v80, v112, v113
  v_exp_f32 v120, v120
  v_exp_f32 v121, v121
  v_cvt_pk_bf16_f32 v81, v114, v115
  v_exp_f32 v122, v122
  v_exp_f32 v123, v123
  v_mfma_f32_32x32x16_bf16 v[144:159], v[92:95], v[84:87], v[144:159]
  s_mov_b64 exec, s[58:59]
  ds_read_b128 v[88:91], v193 offset:13312
  ds_read_b128 v[92:95], v193 offset:13824
  s_mov_b64 exec, -1
  v_cvt_pk_bf16_f32 v82, v116, v117
  v_cvt_pk_bf16_f32 v83, v118, v119
  v_exp_f32 v124, v124
  v_exp_f32 v125, v125
  v_cvt_pk_bf16_f32 v84, v120, v121
  v_exp_f32 v126, v126
  v_exp_f32 v127, v127
  v_cvt_pk_bf16_f32 v85, v122, v123
  v_cvt_pk_bf16_f32 v86, v124, v125
  v_cvt_pk_bf16_f32 v87, v126, v127
  s_branch H_FIN
PE15:
.p2align 12
PG16:
W7:
  s_branch W0
VH3:
  v_mfma_f32_32x32x16_bf16 v[112:127], v[76:79], v[68:71], v[220:235]
  ds_read_b128 v[72:75], v192 offset:10240
  s_nop 7
  v_exp_f32 v96, v96
  v_exp_f32 v97, v97
  v_exp_f32 v98, v98
  v_exp_f32 v99, v99
  v_exp_f32 v100, v100
  v_exp_f32 v101, v101
  v_exp_f32 v102, v102
  v_exp_f32 v103, v103
  v_cvt_pk_bf16_f32 v80, v96, v97
  v_exp_f32 v104, v104
  v_exp_f32 v105, v105
  v_cvt_pk_bf16_f32 v81, v98, v99
  v_exp_f32 v106, v106
  v_exp_f32 v107, v107
  s_mov_b64 exec, s[58:59]
  ds_read_b128 v[88:91], v193 offset:11264
  ds_read_b128 v[92:95], v193 offset:11776
  s_mov_b64 exec, -1
  v_cvt_pk_bf16_f32 v82, v100, v101
  v_cvt_pk_bf16_f32 v83, v102, v103
  v_exp_f32 v108, v108
  v_exp_f32 v109, v109
  v_cvt_pk_bf16_f32 v84, v104, v105
  v_exp_f32 v110, v110
  v_exp_f32 v111, v111
  v_cvt_pk_bf16_f32 v85, v106, v107
  v_cvt_pk_bf16_f32 v86, v108, v109
  v_cvt_pk_bf16_f32 v87, v110, v111
  s_waitcnt lgkmcnt(0)
  v_mfma_f32_32x32x16_bf16 v[96:111], v[72:75], v[64:67], 0
  ds_read_b128 v[76:79], v192 offset:9216
  v_exp_f32 v112, v112
  v_exp_f32 v113, v113
  v_exp_f32 v114, v114
  v_exp_f32 v115, v115
  v_exp_f32 v116, v116
  v_exp_f32 v117, v117
  v_mfma_f32_32x32x16_bf16 v[128:143], v[88:91], v[80:83], 0
  v_exp_f32 v118, v118
  v_exp_f32 v119, v119
  v_cvt_pk_bf16_f32 v80, v112, v113
  v_exp_f32 v120, v120
  v_exp_f32 v121, v121
  v_cvt_pk_bf16_f32 v81, v114, v115
  v_exp_f32 v122, v122
  v_exp_f32 v123, v123
  v_mfma_f32_32x32x16_bf16 v[128:143], v[92:95], v[84:87], v[128:143]
  s_mov_b64 exec, s[58:59]
  ds_read_b128 v[88:91], v193 offset:20480
  ds_read_b128 v[92:95], v193 offset:20992
  s_mov_b64 exec, -1
  v_cvt_pk_bf16_f32 v82, v116, v117
  v_cvt_pk_bf16_f32 v83, v118, v119
  v_exp_f32 v124, v124
  v_exp_f32 v125, v125
  v_cvt_pk_bf16_f32 v84, v120, v121
  v_exp_f32 v126, v126
  v_exp_f32 v127, v127
  v_cvt_pk_bf16_f32 v85, v122, v123
  v_cvt_pk_bf16_f32 v86, v124, v125
  v_cvt_pk_bf16_f32 v87, v126, v127
  s_cmp_eq_u32 s81, 0
  s_cbranch_scc1 CK2
CR2_3:
  s_waitcnt lgkmcnt(0)
  v_mfma_f32_32x32x16_bf16 v[112:127], v[76:79], v[64:67], 0
  ds_read_b128 v[72:75], v192 offset:8192
  v_exp_f32 v96, v96
  v_exp_f32 v97, v97
  v_exp_f32 v98, v98
  v_exp_f32 v99, v99
  v_exp_f32 v100, v100
  v_exp_f32 v101, v101
  v_mfma_f32_32x32x16_bf16 v[144:159], v[88:91], v[80:83], 0
  v_exp_f32 v102, v102
  v_exp_f32 v103, v103
  v_cvt_pk_bf16_f32 v80, v96, v97
  v_exp_f32 v104, v104
  v_exp_f32 v105, v105
  v_cvt_pk_bf16_f32 v81, v98, v99
  v_exp_f32 v106, v106
  v_exp_f32 v107, v107
  v_mfma_f32_32x32x16_bf16 v[144:159], v[92:95], v[84:87], v[144:159]
  s_mov_b64 exec, s[58:59]
  ds_read_b128 v[88:91], v193 offset:10240
  ds_read_b128 v[92:95], v193 offset:10752
  s_mov_b64 exec, -1
  v_cvt_pk_bf16_f32 v82, v100, v101
  v_cvt_pk_bf16_f32 v83, v102, v103
  v_exp_f32 v108, v108
  v_exp_f32 v109, v109
  v_cvt_pk_bf16_f32 v84, v104, v105
  v_exp_f32 v110, v110
  v_exp_f32 v111, v111
  v_cvt_pk_bf16_f32 v85, v106, v107
  v_cvt_pk_bf16_f32 v86, v108, v109
  v_cvt_pk_bf16_f32 v87, v110, v111
  s_waitcnt lgkmcnt(0)
  v_mfma_f32_32x32x16_bf16 v[96:111], v[72:75], v[64:67], 0
  v_exp_f32 v112, v112
  v_exp_f32 v113, v113
  v_exp_f32 v114, v114
  v_exp_f32 v115, v115
  v_exp_f32 v116, v116
  v_exp_f32 v117, v117
  v_mfma_f32_32x32x16_bf16 v[128:143], v[88:91], v[80:83], v[128:143]
  v_exp_f32 v118, v118
  v_exp_f32 v119, v119
  v_cvt_pk_bf16_f32 v80, v112, v113
  v_exp_f32 v120, v120
  v_exp_f32 v121, v121
  v_cvt_pk_bf16_f32 v81, v114, v115
  v_exp_f32 v122, v122
  v_exp_f32 v123, v123
  v_mfma_f32_32x32x16_bf16 v[128:143], v[92:95], v[84:87], v[128:143]
  s_mov_b64 exec, s[58:59]
  ds_read_b128 v[88:91], v193 offset:9216
  ds_read_b128 v[92:95], v193 offset:9728
  s_mov_b64 exec, -1
  v_cvt_pk_bf16_f32 v82, v116, v117
  v_cvt_pk_bf16_f32 v83, v118, v119
  v_exp_f32 v124, v124
  v_exp_f32 v125, v125
  v_cvt_pk_bf16_f32 v84, v120, v121
  v_exp_f32 v126, v126
  v_exp_f32 v127, v127
  v_cvt_pk_bf16_f32 v85, v122, v123
  v_cvt_pk_bf16_f32 v86, v124, v125
  v_cvt_pk_bf16_f32 v87, v126, v127
  s_cmp_eq_u32 s81, 0
  s_cbranch_scc1 CK4
CR4_3:
  s_waitcnt lgkmcnt(0)
  v_exp_f32 v96, v96
  v_exp_f32 v97, v97
  v_exp_f32 v98, v98
  v_exp_f32 v99, v99
  v_exp_f32 v100, v100
  v_exp_f32 v101, v101
  v_mfma_f32_32x32x16_bf16 v[128:143], v[88:91], v[80:83], v[128:143]
  v_exp_f32 v102, v102
  v_exp_f32 v103, v103
  v_cvt_pk_bf16_f32 v80, v96, v97
  v_exp_f32 v104, v104
  v_exp_f32 v105, v105
  v_cvt_pk_bf16_f32 v81, v98, v99
  v_exp_f32 v106, v106
  v_exp_f32 v107, v107
  v_mfma_f32_32x32x16_bf16 v[128:143], v[92:95], v[84:87], v[128:143]
  s_mov_b64 exec, s[58:59]
  ds_read_b128 v[88:91], v193 offset:8192
  ds_read_b128 v[92:95], v193 offset:8704
  s_mov_b64 exec, -1
  v_cvt_pk_bf16_f32 v82, v100, v101
  v_cvt_pk_bf16_f32 v83, v102, v103
  v_exp_f32 v108, v108
  v_exp_f32 v109, v109
  v_cvt_pk_bf16_f32 v84, v104, v105
  v_exp_f32 v110, v110
  v_exp_f32 v111, v111
  v_cvt_pk_bf16_f32 v85, v106, v107
  v_cvt_pk_bf16_f32 v86, v108, v109
  v_cvt_pk_bf16_f32 v87, v110, v111
  s_waitcnt vmcnt(0)
  s_barrier
  s_lshl_b32 s5, s22, 2
  s_lshl_b64 exec, 15, s5
  s_cmp_eq_u32 s19, 0
  s_cbranch_scc1 DU_A23
  buffer_store_dword v253, v198, s[32:35], 0 offen
DU_B23:
  s_mov_b64 exec, -1
  buffer_load_dword v252, v196, s[32:35], 0 offen
  buffer_load_dword v219, v19, s[40:43], s80 offen offset:384
  ds_read_b128 v[76:79], v192 offset:7168
  ds_read_b128 v[72:75], v192 offset:6144
  s_waitcnt lgkmcnt(3)
  v_mfma_f32_32x32x16_bf16 v[128:143], v[88:91], v[80:83], v[128:143]
  s_waitcnt lgkmcnt(2)
  v_mfma_f32_32x32x16_bf16 v[128:143], v[92:95], v[84:87], v[128:143]
  s_waitcnt lgkmcnt(1)
  v_mfma_f32_32x32x16_bf16 v[112:127], v[76:79], v[64:67], v[172:187]
  s_add_u32 m0, s99, s8
  s_add_u32 s78, s78, s9
  buffer_load_dwordx4 v195, s[40:43], s78 offen lds
  s_add_u32 m0, m0, s8
  s_add_u32 s78, s78, s9
  buffer_load_dwordx4 v195, s[40:43], s78 offen lds
  s_add_u32 m0, m0, s8
  s_add_u32 s78, s78, s9
  buffer_load_dwordx4 v195, s[40:43], s78 offen lds
  s_add_u32 m0, m0, s8
  s_add_u32 s78, s78, s9
  buffer_load_dwordx4 v195, s[40:43], s78 offen lds
  s_add_u32 m0, m0, s8
  s_add_u32 s78, s78, s9
  buffer_load_dwordx4 v195, s[40:43], s78 offen lds
  s_add_u32 m0, m0, s8
  s_add_u32 s78, s78, s9
  buffer_load_dwordx4 v195, s[40:43], s78 offen lds
  s_add_u32 m0, m0, s8
  s_add_u32 s78, s78, s9
  buffer_load_dwordx4 v195, s[40:43], s78 offen lds
  s_add_u32 m0, m0, s8
  s_add_u32 s78, s78, s9
  buffer_load_dwordx4 v195, s[40:43], s78 offen lds
  s_add_u32 m0, m0, s8
  s_add_u32 s78, s78, s9
  buffer_load_dwordx4 v195, s[40:43], s78 offen lds
  s_add_u32 m0, m0, s8
  s_add_u32 s78, s78, s9
  buffer_load_dwordx4 v195, s[40:43], s78 offen lds
  s_add_u32 m0, m0, s8
  s_add_u32 s78, s78, s9
  buffer_load_dwordx4 v195, s[40:43], s78 offen lds
  s_add_u32 m0, m0, s8
  s_add_u32 s78, s78, s9
  buffer_load_dwordx4 v195, s[40:43], s78 offen lds
  s_add_u32 m0, m0, s8
  s_add_u32 s78, s78, s9
  buffer_load_dwordx4 v195, s[40:43], s78 offen lds
  s_add_u32 m0, m0, s8
  s_add_u32 s78, s78, s9
  buffer_load_dwordx4 v195, s[40:43], s78 offen lds
  s_add_u32 m0, m0, s8
  s_add_u32 s78, s78, s9
  buffer_load_dwordx4 v195, s[40:43], s78 offen lds
  s_add_u32 m0, m0, s8
  s_add_u32 s78, s78, s9
  buffer_load_dwordx4 v195, s[40:43], s78 offen lds
  s_waitcnt lgkmcnt(0)
  v_mfma_f32_32x32x16_bf16 v[96:111], v[72:75], v[64:67], v[172:187]
  ds_read_b128 v[76:79], v192 offset:5120
  s_nop 8
  v_exp_f32 v112, v112
  v_exp_f32 v113, v113
  v_exp_f32 v114, v114
  v_exp_f32 v115, v115
  v_exp_f32 v116, v116
  v_exp_f32 v117, v117
  v_exp_f32 v118, v118
  v_exp_f32 v119, v119
  v_cvt_pk_bf16_f32 v80, v112, v113
  v_exp_f32 v120, v120
  v_exp_f32 v121, v121
  v_cvt_pk_bf16_f32 v81, v114, v115
  v_exp_f32 v122, v122
  v_exp_f32 v123, v123
  s_mov_b64 exec, s[58:59]
  ds_read_b128 v[88:91], v193 offset:7168
  ds_read_b128 v[92:95], v193 offset:7680
  s_mov_b64 exec, -1
  v_cvt_pk_bf16_f32 v82, v116, v117
  v_cvt_pk_bf16_f32 v83, v118, v119
  v_exp_f32 v124, v124
  v_exp_f32 v125, v125
  v_cvt_pk_bf16_f32 v84, v120, v121
  v_exp_f32 v126, v126
  v_exp_f32 v127, v127
  v_cvt_pk_bf16_f32 v85, v122, v123
  v_cvt_pk_bf16_f32 v86, v124, v125
  v_cvt_pk_bf16_f32 v87, v126, v127
  s_waitcnt lgkmcnt(0)
  v_mfma_f32_32x32x16_bf16 v[112:127], v[76:79], v[64:67], v[172:187]
  ds_read_b128 v[72:75], v192 offset:4096
  v_exp_f32 v96, v96
  v_exp_f32 v97, v97
  v_exp_f32 v98, v98
  v_exp_f32 v99, v99
  v_exp_f32 v100, v100
  v_exp_f32 v101, v101
  v_mfma_f32_32x32x16_bf16 v[128:143], v[88:91], v[80:83], v[128:143]
  v_exp_f32 v102, v102
  v_exp_f32 v103, v103
  v_cvt_pk_bf16_f32 v80, v96, v97
  v_exp_f32 v104, v104
  v_exp_f32 v105, v105
  v_cvt_pk_bf16_f32 v81, v98, v99
  v_exp_f32 v106, v106
  v_exp_f32 v107, v107
  v_mfma_f32_32x32x16_bf16 v[128:143], v[92:95], v[84:87], v[128:143]
  s_mov_b64 exec, s[58:59]
  ds_read_b128 v[88:91], v193 offset:6144
  ds_read_b128 v[92:95], v193 offset:6656
  s_mov_b64 exec, -1
  v_cvt_pk_bf16_f32 v82, v100, v101
  v_cvt_pk_bf16_f32 v83, v102, v103
  v_exp_f32 v108, v108
  v_exp_f32 v109, v109
  v_cvt_pk_bf16_f32 v84, v104, v105
  v_exp_f32 v110, v110
  v_exp_f32 v111, v111
  v_cvt_pk_bf16_f32 v85, v106, v107
  v_cvt_pk_bf16_f32 v86, v108, v109
  v_cvt_pk_bf16_f32 v87, v110, v111
  s_waitcnt vmcnt(0)
  s_mov_b64 exec, 3
  s_cmp_eq_u32 s19, 0
  s_cbranch_scc1 DU_A24
  buffer_store_dword v253, v218, s[32:35], s79 offen
DU_B24:
  s_mov_b64 exec, -1
  s_setprio 1
  s_waitcnt lgkmcnt(0)
  v_mfma_f32_32x32x16_bf16 v[96:111], v[72:75], v[64:67], v[172:187]
  ds_read_b128 v[76:79], v192 offset:3072
  v_exp_f32 v112, v112
  v_exp_f32 v113, v113
  v_exp_f32 v114, v114
  v_exp_f32 v115, v115
  v_exp_f32 v116, v116
  v_exp_f32 v117, v117
  v_mfma_f32_32x32x16_bf16 v[128:143], v[88:91], v[80:83], v[128:143]
  v_exp_f32 v118, v118
  v_exp_f32 v119, v119
  v_cvt_pk_bf16_f32 v80, v112, v113
  v_exp_f32 v120, v120
  v_exp_f32 v121, v121
  v_cvt_pk_bf16_f32 v81, v114, v115
  v_exp_f32 v122, v122
  v_exp_f32 v123, v123
  v_mfma_f32_32x32x16_bf16 v[128:143], v[92:95], v[84:87], v[128:143]
  s_mov_b64 exec, s[58:59]
  ds_read_b128 v[88:91], v193 offset:5120
  ds_read_b128 v[92:95], v193 offset:5632
  s_mov_b64 exec, -1
  v_cvt_pk_bf16_f32 v82, v116, v117
  v_cvt_pk_bf16_f32 v83, v118, v119
  v_exp_f32 v124, v124
  v_exp_f32 v125, v125
  v_cvt_pk_bf16_f32 v84, v120, v121
  v_exp_f32 v126, v126
  v_exp_f32 v127, v127
  v_cvt_pk_bf16_f32 v85, v122, v123
  v_cvt_pk_bf16_f32 v86, v124, v125
  v_cvt_pk_bf16_f32 v87, v126, v127
  s_waitcnt lgkmcnt(0)
  v_mfma_f32_32x32x16_bf16 v[112:127], v[76:79], v[64:67], v[236:251]
  ds_read_b128 v[72:75], v192 offset:19456
  v_exp_f32 v96, v96
  v_exp_f32 v97, v97
  v_exp_f32 v98, v98
  v_exp_f32 v99, v99
  v_exp_f32 v100, v100
  v_exp_f32 v101, v101
  v_mfma_f32_32x32x16_bf16 v[128:143], v[88:91], v[80:83], v[128:143]
  v_exp_f32 v102, v102
  v_exp_f32 v103, v103
  v_cvt_pk_bf16_f32 v80, v96, v97
  v_exp_f32 v104, v104
  v_exp_f32 v105, v105
  v_cvt_pk_bf16_f32 v81, v98, v99
  v_exp_f32 v106, v106
  v_exp_f32 v107, v107
  v_mfma_f32_32x32x16_bf16 v[128:143], v[92:95], v[84:87], v[128:143]
  s_mov_b64 exec, s[58:59]
  ds_read_b128 v[88:91], v193 offset:4096
  ds_read_b128 v[92:95], v193 offset:4608
  s_mov_b64 exec, -1
  v_cvt_pk_bf16_f32 v82, v100, v101
  v_cvt_pk_bf16_f32 v83, v102, v103
  v_exp_f32 v108, v108
  v_exp_f32 v109, v109
  v_cvt_pk_bf16_f32 v84, v104, v105
  v_exp_f32 v110, v110
  v_exp_f32 v111, v111
  v_cvt_pk_bf16_f32 v85, v106, v107
  v_cvt_pk_bf16_f32 v86, v108, v109
  v_cvt_pk_bf16_f32 v87, v110, v111
  s_waitcnt lgkmcnt(0)
  v_mfma_f32_32x32x16_bf16 v[96:111], v[72:75], v[68:71], v[172:187]
  ds_read_b128 v[76:79], v192 offset:18432
  v_exp_f32 v112, v112
  v_exp_f32 v113, v113
  v_exp_f32 v114, v114
  v_exp_f32 v115, v115
  v_exp_f32 v116, v116
  v_exp_f32 v117, v117
  v_mfma_f32_32x32x16_bf16 v[128:143], v[88:91], v[80:83], v[128:143]
  v_exp_f32 v118, v118
  v_exp_f32 v119, v119
  v_cvt_pk_bf16_f32 v80, v112, v113
  v_exp_f32 v120, v120
  v_exp_f32 v121, v121
  v_cvt_pk_bf16_f32 v81, v114, v115
  v_exp_f32 v122, v122
  v_exp_f32 v123, v123
  v_mfma_f32_32x32x16_bf16 v[128:143], v[92:95], v[84:87], v[128:143]
  s_mov_b64 exec, s[58:59]
  ds_read_b128 v[88:91], v193 offset:3072
  ds_read_b128 v[92:95], v193 offset:3584
  s_mov_b64 exec, -1
  v_cvt_pk_bf16_f32 v82, v116, v117
  v_cvt_pk_bf16_f32 v83, v118, v119
  v_exp_f32 v124, v124
  v_exp_f32 v125, v125
  v_cvt_pk_bf16_f32 v84, v120, v121
  v_exp_f32 v126, v126
  v_exp_f32 v127, v127
  v_cvt_pk_bf16_f32 v85, v122, v123
  v_cvt_pk_bf16_f32 v86, v124, v125
  v_cvt_pk_bf16_f32 v87, v126, v127
  s_waitcnt lgkmcnt(0)
  v_mfma_f32_32x32x16_bf16 v[112:127], v[76:79], v[68:71], v[172:187]
  ds_read_b128 v[72:75], v192 offset:17408
  v_exp_f32 v96, v96
  v_exp_f32 v97, v97
  v_exp_f32 v98, v98
  v_exp_f32 v99, v99
  v_exp_f32 v100, v100
  v_exp_f32 v101, v101
  v_mfma_f32_32x32x16_bf16 v[128:143], v[88:91], v[80:83], v[128:143]
  v_exp_f32 v102, v102
  v_exp_f32 v103, v103
  v_cvt_pk_bf16_f32 v80, v96, v97
  v_exp_f32 v104, v104
  v_exp_f32 v105, v105
  v_cvt_pk_bf16_f32 v81, v98, v99
  v_exp_f32 v106, v106
  v_exp_f32 v107, v107
  v_mfma_f32_32x32x16_bf16 v[128:143], v[92:95], v[84:87], v[128:143]
  s_mov_b64 exec, s[58:59]
  ds_read_b128 v[88:91], v193 offset:19456
  ds_read_b128 v[92:95], v193 offset:19968
  s_mov_b64 exec, -1
  v_cvt_pk_bf16_f32 v82, v100, v101
  v_cvt_pk_bf16_f32 v83, v102, v103
  v_exp_f32 v108, v108
  v_exp_f32 v109, v109
  v_cvt_pk_bf16_f32 v84, v104, v105
  v_exp_f32 v110, v110
  v_exp_f32 v111, v111
  v_cvt_pk_bf16_f32 v85, v106, v107
  v_cvt_pk_bf16_f32 v86, v108, v109
  v_cvt_pk_bf16_f32 v87, v110, v111
  v_med3_f32 v14, v136, s56, v197
  v_cmp_neq_f32 vcc, v14, v136
  s_cbranch_vccnz FB0
FBDa7:
  v_rcp_f32 v14, v136
  s_nop 0
  v_mul_f32 v128, v128, v14
  v_mul_f32 v129, v129, v14
  v_mul_f32 v130, v130, v14
  v_mul_f32 v131, v131, v14
  v_mul_f32 v132, v132, v14
  v_mul_f32 v133, v133, v14
  v_mul_f32 v134, v134, v14
  v_mul_f32 v135, v135, v14
  v_cvt_pk_bf16_f32 v56, v128, v129
  v_cvt_pk_bf16_f32 v57, v130, v131
  v_cvt_pk_bf16_f32 v58, v132, v133
  v_cvt_pk_bf16_f32 v59, v134, v135
  s_cmp_eq_u32 s19, 0
  s_cbranch_scc1 DU_A25
  buffer_store_dwordx4 v[56:59], v1, s[32:35], s12 offen
DU_B25:
  s_waitcnt lgkmcnt(0)
  v_mfma_f32_32x32x16_bf16 v[96:111], v[72:75], v[68:71], v[172:187]
  ds_read_b128 v[76:79], v192 offset:16384
  v_exp_f32 v112, v112
  v_exp_f32 v113, v113
  v_exp_f32 v114, v114
  v_exp_f32 v115, v115
  v_exp_f32 v116, v116
  v_exp_f32 v117, v117
  v_mfma_f32_32x32x16_bf16 v[144:159], v[88:91], v[80:83], v[144:159]
  v_exp_f32 v118, v118
  v_exp_f32 v119, v119
  v_cvt_pk_bf16_f32 v80, v112, v113
  v_exp_f32 v120, v120
  v_exp_f32 v121, v121
  v_cvt_pk_bf16_f32 v81, v114, v115
  v_exp_f32 v122, v122
  v_exp_f32 v123, v123
  v_mfma_f32_32x32x16_bf16 v[144:159], v[92:95], v[84:87], v[144:159]
  s_mov_b64 exec, s[58:59]
  ds_read_b128 v[88:91], v193 offset:18432
  ds_read_b128 v[92:95], v193 offset:18944
  s_mov_b64 exec, -1
  v_cvt_pk_bf16_f32 v82, v116, v117
  v_cvt_pk_bf16_f32 v83, v118, v119
  v_exp_f32 v124, v124
  v_exp_f32 v125, v125
  v_cvt_pk_bf16_f32 v84, v120, v121
  v_exp_f32 v126, v126
  v_exp_f32 v127, v127
  v_cvt_pk_bf16_f32 v85, v122, v123
  v_cvt_pk_bf16_f32 v86, v124, v125
  v_cvt_pk_bf16_f32 v87, v126, v127
  s_waitcnt lgkmcnt(0)
  v_mfma_f32_32x32x16_bf16 v[112:127], v[76:79], v[68:71], v[172:187]
  ds_read_b128 v[72:75], v192 offset:15360
  v_exp_f32 v96, v96
  v_exp_f32 v97, v97
  v_exp_f32 v98, v98
  v_exp_f32 v99, v99
  v_exp_f32 v100, v100
  v_exp_f32 v101, v101
  v_mfma_f32_32x32x16_bf16 v[144:159], v[88:91], v[80:83], v[144:159]
  v_exp_f32 v102, v102
  v_exp_f32 v103, v103
  v_cvt_pk_bf16_f32 v80, v96, v97
  v_exp_f32 v104, v104
  v_exp_f32 v105, v105
  v_cvt_pk_bf16_f32 v81, v98, v99
  v_exp_f32 v106, v106
  v_exp_f32 v107, v107
  v_mfma_f32_32x32x16_bf16 v[144:159], v[92:95], v[84:87], v[144:159]
  s_mov_b64 exec, s[58:59]
  ds_read_b128 v[88:91], v193 offset:17408
  ds_read_b128 v[92:95], v193 offset:17920
  s_mov_b64 exec, -1
  v_cvt_pk_bf16_f32 v82, v100, v101
  v_cvt_pk_bf16_f32 v83, v102, v103
  v_exp_f32 v108, v108
  v_exp_f32 v109, v109
  v_cvt_pk_bf16_f32 v84, v104, v105
  v_exp_f32 v110, v110
  v_exp_f32 v111, v111
  v_cvt_pk_bf16_f32 v85, v106, v107
  v_cvt_pk_bf16_f32 v86, v108, v109
  v_cvt_pk_bf16_f32 v87, v110, v111
  s_waitcnt lgkmcnt(0)
  v_mfma_f32_32x32x16_bf16 v[96:111], v[72:75], v[68:71], v[202:217]
  ds_read_b128 v[76:79], v192 offset:14336
  v_exp_f32 v112, v112
  v_exp_f32 v113, v113
  v_exp_f32 v114, v114
  v_exp_f32 v115, v115
  v_exp_f32 v116, v116
  v_exp_f32 v117, v117
  v_mfma_f32_32x32x16_bf16 v[144:159], v[88:91], v[80:83], v[144:159]
  v_exp_f32 v118, v118
  v_exp_f32 v119, v119
  v_cvt_pk_bf16_f32 v80, v112, v113
  v_exp_f32 v120, v120
  v_exp_f32 v121, v121
  v_cvt_pk_bf16_f32 v81, v114, v115
  v_exp_f32 v122, v122
  v_exp_f32 v123, v123
  v_mfma_f32_32x32x16_bf16 v[144:159], v[92:95], v[84:87], v[144:159]
  s_mov_b64 exec, s[58:59]
  ds_read_b128 v[88:91], v193 offset:16384
  ds_read_b128 v[92:95], v193 offset:16896
  s_mov_b64 exec, -1
  v_cvt_pk_bf16_f32 v82, v116, v117
  v_cvt_pk_bf16_f32 v83, v118, v119
  v_exp_f32 v124, v124
  v_exp_f32 v125, v125
  v_cvt_pk_bf16_f32 v84, v120, v121
  v_exp_f32 v126, v126
  v_exp_f32 v127, v127
  v_cvt_pk_bf16_f32 v85, v122, v123
  v_cvt_pk_bf16_f32 v86, v124, v125
  v_cvt_pk_bf16_f32 v87, v126, v127
  s_waitcnt lgkmcnt(0)
  v_mfma_f32_32x32x16_bf16 v[112:127], v[76:79], v[68:71], v[202:217]
  ds_read_b128 v[72:75], v192 offset:13312
  v_exp_f32 v96, v96
  v_exp_f32 v97, v97
  v_exp_f32 v98, v98
  v_exp_f32 v99, v99
  v_exp_f32 v100, v100
  v_exp_f32 v101, v101
  v_mfma_f32_32x32x16_bf16 v[144:159], v[88:91], v[80:83], v[144:159]
  v_exp_f32 v102, v102
  v_exp_f32 v103, v103
  v_cvt_pk_bf16_f32 v80, v96, v97
  v_exp_f32 v104, v104
  v_exp_f32 v105, v105
  v_cvt_pk_bf16_f32 v81, v98, v99
  v_exp_f32 v106, v106
  v_exp_f32 v107, v107
  v_mfma_f32_32x32x16_bf16 v[144:159], v[92:95], v[84:87], v[144:159]
  s_mov_b64 exec, s[58:59]
  ds_read_b128 v[88:91], v193 offset:15360
  ds_read_b128 v[92:95], v193 offset:15872
  s_mov_b64 exec, -1
  v_cvt_pk_bf16_f32 v82, v100, v101
  v_cvt_pk_bf16_f32 v83, v102, v103
  v_exp_f32 v108, v108
  v_exp_f32 v109, v109
  v_cvt_pk_bf16_f32 v84, v104, v105
  v_exp_f32 v110, v110
  v_exp_f32 v111, v111
  v_cvt_pk_bf16_f32 v85, v106, v107
  v_cvt_pk_bf16_f32 v86, v108, v109
  v_cvt_pk_bf16_f32 v87, v110, v111
  s_waitcnt lgkmcnt(0)
  v_mfma_f32_32x32x16_bf16 v[96:111], v[72:75], v[68:71], v[202:217]
  ds_read_b128 v[76:79], v192 offset:12288
  v_exp_f32 v112, v112
  v_exp_f32 v113, v113
  v_exp_f32 v114, v114
  v_exp_f32 v115, v115
  v_exp_f32 v116, v116
  v_exp_f32 v117, v117
  v_mfma_f32_32x32x16_bf16 v[144:159], v[88:91], v[80:83], v[144:159]
  v_exp_f32 v118, v118
  v_exp_f32 v119, v119
  v_cvt_pk_bf16_f32 v80, v112, v113
  v_exp_f32 v120, v120
  v_exp_f32 v121, v121
  v_cvt_pk_bf16_f32 v81, v114, v115
  v_exp_f32 v122, v122
  v_exp_f32 v123, v123
  v_mfma_f32_32x32x16_bf16 v[144:159], v[92:95], v[84:87], v[144:159]
  s_mov_b64 exec, s[58:59]
  ds_read_b128 v[88:91], v193 offset:14336
  ds_read_b128 v[92:95], v193 offset:14848
  s_mov_b64 exec, -1
  v_cvt_pk_bf16_f32 v82, v116, v117
  v_cvt_pk_bf16_f32 v83, v118, v119
  v_exp_f32 v124, v124
  v_exp_f32 v125, v125
  v_cvt_pk_bf16_f32 v84, v120, v121
  v_exp_f32 v126, v126
  v_exp_f32 v127, v127
  v_cvt_pk_bf16_f32 v85, v122, v123
  v_cvt_pk_bf16_f32 v86, v124, v125
  v_cvt_pk_bf16_f32 v87, v126, v127
  s_waitcnt lgkmcnt(0)
  v_mfma_f32_32x32x16_bf16 v[112:127], v[76:79], v[68:71], v[236:251]
  v_exp_f32 v96, v96
  v_exp_f32 v97, v97
  v_exp_f32 v98, v98
  v_exp_f32 v99, v99
  v_exp_f32 v100, v100
  v_exp_f32 v101, v101
  v_mfma_f32_32x32x16_bf16 v[144:159], v[88:91], v[80:83], v[144:159]
  v_exp_f32 v102, v102
  v_exp_f32 v103, v103
  v_cvt_pk_bf16_f32 v80, v96, v97
  v_exp_f32 v104, v104
  v_exp_f32 v105, v105
  v_cvt_pk_bf16_f32 v81, v98, v99
  v_exp_f32 v106, v106
  v_exp_f32 v107, v107
  v_mfma_f32_32x32x16_bf16 v[144:159], v[92:95], v[84:87], v[144:159]
  s_mov_b64 exec, s[58:59]
  ds_read_b128 v[88:91], v193 offset:13312
  ds_read_b128 v[92:95], v193 offset:13824
  s_mov_b64 exec, -1
  v_cvt_pk_bf16_f32 v82, v100, v101
  v_cvt_pk_bf16_f32 v83, v102, v103
  v_exp_f32 v108, v108
  v_exp_f32 v109, v109
  v_cvt_pk_bf16_f32 v84, v104, v105
  v_exp_f32 v110, v110
  v_exp_f32 v111, v111
  v_cvt_pk_bf16_f32 v85, v106, v107
  v_cvt_pk_bf16_f32 v86, v108, v109
  v_cvt_pk_bf16_f32 v87, v110, v111
  s_waitcnt lgkmcnt(0)
  v_exp_f32 v112, v112
  v_exp_f32 v113, v113
  v_exp_f32 v114, v114
  v_exp_f32 v115, v115
  v_exp_f32 v116, v116
  v_exp_f32 v117, v117
  v_mfma_f32_32x32x16_bf16 v[144:159], v[88:91], v[80:83], v[144:159]
  v_exp_f32 v118, v118
  v_exp_f32 v119, v119
  v_cvt_pk_bf16_f32 v80, v112, v113
  v_exp_f32 v120, v120
  v_exp_f32 v121, v121
  v_cvt_pk_bf16_f32 v81, v114, v115
  v_exp_f32 v122, v122
  v_exp_f32 v123, v123
  v_mfma_f32_32x32x16_bf16 v[144:159], v[92:95], v[84:87], v[144:159]
  s_mov_b64 exec, s[58:59]
  ds_read_b128 v[88:91], v193 offset:12288
  ds_read_b128 v[92:95], v193 offset:12800
  s_mov_b64 exec, -1
  v_cvt_pk_bf16_f32 v82, v116, v117
  v_cvt_pk_bf16_f32 v83, v118, v119
  v_exp_f32 v124, v124
  v_exp_f32 v125, v125
  v_cvt_pk_bf16_f32 v84, v120, v121
  v_exp_f32 v126, v126
  v_exp_f32 v127, v127
  v_cvt_pk_bf16_f32 v85, v122, v123
  v_cvt_pk_bf16_f32 v86, v124, v125
  v_cvt_pk_bf16_f32 v87, v126, v127
  s_branch H_FIN
PE16:
.p2align 12
PG17:
POLL_L27:
  s_sleep 1
  buffer_load_dword v12, v198, s[32:35], 0 offen sc1
  s_waitcnt vmcnt(0)
  v_cmp_ne_u32 vcc, s52, v12
  s_and_b64 vcc, vcc, s[62:63]
  s_sub_u32 s7, s7, 1
  s_cbranch_scc1 POLL_T27
  s_cbranch_vccnz POLL_L27
  s_branch POLL_D27
POLL_T27:
  s_branch POLL_D27
W8:
  s_branch W9
H_FIN:
  s_waitcnt lgkmcnt(0)
  v_mfma_f32_32x32x16_bf16 v[144:159], v[88:91], v[80:83], v[144:159]
  v_mfma_f32_32x32x16_bf16 v[144:159], v[92:95], v[84:87], v[144:159]
  s_nop 11
  v_med3_f32 v14, v152, s56, v197
  v_cmp_neq_f32 vcc, v14, v152
  s_cbranch_vccnz FB1
FBDb:
  v_rcp_f32 v14, v152
  s_nop 0
  v_mul_f32 v144, v144, v14
  v_mul_f32 v145, v145, v14
  v_mul_f32 v146, v146, v14
  v_mul_f32 v147, v147, v14
  v_mul_f32 v148, v148, v14
  v_mul_f32 v149, v149, v14
  v_mul_f32 v150, v150, v14
  v_mul_f32 v151, v151, v14
  v_cvt_pk_bf16_f32 v60, v144, v145
  v_cvt_pk_bf16_f32 v61, v146, v147
  v_cvt_pk_bf16_f32 v62, v148, v149
  v_cvt_pk_bf16_f32 v63, v150, v151
  s_cmp_eq_u32 s19, 0
  s_cbranch_scc1 DU_A26
  buffer_store_dwordx4 v[60:63], v1, s[32:35], s14 offen
DU_B26:
  s_cmp_lt_u32 s23, 4
  s_cbranch_scc1 L_FIN
  s_setprio 0
  v_subrev_u32 v2, s11, v199
  v_subrev_u32 v3, s11, v200
  s_waitcnt vmcnt(9)
  v_cmp_ne_u32 vcc, s52, v12
  s_and_b64 vcc, vcc, s[62:63]
  s_mov_b32 s7, 4000
  s_cbranch_vccnz POLL_L27
POLL_D27:
  ds_read_b64_tr_b16 v[176:177], v199 offset:0
  ds_read_b64_tr_b16 v[178:179], v199 offset:1024
  ds_read_b64_tr_b16 v[180:181], v200 offset:0
  ds_read_b64_tr_b16 v[182:183], v200 offset:1024
  ds_read_b64_tr_b16 v[184:185], v199 offset:8192
  ds_read_b64_tr_b16 v[186:187], v199 offset:9216
  ds_read_b64_tr_b16 v[188:189], v200 offset:8192
  ds_read_b64_tr_b16 v[190:191], v200 offset:9216
  s_mov_b32 s7, 4000
  ds_read_b64_tr_b16 v[224:225], v199 offset:16384
  ds_read_b64_tr_b16 v[226:227], v199 offset:17408
  ds_read_b64_tr_b16 v[228:229], v200 offset:16384
  ds_read_b64_tr_b16 v[230:231], v200 offset:17408
  s_waitcnt vmcnt(1)
  v_max3_u32 v13, v19, v23, v27
  v_max3_u32 v13, v13, v31, v35
  v_max3_u32 v13, v13, v39, v43
  v_max_u32 v13, v13, v47
  v_cmp_eq_u32 vcc, -1, v13
  s_cbranch_vccnz SNB0
SRB0:
  s_waitcnt lgkmcnt(10)
  v_mfma_f32_32x32x16_bf16 v[144:159], v[176:179], v[16:19], 0
  buffer_load_dwordx4 v[48:51], v1, s[32:35], s80 offen offset:1024 sc1
  s_waitcnt lgkmcnt(8)
  v_mfma_f32_32x32x16_bf16 v[160:175], v[180:183], v[16:19], 0
  buffer_load_dwordx4 v[52:55], v1, s[32:35], s81 offen offset:1024 sc1
  ds_read_b64_tr_b16 v[176:177], v199 offset:24576
  ds_read_b64_tr_b16 v[178:179], v199 offset:25600
  ds_read_b64_tr_b16 v[180:181], v200 offset:24576
  ds_read_b64_tr_b16 v[182:183], v200 offset:25600
  s_waitcnt lgkmcnt(10)
  v_mfma_f32_32x32x16_bf16 v[144:159], v[184:187], v[20:23], v[144:159]
  buffer_load_dwordx4 v[56:59], v1, s[32:35], s82 offen offset:1024 sc1
  s_waitcnt lgkmcnt(8)
  v_mfma_f32_32x32x16_bf16 v[160:175], v[188:191], v[20:23], v[160:175]
  buffer_load_dwordx4 v[60:63], v1, s[32:35], s83 offen offset:1024 sc1
  ds_read_b64_tr_b16 v[184:185], v199 offset:32768
  ds_read_b64_tr_b16 v[186:187], v199 offset:33792
  ds_read_b64_tr_b16 v[188:189], v200 offset:32768
  ds_read_b64_tr_b16 v[190:191], v200 offset:33792
  s_waitcnt lgkmcnt(10)
  v_mfma_f32_32x32x16_bf16 v[144:159], v[224:227], v[24:27], v[144:159]
  buffer_load_dwordx4 v[64:67], v1, s[32:35], s84 offen offset:1024 sc1
  s_waitcnt lgkmcnt(8)
  v_mfma_f32_32x32x16_bf16 v[160:175], v[228:231], v[24:27], v[160:175]
  buffer_load_dwordx4 v[68:71], v1, s[32:35], s85 offen offset:1024 sc1
  ds_read_b64_tr_b16 v[224:225], v199 offset:40960
  ds_read_b64_tr_b16 v[226:227], v199 offset:41984
  ds_read_b64_tr_b16 v[228:229], v200 offset:40960
  ds_read_b64_tr_b16 v[230:231], v200 offset:41984
  s_waitcnt lgkmcnt(10)
  v_mfma_f32_32x32x16_bf16 v[144:159], v[176:179], v[28:31], v[144:159]
  buffer_load_dwordx4 v[72:75], v1, s[32:35], s86 offen offset:1024 sc1
  s_waitcnt lgkmcnt(8)
  v_mfma_f32_32x32x16_bf16 v[160:175], v[180:183], v[28:31], v[160:175]
  buffer_load_dwordx4 v[76:79], v1, s[32:35], s87 offen offset:1024 sc1
  ds_read_b64_tr_b16 v[176:177], v199 offset:49152
  ds_read_b64_tr_b16 v[178:179], v199 offset:50176
  ds_read_b64_tr_b16 v[180:181], v200 offset:49152
  ds_read_b64_tr_b16 v[182:183], v200 offset:50176
  s_waitcnt lgkmcnt(10)
  v_mfma_f32_32x32x16_bf16 v[144:159], v[184:187], v[32:35], v[144:159]
  s_waitcnt lgkmcnt(8)
  v_mfma_f32_32x32x16_bf16 v[160:175], v[188:191], v[32:35], v[160:175]
  ds_read_b64_tr_b16 v[184:185], v199 offset:57344
  ds_read_b64_tr_b16 v[186:187], v199 offset:58368
  ds_read_b64_tr_b16 v[188:189], v200 offset:57344
  ds_read_b64_tr_b16 v[190:191], v200 offset:58368
  s_waitcnt lgkmcnt(10)
  v_mfma_f32_32x32x16_bf16 v[144:159], v[224:227], v[36:39], v[144:159]
  s_waitcnt lgkmcnt(8)
  v_mfma_f32_32x32x16_bf16 v[160:175], v[228:231], v[36:39], v[160:175]
  ds_read_b64_tr_b16 v[224:225], v2 offset:6144
  ds_read_b64_tr_b16 v[226:227], v2 offset:7168
  ds_read_b64_tr_b16 v[228:229], v3 offset:6144
  ds_read_b64_tr_b16 v[230:231], v3 offset:7168
  s_waitcnt lgkmcnt(10)
  v_mfma_f32_32x32x16_bf16 v[144:159], v[176:179], v[40:43], v[144:159]
  s_waitcnt lgkmcnt(8)
  v_mfma_f32_32x32x16_bf16 v[160:175], v[180:183], v[40:43], v[160:175]
  ds_read_b64_tr_b16 v[176:177], v2 offset:14336
  ds_read_b64_tr_b16 v[178:179], v2 offset:15360
  ds_read_b64_tr_b16 v[180:181], v3 offset:14336
  ds_read_b64_tr_b16 v[182:183], v3 offset:15360
  s_waitcnt lgkmcnt(10)
  v_mfma_f32_32x32x16_bf16 v[144:159], v[184:187], v[44:47], v[144:159]
  s_waitcnt vmcnt(0)
  v_max3_u32 v13, v51, v55, v59
  v_max3_u32 v13, v13, v63, v67
  v_max3_u32 v13, v13, v71, v75
  v_max_u32 v13, v13, v79
  v_cmp_eq_u32 vcc, -1, v13
  s_cbranch_vccnz SNB8
SRB8:
  s_waitcnt lgkmcnt(8)
  v_mfma_f32_32x32x16_bf16 v[160:175], v[188:191], v[44:47], v[160:175]
  ds_read_b64_tr_b16 v[184:185], v2 offset:22528
  ds_read_b64_tr_b16 v[186:187], v2 offset:23552
  ds_read_b64_tr_b16 v[188:189], v3 offset:22528
  ds_read_b64_tr_b16 v[190:191], v3 offset:23552
  s_waitcnt lgkmcnt(10)
  v_mfma_f32_32x32x16_bf16 v[144:159], v[224:227], v[48:51], v[144:159]
  buffer_load_dwordx4 v[80:83], v1, s[32:35], s80 offen offset:2048 sc1
  s_waitcnt lgkmcnt(8)
  v_mfma_f32_32x32x16_bf16 v[160:175], v[228:231], v[48:51], v[160:175]
  buffer_load_dwordx4 v[84:87], v1, s[32:35], s81 offen offset:2048 sc1
  ds_read_b64_tr_b16 v[224:225], v2 offset:30720
  ds_read_b64_tr_b16 v[226:227], v2 offset:31744
  ds_read_b64_tr_b16 v[228:229], v3 offset:30720
  ds_read_b64_tr_b16 v[230:231], v3 offset:31744
  s_waitcnt lgkmcnt(10)
  v_mfma_f32_32x32x16_bf16 v[144:159], v[176:179], v[52:55], v[144:159]
  buffer_load_dwordx4 v[88:91], v1, s[32:35], s82 offen offset:2048 sc1
  s_waitcnt lgkmcnt(8)
  v_mfma_f32_32x32x16_bf16 v[160:175], v[180:183], v[52:55], v[160:175]
  buffer_load_dwordx4 v[92:95], v1, s[32:35], s83 offen offset:2048 sc1
  ds_read_b64_tr_b16 v[176:177], v2 offset:38912
  ds_read_b64_tr_b16 v[178:179], v2 offset:39936
  ds_read_b64_tr_b16 v[180:181], v3 offset:38912
  ds_read_b64_tr_b16 v[182:183], v3 offset:39936
  s_waitcnt lgkmcnt(10)
  v_mfma_f32_32x32x16_bf16 v[144:159], v[184:187], v[56:59], v[144:159]
  buffer_load_dwordx4 v[96:99], v1, s[32:35], s84 offen offset:2048 sc1
  s_waitcnt lgkmcnt(8)
  v_mfma_f32_32x32x16_bf16 v[160:175], v[188:191], v[56:59], v[160:175]
  buffer_load_dwordx4 v[100:103], v1, s[32:35], s85 offen offset:2048 sc1
  ds_read_b64_tr_b16 v[184:185], v2 offset:47104
  ds_read_b64_tr_b16 v[186:187], v2 offset:48128
  ds_read_b64_tr_b16 v[188:189], v3 offset:47104
  ds_read_b64_tr_b16 v[190:191], v3 offset:48128
  s_waitcnt lgkmcnt(10)
  v_mfma_f32_32x32x16_bf16 v[144:159], v[224:227], v[60:63], v[144:159]
  buffer_load_dwordx4 v[104:107], v1, s[32:35], s86 offen offset:2048 sc1
  s_waitcnt lgkmcnt(8)
  v_mfma_f32_32x32x16_bf16 v[160:175], v[228:231], v[60:63], v[160:175]
  buffer_load_dwordx4 v[108:111], v1, s[32:35], s87 offen offset:2048 sc1
  ds_read_b64_tr_b16 v[224:225], v2 offset:55296
  ds_read_b64_tr_b16 v[226:227], v2 offset:56320
  ds_read_b64_tr_b16 v[228:229], v3 offset:55296
  ds_read_b64_tr_b16 v[230:231], v3 offset:56320
  s_waitcnt lgkmcnt(10)
  v_mfma_f32_32x32x16_bf16 v[144:159], v[176:179], v[64:67], v[144:159]
  s_waitcnt lgkmcnt(8)
  v_mfma_f32_32x32x16_bf16 v[160:175], v[180:183], v[64:67], v[160:175]
  ds_read_b64_tr_b16 v[176:177], v2 offset:63488
  ds_read_b64_tr_b16 v[178:179], v2 offset:64512
  ds_read_b64_tr_b16 v[180:181], v3 offset:63488
  ds_read_b64_tr_b16 v[182:183], v3 offset:64512
  s_waitcnt lgkmcnt(10)
  v_mfma_f32_32x32x16_bf16 v[144:159], v[184:187], v[68:71], v[144:159]
  s_waitcnt lgkmcnt(8)
  v_mfma_f32_32x32x16_bf16 v[160:175], v[188:191], v[68:71], v[160:175]
  ds_read_b64_tr_b16 v[184:185], v2 offset:4096
  ds_read_b64_tr_b16 v[186:187], v2 offset:5120
  ds_read_b64_tr_b16 v[188:189], v3 offset:4096
  ds_read_b64_tr_b16 v[190:191], v3 offset:5120
  s_waitcnt lgkmcnt(10)
  v_mfma_f32_32x32x16_bf16 v[144:159], v[224:227], v[72:75], v[144:159]
  s_waitcnt lgkmcnt(8)
  v_mfma_f32_32x32x16_bf16 v[160:175], v[228:231], v[72:75], v[160:175]
  ds_read_b64_tr_b16 v[224:225], v2 offset:12288
  ds_read_b64_tr_b16 v[226:227], v2 offset:13312
  ds_read_b64_tr_b16 v[228:229], v3 offset:12288
  ds_read_b64_tr_b16 v[230:231], v3 offset:13312
  s_waitcnt lgkmcnt(10)
  v_mfma_f32_32x32x16_bf16 v[144:159], v[176:179], v[76:79], v[144:159]
  s_waitcnt vmcnt(0)
  v_max3_u32 v13, v83, v87, v91
  v_max3_u32 v13, v13, v95, v99
  v_max3_u32 v13, v13, v103, v107
  v_max_u32 v13, v13, v111
  v_cmp_eq_u32 vcc, -1, v13
  s_cbranch_vccnz SNB16
SRB16:
  s_waitcnt lgkmcnt(8)
  v_mfma_f32_32x32x16_bf16 v[160:175], v[180:183], v[76:79], v[160:175]
  ds_read_b64_tr_b16 v[176:177], v2 offset:20480
  ds_read_b64_tr_b16 v[178:179], v2 offset:21504
  ds_read_b64_tr_b16 v[180:181], v3 offset:20480
  ds_read_b64_tr_b16 v[182:183], v3 offset:21504
  s_waitcnt lgkmcnt(10)
  v_mfma_f32_32x32x16_bf16 v[144:159], v[184:187], v[80:83], v[144:159]
  s_waitcnt lgkmcnt(8)
  v_mfma_f32_32x32x16_bf16 v[160:175], v[188:191], v[80:83], v[160:175]
  ds_read_b64_tr_b16 v[184:185], v2 offset:28672
  ds_read_b64_tr_b16 v[186:187], v2 offset:29696
  ds_read_b64_tr_b16 v[188:189], v3 offset:28672
  ds_read_b64_tr_b16 v[190:191], v3 offset:29696
  s_waitcnt lgkmcnt(10)
  v_mfma_f32_32x32x16_bf16 v[144:159], v[224:227], v[84:87], v[144:159]
  s_waitcnt lgkmcnt(8)
  v_mfma_f32_32x32x16_bf16 v[160:175], v[228:231], v[84:87], v[160:175]
  ds_read_b64_tr_b16 v[224:225], v2 offset:36864
  ds_read_b64_tr_b16 v[226:227], v2 offset:37888
  ds_read_b64_tr_b16 v[228:229], v3 offset:36864
  ds_read_b64_tr_b16 v[230:231], v3 offset:37888
  s_waitcnt lgkmcnt(10)
  v_mfma_f32_32x32x16_bf16 v[144:159], v[176:179], v[88:91], v[144:159]
  buffer_load_dwordx4 v[112:115], v1, s[32:35], s80 offen offset:3072 sc1
  s_waitcnt lgkmcnt(8)
  v_mfma_f32_32x32x16_bf16 v[160:175], v[180:183], v[88:91], v[160:175]
  buffer_load_dwordx4 v[116:119], v1, s[32:35], s81 offen offset:3072 sc1
  ds_read_b64_tr_b16 v[176:177], v2 offset:45056
  ds_read_b64_tr_b16 v[178:179], v2 offset:46080
  ds_read_b64_tr_b16 v[180:181], v3 offset:45056
  ds_read_b64_tr_b16 v[182:183], v3 offset:46080
  s_waitcnt lgkmcnt(10)
  v_mfma_f32_32x32x16_bf16 v[144:159], v[184:187], v[92:95], v[144:159]
  buffer_load_dwordx4 v[120:123], v1, s[32:35], s82 offen offset:3072 sc1
  s_waitcnt lgkmcnt(8)
  v_mfma_f32_32x32x16_bf16 v[160:175], v[188:191], v[92:95], v[160:175]
  buffer_load_dwordx4 v[124:127], v1, s[32:35], s83 offen offset:3072 sc1
  ds_read_b64_tr_b16 v[184:185], v2 offset:53248
  ds_read_b64_tr_b16 v[186:187], v2 offset:54272
  ds_read_b64_tr_b16 v[188:189], v3 offset:53248
  ds_read_b64_tr_b16 v[190:191], v3 offset:54272
  s_waitcnt lgkmcnt(10)
  v_mfma_f32_32x32x16_bf16 v[144:159], v[224:227], v[96:99], v[144:159]
  buffer_load_dwordx4 v[128:131], v1, s[32:35], s84 offen offset:3072 sc1
  s_waitcnt lgkmcnt(8)
  v_mfma_f32_32x32x16_bf16 v[160:175], v[228:231], v[96:99], v[160:175]
  buffer_load_dwordx4 v[132:135], v1, s[32:35], s85 offen offset:3072 sc1
  ds_read_b64_tr_b16 v[224:225], v2 offset:61440
  ds_read_b64_tr_b16 v[226:227], v2 offset:62464
  ds_read_b64_tr_b16 v[228:229], v3 offset:61440
  ds_read_b64_tr_b16 v[230:231], v3 offset:62464
  s_waitcnt lgkmcnt(10)
  v_mfma_f32_32x32x16_bf16 v[144:159], v[176:179], v[100:103], v[144:159]
  buffer_load_dwordx4 v[136:139], v1, s[32:35], s86 offen offset:3072 sc1
  s_waitcnt lgkmcnt(8)
  v_mfma_f32_32x32x16_bf16 v[160:175], v[180:183], v[100:103], v[160:175]
  buffer_load_dwordx4 v[140:143], v1, s[32:35], s87 offen offset:3072 sc1
  ds_read_b64_tr_b16 v[176:177], v199 offset:2048
  ds_read_b64_tr_b16 v[178:179], v199 offset:3072
  ds_read_b64_tr_b16 v[180:181], v200 offset:2048
  ds_read_b64_tr_b16 v[182:183], v200 offset:3072
  s_waitcnt lgkmcnt(10)
  v_mfma_f32_32x32x16_bf16 v[144:159], v[184:187], v[104:107], v[144:159]
  s_waitcnt lgkmcnt(8)
  v_mfma_f32_32x32x16_bf16 v[160:175], v[188:191], v[104:107], v[160:175]
  ds_read_b64_tr_b16 v[184:185], v199 offset:10240
  ds_read_b64_tr_b16 v[186:187], v199 offset:11264
  ds_read_b64_tr_b16 v[188:189], v200 offset:10240
  ds_read_b64_tr_b16 v[190:191], v200 offset:11264
  s_waitcnt lgkmcnt(10)
  v_mfma_f32_32x32x16_bf16 v[144:159], v[224:227], v[108:111], v[144:159]
  s_waitcnt vmcnt(7)
  v_cmp_eq_u32 vcc, -1, v115
  s_cbranch_vccnz SNB24
SRB24:
  s_waitcnt lgkmcnt(8)
  v_mfma_f32_32x32x16_bf16 v[160:175], v[228:231], v[108:111], v[160:175]
  ds_read_b64_tr_b16 v[224:225], v199 offset:18432
  ds_read_b64_tr_b16 v[226:227], v199 offset:19456
  ds_read_b64_tr_b16 v[228:229], v200 offset:18432
  ds_read_b64_tr_b16 v[230:231], v200 offset:19456
  s_waitcnt lgkmcnt(10)
  v_mfma_f32_32x32x16_bf16 v[144:159], v[176:179], v[112:115], v[144:159]
  s_waitcnt vmcnt(6)
  v_cmp_eq_u32 vcc, -1, v119
  s_cbranch_vccnz SNB25
SRB25:
  s_waitcnt lgkmcnt(8)
  v_mfma_f32_32x32x16_bf16 v[160:175], v[180:183], v[112:115], v[160:175]
  ds_read_b64_tr_b16 v[176:177], v199 offset:26624
  ds_read_b64_tr_b16 v[178:179], v199 offset:27648
  ds_read_b64_tr_b16 v[180:181], v200 offset:26624
  ds_read_b64_tr_b16 v[182:183], v200 offset:27648
  s_waitcnt lgkmcnt(10)
  v_mfma_f32_32x32x16_bf16 v[144:159], v[184:187], v[116:119], v[144:159]
  s_waitcnt vmcnt(5)
  v_cmp_eq_u32 vcc, -1, v123
  s_cbranch_vccnz SNB26
SRB26:
  s_waitcnt lgkmcnt(8)
  v_mfma_f32_32x32x16_bf16 v[160:175], v[188:191], v[116:119], v[160:175]
  ds_read_b64_tr_b16 v[184:185], v199 offset:34816
  ds_read_b64_tr_b16 v[186:187], v199 offset:35840
  ds_read_b64_tr_b16 v[188:189], v200 offset:34816
  ds_read_b64_tr_b16 v[190:191], v200 offset:35840
  s_waitcnt lgkmcnt(10)
  v_mfma_f32_32x32x16_bf16 v[144:159], v[224:227], v[120:123], v[144:159]
  s_waitcnt vmcnt(4)
  v_cmp_eq_u32 vcc, -1, v127
  s_cbranch_vccnz SNB27
SRB27:
  s_waitcnt lgkmcnt(8)
  v_mfma_f32_32x32x16_bf16 v[160:175], v[228:231], v[120:123], v[160:175]
  ds_read_b64_tr_b16 v[224:225], v199 offset:43008
  ds_read_b64_tr_b16 v[226:227], v199 offset:44032
  ds_read_b64_tr_b16 v[228:229], v200 offset:43008
  ds_read_b64_tr_b16 v[230:231], v200 offset:44032
  s_waitcnt lgkmcnt(10)
  v_mfma_f32_32x32x16_bf16 v[144:159], v[176:179], v[124:127], v[144:159]
  s_waitcnt vmcnt(3)
  v_cmp_eq_u32 vcc, -1, v131
  s_cbranch_vccnz SNB28
SRB28:
  s_waitcnt lgkmcnt(8)
  v_mfma_f32_32x32x16_bf16 v[160:175], v[180:183], v[124:127], v[160:175]
  ds_read_b64_tr_b16 v[176:177], v199 offset:51200
  ds_read_b64_tr_b16 v[178:179], v199 offset:52224
  ds_read_b64_tr_b16 v[180:181], v200 offset:51200
  ds_read_b64_tr_b16 v[182:183], v200 offset:52224
  s_waitcnt lgkmcnt(10)
  v_mfma_f32_32x32x16_bf16 v[144:159], v[184:187], v[128:131], v[144:159]
  s_waitcnt vmcnt(2)
  v_cmp_eq_u32 vcc, -1, v135
  s_cbranch_vccnz SNB29
SRB29:
  s_waitcnt lgkmcnt(8)
  v_mfma_f32_32x32x16_bf16 v[160:175], v[188:191], v[128:131], v[160:175]
  ds_read_b64_tr_b16 v[184:185], v199 offset:59392
  ds_read_b64_tr_b16 v[186:187], v199 offset:60416
  ds_read_b64_tr_b16 v[188:189], v200 offset:59392
  ds_read_b64_tr_b16 v[190:191], v200 offset:60416
  s_waitcnt lgkmcnt(10)
  v_mfma_f32_32x32x16_bf16 v[144:159], v[224:227], v[132:135], v[144:159]
  s_waitcnt vmcnt(1)
  v_cmp_eq_u32 vcc, -1, v139
  s_cbranch_vccnz SNB30
SRB30:
  s_waitcnt lgkmcnt(8)
  v_mfma_f32_32x32x16_bf16 v[160:175], v[228:231], v[132:135], v[160:175]
  s_waitcnt lgkmcnt(6)
  v_mfma_f32_32x32x16_bf16 v[144:159], v[176:179], v[136:139], v[144:159]
  s_waitcnt vmcnt(0)
  v_cmp_eq_u32 vcc, -1, v143
  s_cbranch_vccnz SNB31
SRB31:
  s_waitcnt lgkmcnt(4)
  v_mfma_f32_32x32x16_bf16 v[160:175], v[180:183], v[136:139], v[160:175]
  s_waitcnt lgkmcnt(2)
  v_mfma_f32_32x32x16_bf16 v[144:159], v[184:187], v[140:143], v[144:159]
  s_waitcnt lgkmcnt(0)
  v_mfma_f32_32x32x16_bf16 v[160:175], v[188:191], v[140:143], v[160:175]
P3_END:
  s_nop 11
  s_mov_b32 vcc_lo, 0x55555555
  s_mov_b32 vcc_hi, 0x55555555
  v_cvt_pk_bf16_f32 v16, v144, v145
  v_cvt_pk_bf16_f32 v17, v146, v147
  v_cvt_pk_bf16_f32 v20, v148, v149
  v_cvt_pk_bf16_f32 v21, v150, v151
  v_cvt_pk_bf16_f32 v24, v152, v153
  v_cvt_pk_bf16_f32 v25, v154, v155
  v_cvt_pk_bf16_f32 v28, v156, v157
  v_cvt_pk_bf16_f32 v29, v158, v159
  v_cvt_pk_bf16_f32 v18, v160, v161
  v_cvt_pk_bf16_f32 v19, v162, v163
  v_cvt_pk_bf16_f32 v22, v164, v165
  v_cvt_pk_bf16_f32 v23, v166, v167
  v_cvt_pk_bf16_f32 v26, v168, v169
  v_cvt_pk_bf16_f32 v27, v170, v171
  v_cvt_pk_bf16_f32 v30, v172, v173
  v_cvt_pk_bf16_f32 v31, v174, v175
  s_nop 0
  v_permlane32_swap_b32 v16, v18
  v_permlane32_swap_b32 v17, v19
  v_permlane32_swap_b32 v20, v22
  v_permlane32_swap_b32 v21, v23
  v_permlane32_swap_b32 v24, v26
  v_permlane32_swap_b32 v25, v27
  v_permlane32_swap_b32 v28, v30
  v_permlane32_swap_b32 v29, v31
  v_cndmask_b32_dpp v32, v20, v16, vcc quad_perm:[1,0,3,2] row_mask:0xf bank_mask:0xf
  v_cndmask_b32_dpp v33, v21, v17, vcc quad_perm:[1,0,3,2] row_mask:0xf bank_mask:0xf
  v_cndmask_b32_dpp v34, v22, v18, vcc quad_perm:[1,0,3,2] row_mask:0xf bank_mask:0xf
  v_cndmask_b32_dpp v35, v23, v19, vcc quad_perm:[1,0,3,2] row_mask:0xf bank_mask:0xf
  v_cndmask_b32_dpp v40, v28, v24, vcc quad_perm:[1,0,3,2] row_mask:0xf bank_mask:0xf
  v_cndmask_b32_dpp v41, v29, v25, vcc quad_perm:[1,0,3,2] row_mask:0xf bank_mask:0xf
  v_cndmask_b32_dpp v42, v30, v26, vcc quad_perm:[1,0,3,2] row_mask:0xf bank_mask:0xf
  v_cndmask_b32_dpp v43, v31, v27, vcc quad_perm:[1,0,3,2] row_mask:0xf bank_mask:0xf
  s_mov_b32 vcc_lo, 0xaaaaaaaa
  s_mov_b32 vcc_hi, 0xaaaaaaaa
  v_cndmask_b32_dpp v36, v16, v20, vcc quad_perm:[1,0,3,2] row_mask:0xf bank_mask:0xf
  v_cndmask_b32_dpp v37, v17, v21, vcc quad_perm:[1,0,3,2] row_mask:0xf bank_mask:0xf
  v_cndmask_b32_dpp v38, v18, v22, vcc quad_perm:[1,0,3,2] row_mask:0xf bank_mask:0xf
  v_cndmask_b32_dpp v39, v19, v23, vcc quad_perm:[1,0,3,2] row_mask:0xf bank_mask:0xf
  v_cndmask_b32_dpp v44, v24, v28, vcc quad_perm:[1,0,3,2] row_mask:0xf bank_mask:0xf
  v_cndmask_b32_dpp v45, v25, v29, vcc quad_perm:[1,0,3,2] row_mask:0xf bank_mask:0xf
  v_cndmask_b32_dpp v46, v26, v30, vcc quad_perm:[1,0,3,2] row_mask:0xf bank_mask:0xf
  v_cndmask_b32_dpp v47, v27, v31, vcc quad_perm:[1,0,3,2] row_mask:0xf bank_mask:0xf
  s_mov_b32 vcc_lo, 0x33333333
  s_mov_b32 vcc_hi, 0x33333333
  v_cndmask_b32_dpp v16, v40, v32, vcc quad_perm:[2,3,0,1] row_mask:0xf bank_mask:0xf
  v_cndmask_b32_dpp v17, v41, v33, vcc quad_perm:[2,3,0,1] row_mask:0xf bank_mask:0xf
  v_cndmask_b32_dpp v18, v42, v34, vcc quad_perm:[2,3,0,1] row_mask:0xf bank_mask:0xf
  v_cndmask_b32_dpp v19, v43, v35, vcc quad_perm:[2,3,0,1] row_mask:0xf bank_mask:0xf
  buffer_store_dwordx4 v[16:19], v201, s[44:47], s60 offen offset:0
  v_cndmask_b32_dpp v20, v44, v36, vcc quad_perm:[2,3,0,1] row_mask:0xf bank_mask:0xf
  v_cndmask_b32_dpp v21, v45, v37, vcc quad_perm:[2,3,0,1] row_mask:0xf bank_mask:0xf
  v_cndmask_b32_dpp v22, v46, v38, vcc quad_perm:[2,3,0,1] row_mask:0xf bank_mask:0xf
  v_cndmask_b32_dpp v23, v47, v39, vcc quad_perm:[2,3,0,1] row_mask:0xf bank_mask:0xf
  buffer_store_dwordx4 v[20:23], v201, s[44:47], s60 offen offset:2048
  s_mov_b32 vcc_lo, 0xcccccccc
  s_mov_b32 vcc_hi, 0xcccccccc
  v_cndmask_b32_dpp v24, v32, v40, vcc quad_perm:[2,3,0,1] row_mask:0xf bank_mask:0xf
  v_cndmask_b32_dpp v25, v33, v41, vcc quad_perm:[2,3,0,1] row_mask:0xf bank_mask:0xf
  v_cndmask_b32_dpp v26, v34, v42, vcc quad_perm:[2,3,0,1] row_mask:0xf bank_mask:0xf
  v_cndmask_b32_dpp v27, v35, v43, vcc quad_perm:[2,3,0,1] row_mask:0xf bank_mask:0xf
  s_add_u32 s60, s60, 4096
  buffer_store_dwordx4 v[24:27], v201, s[44:47], s60 offen offset:0
  v_cndmask_b32_dpp v28, v36, v44, vcc quad_perm:[2,3,0,1] row_mask:0xf bank_mask:0xf
  v_cndmask_b32_dpp v29, v37, v45, vcc quad_perm:[2,3,0,1] row_mask:0xf bank_mask:0xf
  v_cndmask_b32_dpp v30, v38, v46, vcc quad_perm:[2,3,0,1] row_mask:0xf bank_mask:0xf
  v_cndmask_b32_dpp v31, v39, v47, vcc quad_perm:[2,3,0,1] row_mask:0xf bank_mask:0xf
  buffer_store_dwordx4 v[28:31], v201, s[44:47], s60 offen offset:2048
K_FIN:
K_END:
  s_endpgm
SNB0:
  s_sub_u32 s7, s7, 1
  s_cselect_b32 s7, 0, s7
  buffer_load_dwordx4 v[16:19], v1, s[32:35], s80 offen offset:0 sc1
  buffer_load_dwordx4 v[20:23], v1, s[32:35], s81 offen offset:0 sc1
  buffer_load_dwordx4 v[24:27], v1, s[32:35], s82 offen offset:0 sc1
  buffer_load_dwordx4 v[28:31], v1, s[32:35], s83 offen offset:0 sc1
  buffer_load_dwordx4 v[32:35], v1, s[32:35], s84 offen offset:0 sc1
  buffer_load_dwordx4 v[36:39], v1, s[32:35], s85 offen offset:0 sc1
  buffer_load_dwordx4 v[40:43], v1, s[32:35], s86 offen offset:0 sc1
  buffer_load_dwordx4 v[44:47], v1, s[32:35], s87 offen offset:0 sc1
  s_waitcnt vmcnt(0)
  v_max3_u32 v13, v19, v23, v27
  v_max3_u32 v13, v13, v31, v35
  v_max3_u32 v13, v13, v39, v43
  v_max_u32 v13, v13, v47
  v_cmp_eq_u32 vcc, -1, v13
  s_cbranch_vccz SRB0
  s_cmp_lg_u32 s7, 0
  s_cbranch_scc1 SNB0
  s_branch SRB0
SNB8:
  s_sub_u32 s7, s7, 1
  s_cselect_b32 s7, 0, s7
  buffer_load_dwordx4 v[48:51], v1, s[32:35], s80 offen offset:1024 sc1
  buffer_load_dwordx4 v[52:55], v1, s[32:35], s81 offen offset:1024 sc1
  buffer_load_dwordx4 v[56:59], v1, s[32:35], s82 offen offset:1024 sc1
  buffer_load_dwordx4 v[60:63], v1, s[32:35], s83 offen offset:1024 sc1
  buffer_load_dwordx4 v[64:67], v1, s[32:35], s84 offen offset:1024 sc1
  buffer_load_dwordx4 v[68:71], v1, s[32:35], s85 offen offset:1024 sc1
  buffer_load_dwordx4 v[72:75], v1, s[32:35], s86 offen offset:1024 sc1
  buffer_load_dwordx4 v[76:79], v1, s[32:35], s87 offen offset:1024 sc1
  s_waitcnt vmcnt(0)
  v_max3_u32 v13, v51, v55, v59
  v_max3_u32 v13, v13, v63, v67
  v_max3_u32 v13, v13, v71, v75
  v_max_u32 v13, v13, v79
  v_cmp_eq_u32 vcc, -1, v13
  s_cbranch_vccz SRB8
  s_cmp_lg_u32 s7, 0
  s_cbranch_scc1 SNB8
  s_branch SRB8
SNB16:
  s_sub_u32 s7, s7, 1
  s_cselect_b32 s7, 0, s7
  buffer_load_dwordx4 v[80:83], v1, s[32:35], s80 offen offset:2048 sc1
  buffer_load_dwordx4 v[84:87], v1, s[32:35], s81 offen offset:2048 sc1
  buffer_load_dwordx4 v[88:91], v1, s[32:35], s82 offen offset:2048 sc1
  buffer_load_dwordx4 v[92:95], v1, s[32:35], s83 offen offset:2048 sc1
  buffer_load_dwordx4 v[96:99], v1, s[32:35], s84 offen offset:2048 sc1
  buffer_load_dwordx4 v[100:103], v1, s[32:35], s85 offen offset:2048 sc1
  buffer_load_dwordx4 v[104:107], v1, s[32:35], s86 offen offset:2048 sc1
  buffer_load_dwordx4 v[108:111], v1, s[32:35], s87 offen offset:2048 sc1
  s_waitcnt vmcnt(0)
  v_max3_u32 v13, v83, v87, v91
  v_max3_u32 v13, v13, v95, v99
  v_max3_u32 v13, v13, v103, v107
  v_max_u32 v13, v13, v111
  v_cmp_eq_u32 vcc, -1, v13
  s_cbranch_vccz SRB16
  s_cmp_lg_u32 s7, 0
  s_cbranch_scc1 SNB16
  s_branch SRB16
SNB24:
  s_sub_u32 s7, s7, 1
  s_cselect_b32 s7, 0, s7
  buffer_load_dwordx4 v[112:115], v1, s[32:35], s80 offen offset:3072 sc1
  buffer_load_dwordx4 v[116:119], v1, s[32:35], s81 offen offset:3072 sc1
  buffer_load_dwordx4 v[120:123], v1, s[32:35], s82 offen offset:3072 sc1
  buffer_load_dwordx4 v[124:127], v1, s[32:35], s83 offen offset:3072 sc1
  buffer_load_dwordx4 v[128:131], v1, s[32:35], s84 offen offset:3072 sc1
  buffer_load_dwordx4 v[132:135], v1, s[32:35], s85 offen offset:3072 sc1
  buffer_load_dwordx4 v[136:139], v1, s[32:35], s86 offen offset:3072 sc1
  buffer_load_dwordx4 v[140:143], v1, s[32:35], s87 offen offset:3072 sc1
  s_waitcnt vmcnt(7)
  v_cmp_eq_u32 vcc, -1, v115
  s_cbranch_vccz SRB24
  s_cmp_lg_u32 s7, 0
  s_cbranch_scc1 SNB24
  s_branch SRB24
SNB25:
  s_sub_u32 s7, s7, 1
  s_cselect_b32 s7, 0, s7
  buffer_load_dwordx4 v[116:119], v1, s[32:35], s81 offen offset:3072 sc1
  buffer_load_dwordx4 v[120:123], v1, s[32:35], s82 offen offset:3072 sc1
  buffer_load_dwordx4 v[124:127], v1, s[32:35], s83 offen offset:3072 sc1
  buffer_load_dwordx4 v[128:131], v1, s[32:35], s84 offen offset:3072 sc1
  buffer_load_dwordx4 v[132:135], v1, s[32:35], s85 offen offset:3072 sc1
  buffer_load_dwordx4 v[136:139], v1, s[32:35], s86 offen offset:3072 sc1
  buffer_load_dwordx4 v[140:143], v1, s[32:35], s87 offen offset:3072 sc1
  s_waitcnt vmcnt(6)
  v_cmp_eq_u32 vcc, -1, v119
  s_cbranch_vccz SRB25
  s_cmp_lg_u32 s7, 0
  s_cbranch_scc1 SNB25
  s_branch SRB25
SNB26:
  s_sub_u32 s7, s7, 1
  s_cselect_b32 s7, 0, s7
  buffer_load_dwordx4 v[120:123], v1, s[32:35], s82 offen offset:3072 sc1
  buffer_load_dwordx4 v[124:127], v1, s[32:35], s83 offen offset:3072 sc1
  buffer_load_dwordx4 v[128:131], v1, s[32:35], s84 offen offset:3072 sc1
  buffer_load_dwordx4 v[132:135], v1, s[32:35], s85 offen offset:3072 sc1
  buffer_load_dwordx4 v[136:139], v1, s[32:35], s86 offen offset:3072 sc1
  buffer_load_dwordx4 v[140:143], v1, s[32:35], s87 offen offset:3072 sc1
  s_waitcnt vmcnt(5)
  v_cmp_eq_u32 vcc, -1, v123
  s_cbranch_vccz SRB26
  s_cmp_lg_u32 s7, 0
  s_cbranch_scc1 SNB26
  s_branch SRB26
SNB27:
  s_sub_u32 s7, s7, 1
  s_cselect_b32 s7, 0, s7
  buffer_load_dwordx4 v[124:127], v1, s[32:35], s83 offen offset:3072 sc1
  buffer_load_dwordx4 v[128:131], v1, s[32:35], s84 offen offset:3072 sc1
  buffer_load_dwordx4 v[132:135], v1, s[32:35], s85 offen offset:3072 sc1
  buffer_load_dwordx4 v[136:139], v1, s[32:35], s86 offen offset:3072 sc1
  buffer_load_dwordx4 v[140:143], v1, s[32:35], s87 offen offset:3072 sc1
  s_waitcnt vmcnt(4)
  v_cmp_eq_u32 vcc, -1, v127
  s_cbranch_vccz SRB27
  s_cmp_lg_u32 s7, 0
  s_cbranch_scc1 SNB27
  s_branch SRB27
SNB28:
  s_sub_u32 s7, s7, 1
  s_cselect_b32 s7, 0, s7
  buffer_load_dwordx4 v[128:131], v1, s[32:35], s84 offen offset:3072 sc1
  buffer_load_dwordx4 v[132:135], v1, s[32:35], s85 offen offset:3072 sc1
  buffer_load_dwordx4 v[136:139], v1, s[32:35], s86 offen offset:3072 sc1
  buffer_load_dwordx4 v[140:143], v1, s[32:35], s87 offen offset:3072 sc1
  s_waitcnt vmcnt(3)
  v_cmp_eq_u32 vcc, -1, v131
  s_cbranch_vccz SRB28
  s_cmp_lg_u32 s7, 0
  s_cbranch_scc1 SNB28
  s_branch SRB28
SNB29:
  s_sub_u32 s7, s7, 1
  s_cselect_b32 s7, 0, s7
  buffer_load_dwordx4 v[132:135], v1, s[32:35], s85 offen offset:3072 sc1
  buffer_load_dwordx4 v[136:139], v1, s[32:35], s86 offen offset:3072 sc1
  buffer_load_dwordx4 v[140:143], v1, s[32:35], s87 offen offset:3072 sc1
  s_waitcnt vmcnt(2)
  v_cmp_eq_u32 vcc, -1, v135
  s_cbranch_vccz SRB29
  s_cmp_lg_u32 s7, 0
  s_cbranch_scc1 SNB29
  s_branch SRB29
SNB30:
  s_sub_u32 s7, s7, 1
  s_cselect_b32 s7, 0, s7
  buffer_load_dwordx4 v[136:139], v1, s[32:35], s86 offen offset:3072 sc1
  buffer_load_dwordx4 v[140:143], v1, s[32:35], s87 offen offset:3072 sc1
  s_waitcnt vmcnt(1)
  v_cmp_eq_u32 vcc, -1, v139
  s_cbranch_vccz SRB30
  s_cmp_lg_u32 s7, 0
  s_cbranch_scc1 SNB30
  s_branch SRB30
SNB31:
  s_sub_u32 s7, s7, 1
  s_cselect_b32 s7, 0, s7
  buffer_load_dwordx4 v[140:143], v1, s[32:35], s87 offen offset:3072 sc1
  s_waitcnt vmcnt(0)
  v_cmp_eq_u32 vcc, -1, v143
  s_cbranch_vccz SRB31
  s_cmp_lg_u32 s7, 0
  s_cbranch_scc1 SNB31
  s_branch SRB31
PE17:
FMq:
  v_mfma_f32_32x32x16_bf16 v[16:31], v[236:239], v[80:83], 0
  v_mfma_f32_32x32x16_bf16 v[32:47], v[240:243], v[84:87], 0
  v_mfma_f32_32x32x16_bf16 v[48:63], v[236:239], v[88:91], 0
  v_mfma_f32_32x32x16_bf16 v[64:79], v[240:243], v[92:95], 0
  v_mfma_f32_32x32x16_bf16 v[16:31], v[244:247], v[80:83], v[16:31]
  v_mfma_f32_32x32x16_bf16 v[32:47], v[248:251], v[84:87], v[32:47]
  v_mfma_f32_32x32x16_bf16 v[48:63], v[244:247], v[88:91], v[48:63]
  v_mfma_f32_32x32x16_bf16 v[64:79], v[248:251], v[92:95], v[64:79]
  s_nop 15
  v_max3_f32 v144, v16, v17, v18
  v_max3_f32 v148, v32, v33, v34
  v_max3_f32 v152, v48, v49, v50
  v_max3_f32 v156, v64, v65, v66
  v_max3_f32 v145, v24, v25, v26
  v_max3_f32 v149, v40, v41, v42
  v_max3_f32 v153, v56, v57, v58
  v_max3_f32 v157, v72, v73, v74
  v_max3_f32 v144, v144, v19, v20
  v_max3_f32 v148, v148, v35, v36
  v_max3_f32 v152, v152, v51, v52
  v_max3_f32 v156, v156, v67, v68
  v_max3_f32 v145, v145, v27, v28
  v_max3_f32 v149, v149, v43, v44
  v_max3_f32 v153, v153, v59, v60
  v_max3_f32 v157, v157, v75, v76
  v_max3_f32 v144, v144, v21, v22
  v_max3_f32 v148, v148, v37, v38
  v_max3_f32 v152, v152, v53, v54
  v_max3_f32 v156, v156, v69, v70
  v_max3_f32 v145, v145, v29, v30
  v_max3_f32 v149, v149, v45, v46
  v_max3_f32 v153, v153, v61, v62
  v_max3_f32 v157, v157, v77, v78
  v_max_f32 v144, v144, v23
  v_max_f32 v148, v148, v39
  v_max_f32 v152, v152, v55
  v_max_f32 v156, v156, v71
  v_max_f32 v145, v145, v31
  v_max_f32 v149, v149, v47
  v_max_f32 v153, v153, v63
  v_max_f32 v157, v157, v79
  v_permlane32_swap_b32 v144, v145
  v_permlane32_swap_b32 v148, v149
  v_permlane32_swap_b32 v152, v153
  v_permlane32_swap_b32 v156, v157
  v_max_f32 v144, v144, v145
  v_max_f32 v148, v148, v149
  v_max_f32 v152, v152, v153
  v_max_f32 v156, v156, v157
  v_mov_b32 v145, v144
  v_mov_b32 v149, v148
  v_mov_b32 v153, v152
  v_mov_b32 v157, v156
  v_permlane32_swap_b32 v144, v145
  v_permlane32_swap_b32 v148, v149
  v_permlane32_swap_b32 v152, v153
  v_permlane32_swap_b32 v156, v157
  v_sub_f32 v16, v16, v144
  v_sub_f32 v32, v32, v148
  v_sub_f32 v48, v48, v152
  v_sub_f32 v64, v64, v156
  v_sub_f32 v17, v17, v144
  v_sub_f32 v33, v33, v148
  v_sub_f32 v49, v49, v152
  v_sub_f32 v65, v65, v156
  v_sub_f32 v18, v18, v144
  v_sub_f32 v34, v34, v148
  v_sub_f32 v50, v50, v152
  v_sub_f32 v66, v66, v156
  v_sub_f32 v19, v19, v144
  v_sub_f32 v35, v35, v148
  v_sub_f32 v51, v51, v152
  v_sub_f32 v67, v67, v156
  v_sub_f32 v20, v20, v144
  v_sub_f32 v36, v36, v148
  v_sub_f32 v52, v52, v152
  v_sub_f32 v68, v68, v156
  v_sub_f32 v21, v21, v144
  v_sub_f32 v37, v37, v148
  v_sub_f32 v53, v53, v152
  v_sub_f32 v69, v69, v156
  v_sub_f32 v22, v22, v144
  v_sub_f32 v38, v38, v148
  v_sub_f32 v54, v54, v152
  v_sub_f32 v70, v70, v156
  v_sub_f32 v23, v23, v144
  v_sub_f32 v39, v39, v148
  v_sub_f32 v55, v55, v152
  v_sub_f32 v71, v71, v156
  v_sub_f32 v24, v24, v145
  v_sub_f32 v40, v40, v149
  v_sub_f32 v56, v56, v153
  v_sub_f32 v72, v72, v157
  v_sub_f32 v25, v25, v145
  v_sub_f32 v41, v41, v149
  v_sub_f32 v57, v57, v153
  v_sub_f32 v73, v73, v157
  v_sub_f32 v26, v26, v145
  v_sub_f32 v42, v42, v149
  v_sub_f32 v58, v58, v153
  v_sub_f32 v74, v74, v157
  v_sub_f32 v27, v27, v145
  v_sub_f32 v43, v43, v149
  v_sub_f32 v59, v59, v153
  v_sub_f32 v75, v75, v157
  v_sub_f32 v28, v28, v145
  v_sub_f32 v44, v44, v149
  v_sub_f32 v60, v60, v153
  v_sub_f32 v76, v76, v157
  v_sub_f32 v29, v29, v145
  v_sub_f32 v45, v45, v149
  v_sub_f32 v61, v61, v153
  v_sub_f32 v77, v77, v157
  v_sub_f32 v30, v30, v145
  v_sub_f32 v46, v46, v149
  v_sub_f32 v62, v62, v153
  v_sub_f32 v78, v78, v157
  v_sub_f32 v31, v31, v145
  v_sub_f32 v47, v47, v149
  v_sub_f32 v63, v63, v153
  v_sub_f32 v79, v79, v157
  v_exp_f32 v16, v16
  v_exp_f32 v32, v32
  v_exp_f32 v48, v48
  v_exp_f32 v64, v64
  v_exp_f32 v17, v17
  v_exp_f32 v33, v33
  v_exp_f32 v49, v49
  v_exp_f32 v65, v65
  v_exp_f32 v18, v18
  v_exp_f32 v34, v34
  v_exp_f32 v50, v50
  v_exp_f32 v66, v66
  v_exp_f32 v19, v19
  v_exp_f32 v35, v35
  v_exp_f32 v51, v51
  v_exp_f32 v67, v67
  v_exp_f32 v20, v20
  v_exp_f32 v36, v36
  v_exp_f32 v52, v52
  v_exp_f32 v68, v68
  v_exp_f32 v21, v21
  v_exp_f32 v37, v37
  v_exp_f32 v53, v53
  v_exp_f32 v69, v69
  v_exp_f32 v22, v22
  v_exp_f32 v38, v38
  v_exp_f32 v54, v54
  v_exp_f32 v70, v70
  v_exp_f32 v23, v23
  v_exp_f32 v39, v39
  v_exp_f32 v55, v55
  v_exp_f32 v71, v71
  v_exp_f32 v24, v24
  v_exp_f32 v40, v40
  v_exp_f32 v56, v56
  v_exp_f32 v72, v72
  v_exp_f32 v25, v25
  v_exp_f32 v41, v41
  v_exp_f32 v57, v57
  v_exp_f32 v73, v73
  v_exp_f32 v26, v26
  v_exp_f32 v42, v42
  v_exp_f32 v58, v58
  v_exp_f32 v74, v74
  v_exp_f32 v27, v27
  v_exp_f32 v43, v43
  v_exp_f32 v59, v59
  v_exp_f32 v75, v75
  v_exp_f32 v28, v28
  v_exp_f32 v44, v44
  v_exp_f32 v60, v60
  v_exp_f32 v76, v76
  v_exp_f32 v29, v29
  v_exp_f32 v45, v45
  v_exp_f32 v61, v61
  v_exp_f32 v77, v77
  v_exp_f32 v30, v30
  v_exp_f32 v46, v46
  v_exp_f32 v62, v62
  v_exp_f32 v78, v78
  v_exp_f32 v31, v31
  v_exp_f32 v47, v47
  v_exp_f32 v63, v63
  v_exp_f32 v79, v79
  v_add_f32 v144, v16, v18
  v_add_f32 v148, v32, v34
  v_add_f32 v152, v48, v50
  v_add_f32 v156, v64, v66
  v_add_f32 v145, v17, v19
  v_add_f32 v149, v33, v35
  v_add_f32 v153, v49, v51
  v_add_f32 v157, v65, v67
  v_add_f32 v146, v24, v26
  v_add_f32 v150, v40, v42
  v_add_f32 v154, v56, v58
  v_add_f32 v158, v72, v74
  v_add_f32 v147, v25, v27
  v_add_f32 v151, v41, v43
  v_add_f32 v155, v57, v59
  v_add_f32 v159, v73, v75
  v_add_f32 v144, v144, v20
  v_add_f32 v148, v148, v36
  v_add_f32 v152, v152, v52
  v_add_f32 v156, v156, v68
  v_add_f32 v145, v145, v21
  v_add_f32 v149, v149, v37
  v_add_f32 v153, v153, v53
  v_add_f32 v157, v157, v69
  v_add_f32 v146, v146, v28
  v_add_f32 v150, v150, v44
  v_add_f32 v154, v154, v60
  v_add_f32 v158, v158, v76
  v_add_f32 v147, v147, v29
  v_add_f32 v151, v151, v45
  v_add_f32 v155, v155, v61
  v_add_f32 v159, v159, v77
  v_add_f32 v144, v144, v22
  v_add_f32 v148, v148, v38
  v_add_f32 v152, v152, v54
  v_add_f32 v156, v156, v70
  v_add_f32 v145, v145, v23
  v_add_f32 v149, v149, v39
  v_add_f32 v153, v153, v55
  v_add_f32 v157, v157, v71
  v_add_f32 v146, v146, v30
  v_add_f32 v150, v150, v46
  v_add_f32 v154, v154, v62
  v_add_f32 v158, v158, v78
  v_add_f32 v147, v147, v31
  v_add_f32 v151, v151, v47
  v_add_f32 v155, v155, v63
  v_add_f32 v159, v159, v79
  v_add_f32 v144, v144, v145
  v_add_f32 v148, v148, v149
  v_add_f32 v152, v152, v153
  v_add_f32 v156, v156, v157
  v_add_f32 v145, v146, v147
  v_add_f32 v149, v150, v151
  v_add_f32 v153, v154, v155
  v_add_f32 v157, v158, v159
  v_permlane32_swap_b32 v144, v145
  v_permlane32_swap_b32 v148, v149
  v_permlane32_swap_b32 v152, v153
  v_permlane32_swap_b32 v156, v157
  v_add_f32 v144, v144, v145
  v_add_f32 v148, v148, v149
  v_add_f32 v152, v152, v153
  v_add_f32 v156, v156, v157
  s_branch FMDq
OS_A:
  v_add_f32 v144, 0x358637bd, v24
  v_rcp_f32 v144, v144
  v_mfma_f32_32x32x16_bf16 v[48:63], v[172:175], v[128:131], 0
  v_mul_f32 v16, v16, v144
  v_mul_f32 v17, v17, v144
  v_mul_f32 v18, v18, v144
  v_mul_f32 v19, v19, v144
  v_mul_f32 v20, v20, v144
  v_mfma_f32_32x32x16_bf16 v[48:63], v[176:179], v[132:135], v[48:63]
  v_mul_f32 v21, v21, v144
  v_mul_f32 v22, v22, v144
  v_mul_f32 v23, v23, v144
  v_cvt_pk_bf16_f32 v80, v16, v17
  v_cvt_pk_bf16_f32 v81, v18, v19
  v_cvt_pk_bf16_f32 v82, v20, v21
  v_cvt_pk_bf16_f32 v83, v22, v23
  buffer_store_dwordx4 v[80:83], v1, s[32:35], s12 offen offset:0 sc1
  v_add_f32 v144, 0x358637bd, v40
  v_rcp_f32 v144, v144
  v_mfma_f32_32x32x16_bf16 v[64:79], v[184:187], v[136:139], 0
  v_mul_f32 v32, v32, v144
  v_mul_f32 v33, v33, v144
  v_mul_f32 v34, v34, v144
  v_mul_f32 v35, v35, v144
  v_mul_f32 v36, v36, v144
  v_mfma_f32_32x32x16_bf16 v[64:79], v[188:191], v[140:143], v[64:79]
  v_mul_f32 v37, v37, v144
  v_mul_f32 v38, v38, v144
  v_mul_f32 v39, v39, v144
  v_cvt_pk_bf16_f32 v84, v32, v33
  v_cvt_pk_bf16_f32 v85, v34, v35
  v_cvt_pk_bf16_f32 v86, v36, v37
  v_cvt_pk_bf16_f32 v87, v38, v39
  buffer_store_dwordx4 v[84:87], v1, s[32:35], s12 offen offset:1024 sc1
  v_add_f32 v144, 0x358637bd, v56
  v_rcp_f32 v144, v144
  s_nop 0
  v_mul_f32 v48, v48, v144
  v_mul_f32 v49, v49, v144
  v_mul_f32 v50, v50, v144
  v_mul_f32 v51, v51, v144
  v_mul_f32 v52, v52, v144
  v_mul_f32 v53, v53, v144
  v_mul_f32 v54, v54, v144
  v_mul_f32 v55, v55, v144
  v_cvt_pk_bf16_f32 v88, v48, v49
  v_cvt_pk_bf16_f32 v89, v50, v51
  v_cvt_pk_bf16_f32 v90, v52, v53
  v_cvt_pk_bf16_f32 v91, v54, v55
  buffer_store_dwordx4 v[88:91], v1, s[32:35], s13 offen offset:0 sc1
  v_add_f32 v144, 0x358637bd, v72
  v_rcp_f32 v144, v144
  s_nop 0
  v_mul_f32 v64, v64, v144
  v_mul_f32 v65, v65, v144
  v_mul_f32 v66, v66, v144
  v_mul_f32 v67, v67, v144
  v_mul_f32 v68, v68, v144
  v_mul_f32 v69, v69, v144
  v_mul_f32 v70, v70, v144
  v_mul_f32 v71, v71, v144
  v_cvt_pk_bf16_f32 v92, v64, v65
  v_cvt_pk_bf16_f32 v93, v66, v67
  v_cvt_pk_bf16_f32 v94, v68, v69
  v_cvt_pk_bf16_f32 v95, v70, v71
  buffer_store_dwordx4 v[92:95], v1, s[32:35], s13 offen offset:1024 sc1
  s_branch OS_B
DU_A2:
  buffer_store_dword v253, v171, s[32:35], s14 offen sc1
  s_branch DU_B2
FMk:
  v_mfma_f32_32x32x16_bf16 v[220:235], v[240:243], v[180:183], 0
  v_mfma_f32_32x32x16_bf16 v[220:235], v[248:251], v[180:183], v[220:235]
  v_mfma_f32_32x32x16_bf16 v[192:207], v[240:243], v[188:191], 0
  v_mfma_f32_32x32x16_bf16 v[192:207], v[248:251], v[188:191], v[192:207]
  s_nop 15
  v_max3_f32 v84, v220, v221, v222
  v_max3_f32 v92, v192, v193, v194
  v_max3_f32 v85, v228, v229, v230
  v_max3_f32 v93, v200, v201, v202
  v_max3_f32 v84, v84, v223, v224
  v_max3_f32 v92, v92, v195, v196
  v_max3_f32 v85, v85, v231, v232
  v_max3_f32 v93, v93, v203, v204
  v_max3_f32 v84, v84, v225, v226
  v_max3_f32 v92, v92, v197, v198
  v_max3_f32 v85, v85, v233, v234
  v_max3_f32 v93, v93, v205, v206
  v_max_f32 v84, v84, v227
  v_max_f32 v92, v92, v199
  v_max_f32 v85, v85, v235
  v_max_f32 v93, v93, v207
  s_nop 0
  v_permlane32_swap_b32 v84, v85
  v_permlane32_swap_b32 v92, v93
  s_nop 0
  v_max_f32 v84, v84, v85
  v_max_f32 v92, v92, v93
  v_mov_b32 v85, v84
  v_mov_b32 v93, v92
  s_nop 0
  v_permlane32_swap_b32 v84, v85
  v_permlane32_swap_b32 v92, v93
  s_nop 0
  v_sub_f32 v220, v220, v84
  v_sub_f32 v192, v192, v92
  v_sub_f32 v221, v221, v84
  v_sub_f32 v193, v193, v92
  v_sub_f32 v222, v222, v84
  v_sub_f32 v194, v194, v92
  v_sub_f32 v223, v223, v84
  v_sub_f32 v195, v195, v92
  v_sub_f32 v224, v224, v84
  v_sub_f32 v196, v196, v92
  v_sub_f32 v225, v225, v84
  v_sub_f32 v197, v197, v92
  v_sub_f32 v226, v226, v84
  v_sub_f32 v198, v198, v92
  v_sub_f32 v227, v227, v84
  v_sub_f32 v199, v199, v92
  v_sub_f32 v228, v228, v85
  v_sub_f32 v200, v200, v93
  v_sub_f32 v229, v229, v85
  v_sub_f32 v201, v201, v93
  v_sub_f32 v230, v230, v85
  v_sub_f32 v202, v202, v93
  v_sub_f32 v231, v231, v85
  v_sub_f32 v203, v203, v93
  v_sub_f32 v232, v232, v85
  v_sub_f32 v204, v204, v93
  v_sub_f32 v233, v233, v85
  v_sub_f32 v205, v205, v93
  v_sub_f32 v234, v234, v85
  v_sub_f32 v206, v206, v93
  v_sub_f32 v235, v235, v85
  v_sub_f32 v207, v207, v93
  v_exp_f32 v220, v220
  v_exp_f32 v192, v192
  v_exp_f32 v221, v221
  v_exp_f32 v193, v193
  v_exp_f32 v222, v222
  v_exp_f32 v194, v194
  v_exp_f32 v223, v223
  v_exp_f32 v195, v195
  v_exp_f32 v224, v224
  v_exp_f32 v196, v196
  v_exp_f32 v225, v225
  v_exp_f32 v197, v197
  v_exp_f32 v226, v226
  v_exp_f32 v198, v198
  v_exp_f32 v227, v227
  v_exp_f32 v199, v199
  v_exp_f32 v228, v228
  v_exp_f32 v200, v200
  v_exp_f32 v229, v229
  v_exp_f32 v201, v201
  v_exp_f32 v230, v230
  v_exp_f32 v202, v202
  v_exp_f32 v231, v231
  v_exp_f32 v203, v203
  v_exp_f32 v232, v232
  v_exp_f32 v204, v204
  v_exp_f32 v233, v233
  v_exp_f32 v205, v205
  v_exp_f32 v234, v234
  v_exp_f32 v206, v206
  v_exp_f32 v235, v235
  v_exp_f32 v207, v207
  v_add_f32 v84, v220, v222
  v_add_f32 v92, v192, v194
  v_add_f32 v85, v221, v223
  v_add_f32 v93, v193, v195
  v_add_f32 v86, v228, v230
  v_add_f32 v94, v200, v202
  v_add_f32 v87, v229, v231
  v_add_f32 v95, v201, v203
  v_add_f32 v84, v84, v224
  v_add_f32 v92, v92, v196
  v_add_f32 v85, v85, v225
  v_add_f32 v93, v93, v197
  v_add_f32 v86, v86, v232
  v_add_f32 v94, v94, v204
  v_add_f32 v87, v87, v233
  v_add_f32 v95, v95, v205
  v_add_f32 v84, v84, v226
  v_add_f32 v92, v92, v198
  v_add_f32 v85, v85, v227
  v_add_f32 v93, v93, v199
  v_add_f32 v86, v86, v234
  v_add_f32 v94, v94, v206
  v_add_f32 v87, v87, v235
  v_add_f32 v95, v95, v207
  v_add_f32 v84, v84, v85
  v_add_f32 v92, v92, v93
  v_add_f32 v85, v86, v87
  v_add_f32 v93, v94, v95
  s_nop 0
  v_permlane32_swap_b32 v84, v85
  v_permlane32_swap_b32 v92, v93
  s_nop 0
  v_add_f32 v84, v84, v85
  v_add_f32 v92, v92, v93
  s_branch FMDk
FMl:
  v_mfma_f32_32x32x16_bf16 v[112:127], v[236:239], v[176:179], 0
  v_mfma_f32_32x32x16_bf16 v[112:127], v[244:247], v[176:179], v[112:127]
  v_mfma_f32_32x32x16_bf16 v[144:159], v[236:239], v[184:187], 0
  v_mfma_f32_32x32x16_bf16 v[144:159], v[244:247], v[184:187], v[144:159]
  s_nop 15
  v_max3_f32 v80, v112, v113, v114
  v_max3_f32 v88, v144, v145, v146
  v_max3_f32 v81, v120, v121, v122
  v_max3_f32 v89, v152, v153, v154
  v_max3_f32 v80, v80, v115, v116
  v_max3_f32 v88, v88, v147, v148
  v_max3_f32 v81, v81, v123, v124
  v_max3_f32 v89, v89, v155, v156
  v_max3_f32 v80, v80, v117, v118
  v_max3_f32 v88, v88, v149, v150
  v_max3_f32 v81, v81, v125, v126
  v_max3_f32 v89, v89, v157, v158
  v_max_f32 v80, v80, v119
  v_max_f32 v88, v88, v151
  v_max_f32 v81, v81, v127
  v_max_f32 v89, v89, v159
  s_nop 0
  v_permlane32_swap_b32 v80, v81
  v_permlane32_swap_b32 v88, v89
  s_nop 0
  v_max_f32 v80, v80, v81
  v_max_f32 v88, v88, v89
  v_mov_b32 v81, v80
  v_mov_b32 v89, v88
  s_nop 0
  v_permlane32_swap_b32 v80, v81
  v_permlane32_swap_b32 v88, v89
  s_nop 0
  v_sub_f32 v112, v112, v80
  v_sub_f32 v144, v144, v88
  v_sub_f32 v113, v113, v80
  v_sub_f32 v145, v145, v88
  v_sub_f32 v114, v114, v80
  v_sub_f32 v146, v146, v88
  v_sub_f32 v115, v115, v80
  v_sub_f32 v147, v147, v88
  v_sub_f32 v116, v116, v80
  v_sub_f32 v148, v148, v88
  v_sub_f32 v117, v117, v80
  v_sub_f32 v149, v149, v88
  v_sub_f32 v118, v118, v80
  v_sub_f32 v150, v150, v88
  v_sub_f32 v119, v119, v80
  v_sub_f32 v151, v151, v88
  v_sub_f32 v120, v120, v81
  v_sub_f32 v152, v152, v89
  v_sub_f32 v121, v121, v81
  v_sub_f32 v153, v153, v89
  v_sub_f32 v122, v122, v81
  v_sub_f32 v154, v154, v89
  v_sub_f32 v123, v123, v81
  v_sub_f32 v155, v155, v89
  v_sub_f32 v124, v124, v81
  v_sub_f32 v156, v156, v89
  v_sub_f32 v125, v125, v81
  v_sub_f32 v157, v157, v89
  v_sub_f32 v126, v126, v81
  v_sub_f32 v158, v158, v89
  v_sub_f32 v127, v127, v81
  v_sub_f32 v159, v159, v89
  v_exp_f32 v112, v112
  v_exp_f32 v144, v144
  v_exp_f32 v113, v113
  v_exp_f32 v145, v145
  v_exp_f32 v114, v114
  v_exp_f32 v146, v146
  v_exp_f32 v115, v115
  v_exp_f32 v147, v147
  v_exp_f32 v116, v116
  v_exp_f32 v148, v148
  v_exp_f32 v117, v117
  v_exp_f32 v149, v149
  v_exp_f32 v118, v118
  v_exp_f32 v150, v150
  v_exp_f32 v119, v119
  v_exp_f32 v151, v151
  v_exp_f32 v120, v120
  v_exp_f32 v152, v152
  v_exp_f32 v121, v121
  v_exp_f32 v153, v153
  v_exp_f32 v122, v122
  v_exp_f32 v154, v154
  v_exp_f32 v123, v123
  v_exp_f32 v155, v155
  v_exp_f32 v124, v124
  v_exp_f32 v156, v156
  v_exp_f32 v125, v125
  v_exp_f32 v157, v157
  v_exp_f32 v126, v126
  v_exp_f32 v158, v158
  v_exp_f32 v127, v127
  v_exp_f32 v159, v159
  v_add_f32 v80, v112, v114
  v_add_f32 v88, v144, v146
  v_add_f32 v81, v113, v115
  v_add_f32 v89, v145, v147
  v_add_f32 v82, v120, v122
  v_add_f32 v90, v152, v154
  v_add_f32 v83, v121, v123
  v_add_f32 v91, v153, v155
  v_add_f32 v80, v80, v116
  v_add_f32 v88, v88, v148
  v_add_f32 v81, v81, v117
  v_add_f32 v89, v89, v149
  v_add_f32 v82, v82, v124
  v_add_f32 v90, v90, v156
  v_add_f32 v83, v83, v125
  v_add_f32 v91, v91, v157
  v_add_f32 v80, v80, v118
  v_add_f32 v88, v88, v150
  v_add_f32 v81, v81, v119
  v_add_f32 v89, v89, v151
  v_add_f32 v82, v82, v126
  v_add_f32 v90, v90, v158
  v_add_f32 v83, v83, v127
  v_add_f32 v91, v91, v159
  v_add_f32 v80, v80, v81
  v_add_f32 v88, v88, v89
  v_add_f32 v81, v82, v83
  v_add_f32 v89, v90, v91
  s_nop 0
  v_permlane32_swap_b32 v80, v81
  v_permlane32_swap_b32 v88, v89
  s_nop 0
  v_add_f32 v80, v80, v81
  v_add_f32 v88, v88, v89
  s_branch FMDl
DU_A5:
  buffer_store_dwordx4 v[144:147], v210, s[32:35], s16 offen sc1
  s_branch DU_B5
FB0:
  s_waitcnt vmcnt(0) lgkmcnt(0)
  v_mov_b32 v2, 0
  v_mov_b32 v3, 0xff800000
  s_mov_b32 s66, 0
  s_xor_b32 s64, s74, 0
  s_lshl2_add_u32 s5, s21, s64
  s_sub_i32 s65, 8, s5
  s_max_i32 s65, s65, 0
  s_add_u32 s64, s64, s65
  s_lshl_b32 s64, s64, 10
  s_add_u32 s64, s64, 0
  v_mov_b32 v48, 0x3f803f80
  v_mov_b32 v49, 0x3f803f80
  v_mov_b32 v50, 0x3f803f80
  v_mov_b32 v51, 0x3f803f80
  v_mov_b32 v52, 0x3f803f80
  v_mov_b32 v53, 0x3f803f80
  v_mov_b32 v54, 0x3f803f80
  v_mov_b32 v55, 0x3f803f80
  v_mov_b32 v128, 0
  v_mov_b32 v129, 0
  v_mov_b32 v130, 0
  v_mov_b32 v131, 0
  v_mov_b32 v132, 0
  v_mov_b32 v133, 0
  v_mov_b32 v134, 0
  v_mov_b32 v135, 0
  v_mov_b32 v136, 0
  v_mov_b32 v137, 0
  v_mov_b32 v138, 0
  v_mov_b32 v139, 0
  v_mov_b32 v140, 0
  v_mov_b32 v141, 0
  v_mov_b32 v142, 0
  v_mov_b32 v143, 0
FBP0:
  s_mov_b32 s67, s65
  v_add_u32 v4, s64, v192
  v_add_u32 v5, s64, v193
FBL0:
  ds_read_b128 v[10:13], v4
  s_mov_b64 exec, s[58:59]
  ds_read_b128 v[48:51], v5
  ds_read_b128 v[52:55], v5 offset:512
  s_mov_b64 exec, -1
  v_mov_b32 v16, v2
  v_mov_b32 v17, v2
  v_mov_b32 v18, v2
  v_mov_b32 v19, v2
  v_mov_b32 v20, v2
  v_mov_b32 v21, v2
  v_mov_b32 v22, v2
  v_mov_b32 v23, v2
  v_mov_b32 v24, v2
  v_mov_b32 v25, v2
  v_mov_b32 v26, v2
  v_mov_b32 v27, v2
  v_mov_b32 v28, v2
  v_mov_b32 v29, v2
  v_mov_b32 v30, v2
  v_mov_b32 v31, v2
  s_cmp_lg_u32 s67, 0
  s_cbranch_scc1 FB10
  v_add_f32 v16, v2, v236
  v_add_f32 v17, v2, v237
  v_add_f32 v18, v2, v238
  v_add_f32 v19, v2, v239
  v_add_f32 v20, v2, v240
  v_add_f32 v21, v2, v241
  v_add_f32 v22, v2, v242
  v_add_f32 v23, v2, v243
  v_add_f32 v24, v2, v244
  v_add_f32 v25, v2, v245
  v_add_f32 v26, v2, v246
  v_add_f32 v27, v2, v247
  v_add_f32 v28, v2, v248
  v_add_f32 v29, v2, v249
  v_add_f32 v30, v2, v250
  v_add_f32 v31, v2, v251
FB10:
  s_cmp_lg_u32 s67, 8
  s_cbranch_scc1 FB20
  v_add_f32 v16, v2, v220
  v_add_f32 v17, v2, v221
  v_add_f32 v18, v2, v222
  v_add_f32 v19, v2, v223
  v_add_f32 v20, v2, v224
  v_add_f32 v21, v2, v225
  v_add_f32 v22, v2, v226
  v_add_f32 v23, v2, v227
  v_add_f32 v24, v2, v228
  v_add_f32 v25, v2, v229
  v_add_f32 v26, v2, v230
  v_add_f32 v27, v2, v231
  v_add_f32 v28, v2, v232
  v_add_f32 v29, v2, v233
  v_add_f32 v30, v2, v234
  v_add_f32 v31, v2, v235
FB20:
  s_waitcnt lgkmcnt(0)
  s_nop 1
  v_mfma_f32_32x32x16_bf16 v[32:47], v[10:13], v[64:67], v[16:31]
  s_nop 15
  s_nop 3
  s_cmp_lg_u32 s66, 0
  s_cbranch_scc1 FB30
  v_max3_f32 v3, v3, v32, v33
  v_max3_f32 v3, v3, v34, v35
  v_max3_f32 v3, v3, v36, v37
  v_max3_f32 v3, v3, v38, v39
  v_max3_f32 v3, v3, v40, v41
  v_max3_f32 v3, v3, v42, v43
  v_max3_f32 v3, v3, v44, v45
  v_max3_f32 v3, v3, v46, v47
  s_branch FB40
FB30:
  v_exp_f32 v32, v32
  v_exp_f32 v33, v33
  v_exp_f32 v34, v34
  v_exp_f32 v35, v35
  v_exp_f32 v36, v36
  v_exp_f32 v37, v37
  v_exp_f32 v38, v38
  v_exp_f32 v39, v39
  v_exp_f32 v40, v40
  v_exp_f32 v41, v41
  v_exp_f32 v42, v42
  v_exp_f32 v43, v43
  v_exp_f32 v44, v44
  v_exp_f32 v45, v45
  v_exp_f32 v46, v46
  v_exp_f32 v47, v47
  s_nop 0
  v_cvt_pk_bf16_f32 v160, v32, v33
  v_cvt_pk_bf16_f32 v161, v34, v35
  v_cvt_pk_bf16_f32 v162, v36, v37
  v_cvt_pk_bf16_f32 v163, v38, v39
  v_cvt_pk_bf16_f32 v164, v40, v41
  v_cvt_pk_bf16_f32 v165, v42, v43
  v_cvt_pk_bf16_f32 v166, v44, v45
  v_cvt_pk_bf16_f32 v167, v46, v47
  s_nop 1
  v_mfma_f32_32x32x16_bf16 v[128:143], v[48:51], v[160:163], v[128:143]
  v_mfma_f32_32x32x16_bf16 v[128:143], v[52:55], v[164:167], v[128:143]
  s_nop 15
  s_nop 3
FB40:
  v_add_u32 v4, 1024, v4
  v_add_u32 v5, 1024, v5
  s_add_u32 s67, s67, 1
  s_cmp_le_u32 s67, 8
  s_cbranch_scc1 FBL0
  s_cmp_lg_u32 s66, 0
  s_cbranch_scc1 FBR0
  s_mov_b32 s66, 1
  v_mov_b32 v2, v3
  s_nop 1
  v_permlane32_swap_b32 v2, v3
  s_nop 1
  v_max_f32 v2, v2, v3
  v_sub_f32 v2, 0, v2
  s_branch FBP0
FBR0:
  s_andn2_b32 s5, 4, s23
  s_add_u32 s5, s5, s74
  s_cmp_eq_u32 s5, 0
  s_cbranch_scc1 FBDa0
  s_cmp_eq_u32 s5, 1
  s_cbranch_scc1 FBDa1
  s_cmp_eq_u32 s5, 2
  s_cbranch_scc1 FBDa2
  s_cmp_eq_u32 s5, 3
  s_cbranch_scc1 FBDa3
  s_cmp_eq_u32 s5, 4
  s_cbranch_scc1 FBDa4
  s_cmp_eq_u32 s5, 5
  s_cbranch_scc1 FBDa5
  s_cmp_eq_u32 s5, 6
  s_cbranch_scc1 FBDa6
  s_branch FBDa7
FB1:
  s_waitcnt vmcnt(0) lgkmcnt(0)
  v_mov_b32 v2, 0
  v_mov_b32 v3, 0xff800000
  s_mov_b32 s66, 0
  s_xor_b32 s64, s74, 3
  s_lshl2_add_u32 s5, s21, s64
  s_sub_i32 s65, 8, s5
  s_max_i32 s65, s65, 0
  s_add_u32 s64, s64, s65
  s_lshl_b32 s64, s64, 10
  s_add_u32 s64, s64, 12288
  v_mov_b32 v48, 0x3f803f80
  v_mov_b32 v49, 0x3f803f80
  v_mov_b32 v50, 0x3f803f80
  v_mov_b32 v51, 0x3f803f80
  v_mov_b32 v52, 0x3f803f80
  v_mov_b32 v53, 0x3f803f80
  v_mov_b32 v54, 0x3f803f80
  v_mov_b32 v55, 0x3f803f80
  v_mov_b32 v144, 0
  v_mov_b32 v145, 0
  v_mov_b32 v146, 0
  v_mov_b32 v147, 0
  v_mov_b32 v148, 0
  v_mov_b32 v149, 0
  v_mov_b32 v150, 0
  v_mov_b32 v151, 0
  v_mov_b32 v152, 0
  v_mov_b32 v153, 0
  v_mov_b32 v154, 0
  v_mov_b32 v155, 0
  v_mov_b32 v156, 0
  v_mov_b32 v157, 0
  v_mov_b32 v158, 0
  v_mov_b32 v159, 0
FBP1:
  s_mov_b32 s67, s65
  v_add_u32 v4, s64, v192
  v_add_u32 v5, s64, v193
FBL1:
  ds_read_b128 v[10:13], v4
  s_mov_b64 exec, s[58:59]
  ds_read_b128 v[48:51], v5
  ds_read_b128 v[52:55], v5 offset:512
  s_mov_b64 exec, -1
  v_mov_b32 v16, v2
  v_mov_b32 v17, v2
  v_mov_b32 v18, v2
  v_mov_b32 v19, v2
  v_mov_b32 v20, v2
  v_mov_b32 v21, v2
  v_mov_b32 v22, v2
  v_mov_b32 v23, v2
  v_mov_b32 v24, v2
  v_mov_b32 v25, v2
  v_mov_b32 v26, v2
  v_mov_b32 v27, v2
  v_mov_b32 v28, v2
  v_mov_b32 v29, v2
  v_mov_b32 v30, v2
  v_mov_b32 v31, v2
  s_cmp_lg_u32 s67, 0
  s_cbranch_scc1 FB11
  v_add_f32 v16, v2, v236
  v_add_f32 v17, v2, v237
  v_add_f32 v18, v2, v238
  v_add_f32 v19, v2, v239
  v_add_f32 v20, v2, v240
  v_add_f32 v21, v2, v241
  v_add_f32 v22, v2, v242
  v_add_f32 v23, v2, v243
  v_add_f32 v24, v2, v244
  v_add_f32 v25, v2, v245
  v_add_f32 v26, v2, v246
  v_add_f32 v27, v2, v247
  v_add_f32 v28, v2, v248
  v_add_f32 v29, v2, v249
  v_add_f32 v30, v2, v250
  v_add_f32 v31, v2, v251
FB11:
  s_cmp_lg_u32 s67, 8
  s_cbranch_scc1 FB21
  v_add_f32 v16, v2, v220
  v_add_f32 v17, v2, v221
  v_add_f32 v18, v2, v222
  v_add_f32 v19, v2, v223
  v_add_f32 v20, v2, v224
  v_add_f32 v21, v2, v225
  v_add_f32 v22, v2, v226
  v_add_f32 v23, v2, v227
  v_add_f32 v24, v2, v228
  v_add_f32 v25, v2, v229
  v_add_f32 v26, v2, v230
  v_add_f32 v27, v2, v231
  v_add_f32 v28, v2, v232
  v_add_f32 v29, v2, v233
  v_add_f32 v30, v2, v234
  v_add_f32 v31, v2, v235
FB21:
  s_waitcnt lgkmcnt(0)
  s_nop 1
  v_mfma_f32_32x32x16_bf16 v[32:47], v[10:13], v[68:71], v[16:31]
  s_nop 15
  s_nop 3
  s_cmp_lg_u32 s66, 0
  s_cbranch_scc1 FB31
  v_max3_f32 v3, v3, v32, v33
  v_max3_f32 v3, v3, v34, v35
  v_max3_f32 v3, v3, v36, v37
  v_max3_f32 v3, v3, v38, v39
  v_max3_f32 v3, v3, v40, v41
  v_max3_f32 v3, v3, v42, v43
  v_max3_f32 v3, v3, v44, v45
  v_max3_f32 v3, v3, v46, v47
  s_branch FB41
FB31:
  v_exp_f32 v32, v32
  v_exp_f32 v33, v33
  v_exp_f32 v34, v34
  v_exp_f32 v35, v35
  v_exp_f32 v36, v36
  v_exp_f32 v37, v37
  v_exp_f32 v38, v38
  v_exp_f32 v39, v39
  v_exp_f32 v40, v40
  v_exp_f32 v41, v41
  v_exp_f32 v42, v42
  v_exp_f32 v43, v43
  v_exp_f32 v44, v44
  v_exp_f32 v45, v45
  v_exp_f32 v46, v46
  v_exp_f32 v47, v47
  s_nop 0
  v_cvt_pk_bf16_f32 v160, v32, v33
  v_cvt_pk_bf16_f32 v161, v34, v35
  v_cvt_pk_bf16_f32 v162, v36, v37
  v_cvt_pk_bf16_f32 v163, v38, v39
  v_cvt_pk_bf16_f32 v164, v40, v41
  v_cvt_pk_bf16_f32 v165, v42, v43
  v_cvt_pk_bf16_f32 v166, v44, v45
  v_cvt_pk_bf16_f32 v167, v46, v47
  s_nop 1
  v_mfma_f32_32x32x16_bf16 v[144:159], v[48:51], v[160:163], v[144:159]
  v_mfma_f32_32x32x16_bf16 v[144:159], v[52:55], v[164:167], v[144:159]
  s_nop 15
  s_nop 3
FB41:
  v_add_u32 v4, 1024, v4
  v_add_u32 v5, 1024, v5
  s_add_u32 s67, s67, 1
  s_cmp_le_u32 s67, 8
  s_cbranch_scc1 FBL1
  s_cmp_lg_u32 s66, 0
  s_cbranch_scc1 FBR1
  s_mov_b32 s66, 1
  v_mov_b32 v2, v3
  s_nop 1
  v_permlane32_swap_b32 v2, v3
  s_nop 1
  v_max_f32 v2, v2, v3
  v_sub_f32 v2, 0, v2
  s_branch FBP1
FBR1:
  v_mov_b32 v19, -1
  v_not_b32 v12, v253
  s_branch FBDb
DU_A6:
  buffer_store_dwordx4 v[56:59], v1, s[32:35], s12 offen sc1
  s_branch DU_B6
POLL_L7:
  s_sleep 1
  buffer_load_dword v12, v198, s[32:35], 0 offen sc1
  s_waitcnt vmcnt(0)
  v_cmp_ne_u32 vcc, s52, v12
  s_and_b64 vcc, vcc, s[16:17]
  s_sub_u32 s7, s7, 1
  s_cbranch_scc1 POLL_T7
  s_cbranch_vccnz POLL_L7
  s_branch POLL_D7
POLL_T7:
  s_branch POLL_D7
DU_A8:
  buffer_store_dwordx4 v[56:59], v1, s[32:35], s12 offen sc1
  s_branch DU_B8
POLL_L9:
  s_sleep 1
  buffer_load_dword v12, v198, s[32:35], 0 offen sc1
  s_waitcnt vmcnt(0)
  v_cmp_ne_u32 vcc, s52, v12
  s_and_b64 vcc, vcc, s[16:17]
  s_sub_u32 s7, s7, 1
  s_cbranch_scc1 POLL_T9
  s_cbranch_vccnz POLL_L9
  s_branch POLL_D9
POLL_T9:
  s_branch POLL_D9
DU_A10:
  buffer_store_dwordx4 v[56:59], v1, s[32:35], s12 offen sc1
  s_branch DU_B10
POLL_L11:
  s_sleep 1
  buffer_load_dword v12, v198, s[32:35], 0 offen sc1
  s_waitcnt vmcnt(0)
  v_cmp_ne_u32 vcc, s52, v12
  s_and_b64 vcc, vcc, s[16:17]
  s_sub_u32 s7, s7, 1
  s_cbranch_scc1 POLL_T11
  s_cbranch_vccnz POLL_L11
  s_branch POLL_D11
POLL_T11:
  s_branch POLL_D11
DU_A12:
  buffer_store_dwordx4 v[56:59], v1, s[32:35], s12 offen sc1
  s_branch DU_B12
POLL_L13:
  s_sleep 1
  buffer_load_dword v12, v198, s[32:35], 0 offen sc1
  s_waitcnt vmcnt(0)
  v_cmp_ne_u32 vcc, s52, v12
  s_and_b64 vcc, vcc, s[16:17]
  s_sub_u32 s7, s7, 1
  s_cbranch_scc1 POLL_T13
  s_cbranch_vccnz POLL_L13
  s_branch POLL_D13
POLL_T13:
  s_branch POLL_D13
DU_A14:
  buffer_store_dword v253, v198, s[32:35], 0 offen sc1
  s_branch DU_B14
DU_A15:
  buffer_store_dword v253, v218, s[32:35], s79 offen sc1
  s_branch DU_B15
DU_A16:
  buffer_store_dwordx4 v[56:59], v1, s[32:35], s12 offen sc1
  s_branch DU_B16
DU_A17:
  buffer_store_dword v253, v198, s[32:35], 0 offen sc1
  s_branch DU_B17
DU_A18:
  buffer_store_dword v253, v218, s[32:35], s79 offen sc1
  s_branch DU_B18
DU_A19:
  buffer_store_dwordx4 v[56:59], v1, s[32:35], s12 offen sc1
  s_branch DU_B19
DU_A20:
  buffer_store_dword v253, v198, s[32:35], 0 offen sc1
  s_branch DU_B20
DU_A21:
  buffer_store_dword v253, v218, s[32:35], s79 offen sc1
  s_branch DU_B21
DU_A22:
  buffer_store_dwordx4 v[56:59], v1, s[32:35], s12 offen sc1
  s_branch DU_B22
DU_A23:
  buffer_store_dword v253, v198, s[32:35], 0 offen sc1
  s_branch DU_B23
DU_A24:
  buffer_store_dword v253, v218, s[32:35], s79 offen sc1
  s_branch DU_B24
DU_A25:
  buffer_store_dwordx4 v[56:59], v1, s[32:35], s12 offen sc1
  s_branch DU_B25
DU_A26:
  buffer_store_dwordx4 v[60:63], v1, s[32:35], s14 offen sc1
  s_branch DU_B26
K_LAST:
  s_endpgm
  .fill 64, 4, 0xbf800000
.section .rodata,"a"
.p2align 6
.amdhsa_kernel concat_heads__linear_kernel_hedgehog__sliding_block__prompt_kernel
  .amdhsa_next_free_vgpr 256
  .amdhsa_next_free_sgpr 102
  .amdhsa_accum_offset 256
  .amdhsa_group_segment_fixed_size 0
  .amdhsa_kernarg_size 80
  .amdhsa_user_sgpr_count 2
  .amdhsa_user_sgpr_kernarg_segment_ptr 1
  .amdhsa_system_sgpr_workgroup_id_x 1
.end_amdhsa_kernel
```
